```python
import torch

def _softmax(x, axis=-1):
    return torch.softmax(x, dim=axis)
def _gelu(x):
    return torch.nn.functional.gelu(x, approximate="tanh")
def _silu(x):
    return torch.nn.functional.silu(x)
def _sigmoid(x):
    return torch.sigmoid(x)
def _layernorm(x, axis=-1, eps=1e-5):
    m = x.mean(dim=axis, keepdim=True)
    v = x.var(dim=axis, keepdim=True, unbiased=False)
    return (x - m) / torch.sqrt(v + eps)
def _scatter_add(tgt, idx, src, axis=0):
    return tgt.clone().index_add_(axis, idx, src)
def _segment_sum(src, seg, n):
    out = torch.zeros((n,) + src.shape[1:], dtype=src.dtype)
    return out.index_add_(0, seg, src)
def _pad(x, pw):
    flat = tuple(v for pair in reversed(pw) for v in pair)
    return torch.nn.functional.pad(x, flat)

kernel_name = 'standalone__gqa_block_cached__near_ridge'

def setup_inputs():

    _w = (lambda a: (lambda t: t.to(torch.bfloat16) if t.is_floating_point() else t)(torch.as_tensor(a)))
    B, Sq, D = 16, 96, 576
    Hq, Hkv, Sk, Dh = 32, 16, 1024, 128
    assert Hq % Hkv == 0, (Hq, Hkv)
    return {
        "x": _w((lambda *s: torch.randn(*s, dtype=torch.bfloat16) * 0.8)(B, Sq, D)),
        "k_cache": _w((lambda *s: torch.randn(*s, dtype=torch.bfloat16) * 0.8)(B, Hkv, Sk, Dh)),
        "v_cache": _w((lambda *s: torch.randn(*s, dtype=torch.bfloat16) * 0.05)(B, Hkv, Sk, Dh)),
        "wq": _w((lambda *s: torch.randn(*s, dtype=torch.bfloat16) * 0.8)(D, Hq * Dh) * (D ** -0.5)),
        "wo": _w((lambda *s: torch.randn(*s, dtype=torch.bfloat16) * 0.05)(Hq * Dh, D) * ((Hq * Dh) ** -0.5)),
    }

def reference(x, k_cache, v_cache, wq, wo):
    B, Sq, D = x.shape
    Hq, Dh = 32, 128
    Hkv = k_cache.shape[1]
    rep = Hq // Hkv
    q = (lambda x, *d: x.permute(*d))((x @ wq).reshape(B, Sq, Hq, Dh), 0, 2, 1, 3)
    k = (lambda x, n, axis: torch.repeat_interleave(x, n, dim=axis))(k_cache, rep, axis=1)
    v = (lambda x, n, axis: torch.repeat_interleave(x, n, dim=axis))(v_cache, rep, axis=1)
    scores = torch.einsum("bhqd,bhkd->bhqk", q, k) * (Dh ** -0.5)
    p = _softmax(scores, axis=-1)
    o = torch.einsum("bhqk,bhkd->bhqd", p, v)
    return (lambda x, *d: x.permute(*d))(o, 0, 2, 1, 3).reshape(B, Sq, Hq * Dh) @ wo
```

```asm
; @launch grid=(256,1,1) block=(512,1,1) lds=163344
.amdgcn_target "amdgcn-amd-amdhsa--gfx950"
.text
.globl standalone__gqa_block_cached__near_ridge_kernel
.p2align 8
.type standalone__gqa_block_cached__near_ridge_kernel,@function
standalone__gqa_block_cached__near_ridge_kernel:
  s_cmp_ge_u32 s2, 256
  s_cbranch_scc1 L_exit
  s_load_dwordx16 s[36:51], s[0:1], 0
  v_lshrrev_b32 v1, 6, v0
  v_and_b32 v0, 63, v0
  v_readfirstlane_b32 s54, v1
  v_mov_b32 v255, v0
  s_getpc_b64 s[66:67]
L_pc2:
  s_sub_u32 s66, s66, L_pc2-standalone__gqa_block_cached__near_ridge_kernel
  s_subb_u32 s67, s67, 0
  s_lshr_b32 s64, s2, 3
  s_mul_i32 s64, s64, 14
  v_add_u32 v2, s64, v0
  v_lshlrev_b32 v2, 7, v2
  v_min_u32 v2, L_code_end-standalone__gqa_block_cached__near_ridge_kernel-4, v2
  s_cmp_eq_u32 s54, 5
  s_cbranch_scc0 L_nopf2
  s_mov_b64 exec, 0x3fff
  global_load_dword v254, v2, s[66:67]
  s_mov_b64 exec, -1
L_nopf2:
  s_and_b32 s55, s2, 7
  s_lshr_b32 s56, s2, 3
  s_and_b32 s57, s56, 7
  s_lshr_b32 s58, s56, 3
  s_and_b32 s52, s55, 1
  s_lshl_b32 s52, s52, 3
  s_add_u32 s52, s52, s57
  s_lshr_b32 s53, s55, 1
  s_lshl_b32 s53, s53, 2
  s_add_u32 s53, s53, s58
  s_mul_i32 s61, s57, 9
  s_lshr_b32 s61, s61, 3
  s_mul_i32 s64, s58, 2
  s_add_u32 s61, s61, s64
  s_sub_u32 s64, s61, 9
  s_cmp_ge_u32 s61, 9
  s_cselect_b32 s61, s64, s61
  s_and_b32 s70, s55, 3
  s_lshl_b32 s70, s70, 3
  s_add_u32 s70, s70, s57
  s_lshr_b32 s71, s55, 2
  s_lshl_b32 s71, s71, 2
  s_add_u32 s71, s71, s58
  s_mov_b32 s68, s57
  s_mov_b32 s69, s58
  s_lshl_b32 s62, s58, 1
  s_and_b32 s62, s62, 0
  s_cmp_ge_u32 s54, 6
  s_cbranch_scc0 L_nothw
L_hw:
  s_sub_u32 s55, s54, 6
  v_lshrrev_b32 v1, 4, v0
  v_and_b32 v2, 15, v0
  v_lshlrev_b32 v2, 4, v2
  v_and_b32 v3, 1, v1
  v_lshlrev_b32 v3, 2, v3
  v_lshrrev_b32 v4, 1, v1
  v_lshl_add_u32 v3, v4, 4, v3
  v_lshl_add_u32 v3, v3, 13, v2
  s_lshl_b32 s56, s55, 8
  v_add_u32 v10, s56, v3
  v_lshrrev_b32 v3, 3, v0
  v_and_b32 v4, 7, v0
  v_lshrrev_b32 v5, 1, v3
  v_xor_b32 v4, v4, v5
  v_lshlrev_b32 v4, 4, v4
  v_mul_u32_u24 v3, 1152, v3
  s_mul_i32 s56, s55, 55296
  v_add3_u32 v11, v3, v4, s56
  v_xor_b32 v12, 64, v4
  v_add3_u32 v12, v3, v12, s56
  s_mul_i32 s57, s55, 8448
  s_mul_i32 s58, s55, 6144
  s_mov_b32 s67, s61
  s_lshl_b32 s61, s61, 1
  s_waitcnt lgkmcnt(0)
  s_mul_i32 s64, s52, 110592
  s_add_u32 s36, s36, s64
  s_addc_u32 s37, s37, 0
  s_mov_b32 s16, s36
  s_and_b32 s17, s37, 0xffff
  s_mov_b32 s18, 110592
  s_mov_b32 s19, 0x20000
  s_lshl_b32 s64, s53, 9
  s_add_u32 s42, s42, s64
  s_addc_u32 s43, s43, 0
  s_mov_b32 s20, s42
  s_and_b32 s21, s43, 0xffff
  s_mov_b32 s22, 0
  s_mov_b32 s23, 0x20000
  s_sub_u32 s22, 4718592, s64
  s_cmp_eq_u32 s2, 0
  s_cbranch_scc0 L_notok
  s_cmp_eq_u32 s54, 6
  s_cbranch_scc0 L_notok
  s_memrealtime s[90:91]
  s_waitcnt lgkmcnt(0)
  s_or_b32 s90, s90, 1
  s_mov_b64 exec, 1
  v_mov_b32 v2, 0
  v_mov_b32 v4, s90
  v_mov_b32 v5, s91
  global_store_dwordx2 v2, v[4:5], s[48:49] sc1
  s_mov_b64 exec, -1
L_notok:
  s_lshl_b32 s64, s67, 7
  s_add_u32 m0, s58, 126720
  s_add_u32 s59, s64, 0
  buffer_load_dwordx4 v11, s[16:19], s59 offen lds
  s_add_u32 m0, s58, 127744
  s_add_u32 s59, s64, 9216
  buffer_load_dwordx4 v12, s[16:19], s59 offen lds
  s_add_u32 m0, s58, 128768
  s_add_u32 s59, s64, 18432
  buffer_load_dwordx4 v11, s[16:19], s59 offen lds
  s_add_u32 m0, s58, 129792
  s_add_u32 s59, s64, 27648
  buffer_load_dwordx4 v12, s[16:19], s59 offen lds
  s_add_u32 m0, s58, 130816
  s_add_u32 s59, s64, 36864
  buffer_load_dwordx4 v11, s[16:19], s59 offen lds
  s_add_u32 m0, s58, 131840
  s_add_u32 s59, s64, 46080
  buffer_load_dwordx4 v12, s[16:19], s59 offen lds
  s_add_u32 s67, s67, 1
  s_cmp_eq_u32 s67, 9
  s_cselect_b32 s67, 0, s67
  s_lshl_b32 s56, s61, 18
  s_add_u32 m0, s57, 33792
  s_add_u32 s59, s56, 0
  buffer_load_dwordx4 v10, s[20:23], s59 offen lds
  s_add_u32 m0, s57, 34848
  s_add_u32 s59, s56, 8192
  buffer_load_dwordx4 v10, s[20:23], s59 offen lds
  s_add_u32 m0, s57, 35904
  s_add_u32 s59, s56, 16384
  buffer_load_dwordx4 v10, s[20:23], s59 offen lds
  s_add_u32 m0, s57, 36960
  s_add_u32 s59, s56, 24576
  buffer_load_dwordx4 v10, s[20:23], s59 offen lds
  s_add_u32 m0, s57, 38016
  s_add_u32 s59, s56, 65536
  buffer_load_dwordx4 v10, s[20:23], s59 offen lds
  s_add_u32 m0, s57, 39072
  s_add_u32 s59, s56, 73728
  buffer_load_dwordx4 v10, s[20:23], s59 offen lds
  s_add_u32 m0, s57, 40128
  s_add_u32 s59, s56, 81920
  buffer_load_dwordx4 v10, s[20:23], s59 offen lds
  s_add_u32 m0, s57, 41184
  s_add_u32 s59, s56, 90112
  buffer_load_dwordx4 v10, s[20:23], s59 offen lds
  s_add_u32 s61, s61, 1
  s_cmp_eq_u32 s61, 18
  s_cselect_b32 s61, 0, s61
  s_lshl_b32 s56, s61, 18
  s_add_u32 m0, s57, 50688
  s_add_u32 s59, s56, 0
  buffer_load_dwordx4 v10, s[20:23], s59 offen lds
  s_add_u32 m0, s57, 51744
  s_add_u32 s59, s56, 8192
  buffer_load_dwordx4 v10, s[20:23], s59 offen lds
  s_add_u32 m0, s57, 52800
  s_add_u32 s59, s56, 16384
  buffer_load_dwordx4 v10, s[20:23], s59 offen lds
  s_add_u32 m0, s57, 53856
  s_add_u32 s59, s56, 24576
  buffer_load_dwordx4 v10, s[20:23], s59 offen lds
  s_add_u32 m0, s57, 54912
  s_add_u32 s59, s56, 65536
  buffer_load_dwordx4 v10, s[20:23], s59 offen lds
  s_add_u32 m0, s57, 55968
  s_add_u32 s59, s56, 73728
  buffer_load_dwordx4 v10, s[20:23], s59 offen lds
  s_add_u32 m0, s57, 57024
  s_add_u32 s59, s56, 81920
  buffer_load_dwordx4 v10, s[20:23], s59 offen lds
  s_add_u32 m0, s57, 58080
  s_add_u32 s59, s56, 90112
  buffer_load_dwordx4 v10, s[20:23], s59 offen lds
  s_add_u32 s61, s61, 1
  s_cmp_eq_u32 s61, 18
  s_cselect_b32 s61, 0, s61
  s_lshl_b32 s64, s67, 7
  s_add_u32 m0, s58, 139008
  s_add_u32 s59, s64, 0
  buffer_load_dwordx4 v11, s[16:19], s59 offen lds
  s_add_u32 m0, s58, 140032
  s_add_u32 s59, s64, 9216
  buffer_load_dwordx4 v12, s[16:19], s59 offen lds
  s_add_u32 m0, s58, 141056
  s_add_u32 s59, s64, 18432
  buffer_load_dwordx4 v11, s[16:19], s59 offen lds
  s_add_u32 m0, s58, 142080
  s_add_u32 s59, s64, 27648
  buffer_load_dwordx4 v12, s[16:19], s59 offen lds
  s_add_u32 m0, s58, 143104
  s_add_u32 s59, s64, 36864
  buffer_load_dwordx4 v11, s[16:19], s59 offen lds
  s_add_u32 m0, s58, 144128
  s_add_u32 s59, s64, 46080
  buffer_load_dwordx4 v12, s[16:19], s59 offen lds
  s_add_u32 s67, s67, 1
  s_cmp_eq_u32 s67, 9
  s_cselect_b32 s67, 0, s67
  s_lshl_b32 s64, s52, 4
  s_add_u32 s64, s64, s53
  s_lshl_b32 s64, s64, 18
  s_add_u32 s38, s38, s64
  s_addc_u32 s39, s39, 0
  s_add_u32 s40, s40, s64
  s_addc_u32 s41, s41, 0
  s_mov_b32 s8, s38
  s_and_b32 s9, s39, 0xffff
  s_mov_b32 s10, 262144
  s_mov_b32 s11, 0x20000
  s_mov_b32 s12, s40
  s_and_b32 s13, s41, 0xffff
  s_mov_b32 s14, 262144
  s_mov_b32 s15, 0x20000
  s_mov_b32 s24, s44
  s_and_b32 s25, s45, 0xffff
  s_mov_b32 s26, 4718592
  s_mov_b32 s27, 0x20000
  s_mov_b32 s4, s46
  s_and_b32 s5, s47, 0xffff
  s_mov_b32 s6, 1769472
  s_mov_b32 s7, 0x20000
  s_mov_b32 s47, s62
  s_mov_b32 s28, s50
  s_and_b32 s29, s51, 0xffff
  s_mov_b32 s30, 12582912
  s_mov_b32 s31, 0x20000
  s_add_u32 s50, s50, 12582912
  s_addc_u32 s51, s51, 0
  s_mov_b32 s32, s50
  s_and_b32 s33, s51, 0xffff
  s_mov_b32 s34, 4718592
  s_mov_b32 s35, 0x20000
  s_waitcnt vmcnt(14)
  s_barrier
  s_lshl_b32 s56, s61, 18
  s_add_u32 m0, s57, 92928
  s_add_u32 s59, s56, 0
  buffer_load_dwordx4 v10, s[20:23], s59 offen lds
  s_add_u32 m0, s57, 93984
  s_add_u32 s59, s56, 8192
  buffer_load_dwordx4 v10, s[20:23], s59 offen lds
  s_add_u32 m0, s57, 95040
  s_add_u32 s59, s56, 16384
  buffer_load_dwordx4 v10, s[20:23], s59 offen lds
  s_add_u32 m0, s57, 96096
  s_add_u32 s59, s56, 24576
  buffer_load_dwordx4 v10, s[20:23], s59 offen lds
  s_add_u32 m0, s57, 97152
  s_add_u32 s59, s56, 65536
  buffer_load_dwordx4 v10, s[20:23], s59 offen lds
  s_add_u32 m0, s57, 98208
  s_add_u32 s59, s56, 73728
  buffer_load_dwordx4 v10, s[20:23], s59 offen lds
  s_add_u32 m0, s57, 99264
  s_add_u32 s59, s56, 81920
  buffer_load_dwordx4 v10, s[20:23], s59 offen lds
  s_add_u32 m0, s57, 100320
  s_add_u32 s59, s56, 90112
  buffer_load_dwordx4 v10, s[20:23], s59 offen lds
  s_add_u32 s61, s61, 1
  s_cmp_eq_u32 s61, 18
  s_cselect_b32 s61, 0, s61
  s_lshl_b32 s56, s61, 18
  s_add_u32 m0, s57, 109824
  s_add_u32 s59, s56, 0
  buffer_load_dwordx4 v10, s[20:23], s59 offen lds
  s_add_u32 m0, s57, 110880
  s_add_u32 s59, s56, 8192
  buffer_load_dwordx4 v10, s[20:23], s59 offen lds
  s_add_u32 m0, s57, 111936
  s_add_u32 s59, s56, 16384
  buffer_load_dwordx4 v10, s[20:23], s59 offen lds
  s_add_u32 m0, s57, 112992
  s_add_u32 s59, s56, 24576
  buffer_load_dwordx4 v10, s[20:23], s59 offen lds
  s_add_u32 m0, s57, 114048
  s_add_u32 s59, s56, 65536
  buffer_load_dwordx4 v10, s[20:23], s59 offen lds
  s_add_u32 m0, s57, 115104
  s_add_u32 s59, s56, 73728
  buffer_load_dwordx4 v10, s[20:23], s59 offen lds
  s_add_u32 m0, s57, 116160
  s_add_u32 s59, s56, 81920
  buffer_load_dwordx4 v10, s[20:23], s59 offen lds
  s_add_u32 m0, s57, 117216
  s_add_u32 s59, s56, 90112
  buffer_load_dwordx4 v10, s[20:23], s59 offen lds
  s_add_u32 s61, s61, 1
  s_cmp_eq_u32 s61, 18
  s_cselect_b32 s61, 0, s61
  s_waitcnt vmcnt(22)
  s_barrier
  s_lshl_b32 s64, s67, 7
  s_add_u32 m0, s58, 126720
  s_add_u32 s59, s64, 0
  buffer_load_dwordx4 v11, s[16:19], s59 offen lds
  s_add_u32 m0, s58, 127744
  s_add_u32 s59, s64, 9216
  buffer_load_dwordx4 v12, s[16:19], s59 offen lds
  s_add_u32 m0, s58, 128768
  s_add_u32 s59, s64, 18432
  buffer_load_dwordx4 v11, s[16:19], s59 offen lds
  s_lshl_b32 s56, s61, 18
  s_add_u32 m0, s57, 33792
  s_add_u32 s59, s56, 0
  buffer_load_dwordx4 v10, s[20:23], s59 offen lds
  s_add_u32 m0, s57, 34848
  s_add_u32 s59, s56, 8192
  buffer_load_dwordx4 v10, s[20:23], s59 offen lds
  s_add_u32 m0, s57, 35904
  s_add_u32 s59, s56, 16384
  buffer_load_dwordx4 v10, s[20:23], s59 offen lds
  s_add_u32 m0, s57, 36960
  s_add_u32 s59, s56, 24576
  buffer_load_dwordx4 v10, s[20:23], s59 offen lds
  s_add_u32 m0, s57, 38016
  s_add_u32 s59, s56, 65536
  buffer_load_dwordx4 v10, s[20:23], s59 offen lds
  s_add_u32 m0, s57, 39072
  s_add_u32 s59, s56, 73728
  buffer_load_dwordx4 v10, s[20:23], s59 offen lds
  s_add_u32 m0, s57, 40128
  s_add_u32 s59, s56, 81920
  buffer_load_dwordx4 v10, s[20:23], s59 offen lds
  s_add_u32 m0, s57, 41184
  s_add_u32 s59, s56, 90112
  buffer_load_dwordx4 v10, s[20:23], s59 offen lds
  s_add_u32 s61, s61, 1
  s_cmp_eq_u32 s61, 18
  s_cselect_b32 s61, 0, s61
  s_waitcnt vmcnt(19)
  s_barrier
  s_lshl_b32 s64, s67, 7
  s_add_u32 m0, s58, 129792
  s_add_u32 s59, s64, 27648
  buffer_load_dwordx4 v12, s[16:19], s59 offen lds
  s_add_u32 m0, s58, 130816
  s_add_u32 s59, s64, 36864
  buffer_load_dwordx4 v11, s[16:19], s59 offen lds
  s_add_u32 m0, s58, 131840
  s_add_u32 s59, s64, 46080
  buffer_load_dwordx4 v12, s[16:19], s59 offen lds
  s_add_u32 s67, s67, 1
  s_cmp_eq_u32 s67, 9
  s_cselect_b32 s67, 0, s67
  s_lshl_b32 s56, s61, 18
  s_add_u32 m0, s57, 50688
  s_add_u32 s59, s56, 0
  buffer_load_dwordx4 v10, s[20:23], s59 offen lds
  s_add_u32 m0, s57, 51744
  s_add_u32 s59, s56, 8192
  buffer_load_dwordx4 v10, s[20:23], s59 offen lds
  s_add_u32 m0, s57, 52800
  s_add_u32 s59, s56, 16384
  buffer_load_dwordx4 v10, s[20:23], s59 offen lds
  s_add_u32 m0, s57, 53856
  s_add_u32 s59, s56, 24576
  buffer_load_dwordx4 v10, s[20:23], s59 offen lds
  s_add_u32 m0, s57, 54912
  s_add_u32 s59, s56, 65536
  buffer_load_dwordx4 v10, s[20:23], s59 offen lds
  s_add_u32 m0, s57, 55968
  s_add_u32 s59, s56, 73728
  buffer_load_dwordx4 v10, s[20:23], s59 offen lds
  s_add_u32 m0, s57, 57024
  s_add_u32 s59, s56, 81920
  buffer_load_dwordx4 v10, s[20:23], s59 offen lds
  s_add_u32 m0, s57, 58080
  s_add_u32 s59, s56, 90112
  buffer_load_dwordx4 v10, s[20:23], s59 offen lds
  s_add_u32 s61, s61, 1
  s_cmp_eq_u32 s61, 18
  s_cselect_b32 s61, 0, s61
  s_waitcnt vmcnt(22)
  s_barrier
  s_lshl_b32 s64, s67, 7
  s_add_u32 m0, s58, 139008
  s_add_u32 s59, s64, 0
  buffer_load_dwordx4 v11, s[16:19], s59 offen lds
  s_add_u32 m0, s58, 140032
  s_add_u32 s59, s64, 9216
  buffer_load_dwordx4 v12, s[16:19], s59 offen lds
  s_add_u32 m0, s58, 141056
  s_add_u32 s59, s64, 18432
  buffer_load_dwordx4 v11, s[16:19], s59 offen lds
  s_lshl_b32 s56, s61, 18
  s_add_u32 m0, s57, 92928
  s_add_u32 s59, s56, 0
  buffer_load_dwordx4 v10, s[20:23], s59 offen lds
  s_add_u32 m0, s57, 93984
  s_add_u32 s59, s56, 8192
  buffer_load_dwordx4 v10, s[20:23], s59 offen lds
  s_add_u32 m0, s57, 95040
  s_add_u32 s59, s56, 16384
  buffer_load_dwordx4 v10, s[20:23], s59 offen lds
  s_add_u32 m0, s57, 96096
  s_add_u32 s59, s56, 24576
  buffer_load_dwordx4 v10, s[20:23], s59 offen lds
  s_add_u32 m0, s57, 97152
  s_add_u32 s59, s56, 65536
  buffer_load_dwordx4 v10, s[20:23], s59 offen lds
  s_add_u32 m0, s57, 98208
  s_add_u32 s59, s56, 73728
  buffer_load_dwordx4 v10, s[20:23], s59 offen lds
  s_add_u32 m0, s57, 99264
  s_add_u32 s59, s56, 81920
  buffer_load_dwordx4 v10, s[20:23], s59 offen lds
  s_add_u32 m0, s57, 100320
  s_add_u32 s59, s56, 90112
  buffer_load_dwordx4 v10, s[20:23], s59 offen lds
  s_add_u32 s61, s61, 1
  s_cmp_eq_u32 s61, 18
  s_cselect_b32 s61, 0, s61
  s_waitcnt vmcnt(19)
  s_barrier
  s_lshl_b32 s64, s67, 7
  s_add_u32 m0, s58, 142080
  s_add_u32 s59, s64, 27648
  buffer_load_dwordx4 v12, s[16:19], s59 offen lds
  s_add_u32 m0, s58, 143104
  s_add_u32 s59, s64, 36864
  buffer_load_dwordx4 v11, s[16:19], s59 offen lds
  s_add_u32 m0, s58, 144128
  s_add_u32 s59, s64, 46080
  buffer_load_dwordx4 v12, s[16:19], s59 offen lds
  s_add_u32 s67, s67, 1
  s_cmp_eq_u32 s67, 9
  s_cselect_b32 s67, 0, s67
  s_lshl_b32 s56, s61, 18
  s_add_u32 m0, s57, 109824
  s_add_u32 s59, s56, 0
  buffer_load_dwordx4 v10, s[20:23], s59 offen lds
  s_add_u32 m0, s57, 110880
  s_add_u32 s59, s56, 8192
  buffer_load_dwordx4 v10, s[20:23], s59 offen lds
  s_add_u32 m0, s57, 111936
  s_add_u32 s59, s56, 16384
  buffer_load_dwordx4 v10, s[20:23], s59 offen lds
  s_add_u32 m0, s57, 112992
  s_add_u32 s59, s56, 24576
  buffer_load_dwordx4 v10, s[20:23], s59 offen lds
  s_add_u32 m0, s57, 114048
  s_add_u32 s59, s56, 65536
  buffer_load_dwordx4 v10, s[20:23], s59 offen lds
  s_add_u32 m0, s57, 115104
  s_add_u32 s59, s56, 73728
  buffer_load_dwordx4 v10, s[20:23], s59 offen lds
  s_add_u32 m0, s57, 116160
  s_add_u32 s59, s56, 81920
  buffer_load_dwordx4 v10, s[20:23], s59 offen lds
  s_add_u32 m0, s57, 117216
  s_add_u32 s59, s56, 90112
  buffer_load_dwordx4 v10, s[20:23], s59 offen lds
  s_add_u32 s61, s61, 1
  s_cmp_eq_u32 s61, 18
  s_cselect_b32 s61, 0, s61
  s_waitcnt vmcnt(22)
  s_barrier
  s_lshl_b32 s64, s67, 7
  s_add_u32 m0, s58, 126720
  s_add_u32 s59, s64, 0
  buffer_load_dwordx4 v11, s[16:19], s59 offen lds
  s_add_u32 m0, s58, 127744
  s_add_u32 s59, s64, 9216
  buffer_load_dwordx4 v12, s[16:19], s59 offen lds
  s_add_u32 m0, s58, 128768
  s_add_u32 s59, s64, 18432
  buffer_load_dwordx4 v11, s[16:19], s59 offen lds
  s_lshl_b32 s56, s61, 18
  s_add_u32 m0, s57, 33792
  s_add_u32 s59, s56, 0
  buffer_load_dwordx4 v10, s[20:23], s59 offen lds
  s_add_u32 m0, s57, 34848
  s_add_u32 s59, s56, 8192
  buffer_load_dwordx4 v10, s[20:23], s59 offen lds
  s_add_u32 m0, s57, 35904
  s_add_u32 s59, s56, 16384
  buffer_load_dwordx4 v10, s[20:23], s59 offen lds
  s_add_u32 m0, s57, 36960
  s_add_u32 s59, s56, 24576
  buffer_load_dwordx4 v10, s[20:23], s59 offen lds
  s_add_u32 m0, s57, 38016
  s_add_u32 s59, s56, 65536
  buffer_load_dwordx4 v10, s[20:23], s59 offen lds
  s_add_u32 m0, s57, 39072
  s_add_u32 s59, s56, 73728
  buffer_load_dwordx4 v10, s[20:23], s59 offen lds
  s_add_u32 m0, s57, 40128
  s_add_u32 s59, s56, 81920
  buffer_load_dwordx4 v10, s[20:23], s59 offen lds
  s_add_u32 m0, s57, 41184
  s_add_u32 s59, s56, 90112
  buffer_load_dwordx4 v10, s[20:23], s59 offen lds
  s_add_u32 s61, s61, 1
  s_cmp_eq_u32 s61, 18
  s_cselect_b32 s61, 0, s61
  s_waitcnt vmcnt(19)
  s_barrier
  s_lshl_b32 s64, s67, 7
  s_add_u32 m0, s58, 129792
  s_add_u32 s59, s64, 27648
  buffer_load_dwordx4 v12, s[16:19], s59 offen lds
  s_add_u32 m0, s58, 130816
  s_add_u32 s59, s64, 36864
  buffer_load_dwordx4 v11, s[16:19], s59 offen lds
  s_add_u32 m0, s58, 131840
  s_add_u32 s59, s64, 46080
  buffer_load_dwordx4 v12, s[16:19], s59 offen lds
  s_add_u32 s67, s67, 1
  s_cmp_eq_u32 s67, 9
  s_cselect_b32 s67, 0, s67
  s_lshl_b32 s56, s61, 18
  s_add_u32 m0, s57, 50688
  s_add_u32 s59, s56, 0
  buffer_load_dwordx4 v10, s[20:23], s59 offen lds
  s_add_u32 m0, s57, 51744
  s_add_u32 s59, s56, 8192
  buffer_load_dwordx4 v10, s[20:23], s59 offen lds
  s_add_u32 m0, s57, 52800
  s_add_u32 s59, s56, 16384
  buffer_load_dwordx4 v10, s[20:23], s59 offen lds
  s_add_u32 m0, s57, 53856
  s_add_u32 s59, s56, 24576
  buffer_load_dwordx4 v10, s[20:23], s59 offen lds
  s_add_u32 m0, s57, 54912
  s_add_u32 s59, s56, 65536
  buffer_load_dwordx4 v10, s[20:23], s59 offen lds
  s_add_u32 m0, s57, 55968
  s_add_u32 s59, s56, 73728
  buffer_load_dwordx4 v10, s[20:23], s59 offen lds
  s_add_u32 m0, s57, 57024
  s_add_u32 s59, s56, 81920
  buffer_load_dwordx4 v10, s[20:23], s59 offen lds
  s_add_u32 m0, s57, 58080
  s_add_u32 s59, s56, 90112
  buffer_load_dwordx4 v10, s[20:23], s59 offen lds
  s_add_u32 s61, s61, 1
  s_cmp_eq_u32 s61, 18
  s_cselect_b32 s61, 0, s61
  s_waitcnt vmcnt(22)
  s_barrier
  s_lshl_b32 s64, s67, 7
  s_add_u32 m0, s58, 139008
  s_add_u32 s59, s64, 0
  buffer_load_dwordx4 v11, s[16:19], s59 offen lds
  s_add_u32 m0, s58, 140032
  s_add_u32 s59, s64, 9216
  buffer_load_dwordx4 v12, s[16:19], s59 offen lds
  s_add_u32 m0, s58, 141056
  s_add_u32 s59, s64, 18432
  buffer_load_dwordx4 v11, s[16:19], s59 offen lds
  s_lshl_b32 s56, s61, 18
  s_add_u32 m0, s57, 92928
  s_add_u32 s59, s56, 0
  buffer_load_dwordx4 v10, s[20:23], s59 offen lds
  s_add_u32 m0, s57, 93984
  s_add_u32 s59, s56, 8192
  buffer_load_dwordx4 v10, s[20:23], s59 offen lds
  s_add_u32 m0, s57, 95040
  s_add_u32 s59, s56, 16384
  buffer_load_dwordx4 v10, s[20:23], s59 offen lds
  s_add_u32 m0, s57, 96096
  s_add_u32 s59, s56, 24576
  buffer_load_dwordx4 v10, s[20:23], s59 offen lds
  s_add_u32 m0, s57, 97152
  s_add_u32 s59, s56, 65536
  buffer_load_dwordx4 v10, s[20:23], s59 offen lds
  s_add_u32 m0, s57, 98208
  s_add_u32 s59, s56, 73728
  buffer_load_dwordx4 v10, s[20:23], s59 offen lds
  s_add_u32 m0, s57, 99264
  s_add_u32 s59, s56, 81920
  buffer_load_dwordx4 v10, s[20:23], s59 offen lds
  s_add_u32 m0, s57, 100320
  s_add_u32 s59, s56, 90112
  buffer_load_dwordx4 v10, s[20:23], s59 offen lds
  s_add_u32 s61, s61, 1
  s_cmp_eq_u32 s61, 18
  s_cselect_b32 s61, 0, s61
  s_waitcnt vmcnt(19)
  s_barrier
  s_lshl_b32 s64, s67, 7
  s_add_u32 m0, s58, 142080
  s_add_u32 s59, s64, 27648
  buffer_load_dwordx4 v12, s[16:19], s59 offen lds
  s_add_u32 m0, s58, 143104
  s_add_u32 s59, s64, 36864
  buffer_load_dwordx4 v11, s[16:19], s59 offen lds
  s_add_u32 m0, s58, 144128
  s_add_u32 s59, s64, 46080
  buffer_load_dwordx4 v12, s[16:19], s59 offen lds
  s_add_u32 s67, s67, 1
  s_cmp_eq_u32 s67, 9
  s_cselect_b32 s67, 0, s67
  s_lshl_b32 s56, s61, 18
  s_add_u32 m0, s57, 109824
  s_add_u32 s59, s56, 0
  buffer_load_dwordx4 v10, s[20:23], s59 offen lds
  s_add_u32 m0, s57, 110880
  s_add_u32 s59, s56, 8192
  buffer_load_dwordx4 v10, s[20:23], s59 offen lds
  s_add_u32 m0, s57, 111936
  s_add_u32 s59, s56, 16384
  buffer_load_dwordx4 v10, s[20:23], s59 offen lds
  s_add_u32 m0, s57, 112992
  s_add_u32 s59, s56, 24576
  buffer_load_dwordx4 v10, s[20:23], s59 offen lds
  s_add_u32 m0, s57, 114048
  s_add_u32 s59, s56, 65536
  buffer_load_dwordx4 v10, s[20:23], s59 offen lds
  s_add_u32 m0, s57, 115104
  s_add_u32 s59, s56, 73728
  buffer_load_dwordx4 v10, s[20:23], s59 offen lds
  s_add_u32 m0, s57, 116160
  s_add_u32 s59, s56, 81920
  buffer_load_dwordx4 v10, s[20:23], s59 offen lds
  s_add_u32 m0, s57, 117216
  s_add_u32 s59, s56, 90112
  buffer_load_dwordx4 v10, s[20:23], s59 offen lds
  s_add_u32 s61, s61, 1
  s_cmp_eq_u32 s61, 18
  s_cselect_b32 s61, 0, s61
  s_waitcnt vmcnt(22)
  s_barrier
  s_lshl_b32 s64, s67, 7
  s_add_u32 m0, s58, 126720
  s_add_u32 s59, s64, 0
  buffer_load_dwordx4 v11, s[16:19], s59 offen lds
  s_add_u32 m0, s58, 127744
  s_add_u32 s59, s64, 9216
  buffer_load_dwordx4 v12, s[16:19], s59 offen lds
  s_add_u32 m0, s58, 128768
  s_add_u32 s59, s64, 18432
  buffer_load_dwordx4 v11, s[16:19], s59 offen lds
  s_lshl_b32 s56, s61, 18
  s_add_u32 m0, s57, 33792
  s_add_u32 s59, s56, 0
  buffer_load_dwordx4 v10, s[20:23], s59 offen lds
  s_add_u32 m0, s57, 34848
  s_add_u32 s59, s56, 8192
  buffer_load_dwordx4 v10, s[20:23], s59 offen lds
  s_add_u32 m0, s57, 35904
  s_add_u32 s59, s56, 16384
  buffer_load_dwordx4 v10, s[20:23], s59 offen lds
  s_add_u32 m0, s57, 36960
  s_add_u32 s59, s56, 24576
  buffer_load_dwordx4 v10, s[20:23], s59 offen lds
  s_add_u32 m0, s57, 38016
  s_add_u32 s59, s56, 65536
  buffer_load_dwordx4 v10, s[20:23], s59 offen lds
  s_add_u32 m0, s57, 39072
  s_add_u32 s59, s56, 73728
  buffer_load_dwordx4 v10, s[20:23], s59 offen lds
  s_add_u32 m0, s57, 40128
  s_add_u32 s59, s56, 81920
  buffer_load_dwordx4 v10, s[20:23], s59 offen lds
  s_add_u32 m0, s57, 41184
  s_add_u32 s59, s56, 90112
  buffer_load_dwordx4 v10, s[20:23], s59 offen lds
  s_add_u32 s61, s61, 1
  s_cmp_eq_u32 s61, 18
  s_cselect_b32 s61, 0, s61
  s_waitcnt vmcnt(19)
  s_barrier
  s_lshl_b32 s64, s67, 7
  s_add_u32 m0, s58, 129792
  s_add_u32 s59, s64, 27648
  buffer_load_dwordx4 v12, s[16:19], s59 offen lds
  s_add_u32 m0, s58, 130816
  s_add_u32 s59, s64, 36864
  buffer_load_dwordx4 v11, s[16:19], s59 offen lds
  s_add_u32 m0, s58, 131840
  s_add_u32 s59, s64, 46080
  buffer_load_dwordx4 v12, s[16:19], s59 offen lds
  s_add_u32 s67, s67, 1
  s_cmp_eq_u32 s67, 9
  s_cselect_b32 s67, 0, s67
  s_lshl_b32 s56, s61, 18
  s_add_u32 m0, s57, 50688
  s_add_u32 s59, s56, 0
  buffer_load_dwordx4 v10, s[20:23], s59 offen lds
  s_add_u32 m0, s57, 51744
  s_add_u32 s59, s56, 8192
  buffer_load_dwordx4 v10, s[20:23], s59 offen lds
  s_add_u32 m0, s57, 52800
  s_add_u32 s59, s56, 16384
  buffer_load_dwordx4 v10, s[20:23], s59 offen lds
  s_add_u32 m0, s57, 53856
  s_add_u32 s59, s56, 24576
  buffer_load_dwordx4 v10, s[20:23], s59 offen lds
  s_add_u32 m0, s57, 54912
  s_add_u32 s59, s56, 65536
  buffer_load_dwordx4 v10, s[20:23], s59 offen lds
  s_add_u32 m0, s57, 55968
  s_add_u32 s59, s56, 73728
  buffer_load_dwordx4 v10, s[20:23], s59 offen lds
  s_add_u32 m0, s57, 57024
  s_add_u32 s59, s56, 81920
  buffer_load_dwordx4 v10, s[20:23], s59 offen lds
  s_add_u32 m0, s57, 58080
  s_add_u32 s59, s56, 90112
  buffer_load_dwordx4 v10, s[20:23], s59 offen lds
  s_add_u32 s61, s61, 1
  s_cmp_eq_u32 s61, 18
  s_cselect_b32 s61, 0, s61
  s_waitcnt vmcnt(22)
  s_barrier
  s_lshl_b32 s64, s67, 7
  s_add_u32 m0, s58, 139008
  s_add_u32 s59, s64, 0
  buffer_load_dwordx4 v11, s[16:19], s59 offen lds
  s_add_u32 m0, s58, 140032
  s_add_u32 s59, s64, 9216
  buffer_load_dwordx4 v12, s[16:19], s59 offen lds
  s_add_u32 m0, s58, 141056
  s_add_u32 s59, s64, 18432
  buffer_load_dwordx4 v11, s[16:19], s59 offen lds
  s_lshl_b32 s56, s61, 18
  s_add_u32 m0, s57, 92928
  s_add_u32 s59, s56, 0
  buffer_load_dwordx4 v10, s[20:23], s59 offen lds
  s_add_u32 m0, s57, 93984
  s_add_u32 s59, s56, 8192
  buffer_load_dwordx4 v10, s[20:23], s59 offen lds
  s_add_u32 m0, s57, 95040
  s_add_u32 s59, s56, 16384
  buffer_load_dwordx4 v10, s[20:23], s59 offen lds
  s_add_u32 m0, s57, 96096
  s_add_u32 s59, s56, 24576
  buffer_load_dwordx4 v10, s[20:23], s59 offen lds
  s_add_u32 m0, s57, 97152
  s_add_u32 s59, s56, 65536
  buffer_load_dwordx4 v10, s[20:23], s59 offen lds
  s_add_u32 m0, s57, 98208
  s_add_u32 s59, s56, 73728
  buffer_load_dwordx4 v10, s[20:23], s59 offen lds
  s_add_u32 m0, s57, 99264
  s_add_u32 s59, s56, 81920
  buffer_load_dwordx4 v10, s[20:23], s59 offen lds
  s_add_u32 m0, s57, 100320
  s_add_u32 s59, s56, 90112
  buffer_load_dwordx4 v10, s[20:23], s59 offen lds
  s_add_u32 s61, s61, 1
  s_cmp_eq_u32 s61, 18
  s_cselect_b32 s61, 0, s61
  s_waitcnt vmcnt(19)
  s_barrier
  s_lshl_b32 s64, s67, 7
  s_add_u32 m0, s58, 142080
  s_add_u32 s59, s64, 27648
  buffer_load_dwordx4 v12, s[16:19], s59 offen lds
  s_add_u32 m0, s58, 143104
  s_add_u32 s59, s64, 36864
  buffer_load_dwordx4 v11, s[16:19], s59 offen lds
  s_add_u32 m0, s58, 144128
  s_add_u32 s59, s64, 46080
  buffer_load_dwordx4 v12, s[16:19], s59 offen lds
  s_add_u32 s67, s67, 1
  s_cmp_eq_u32 s67, 9
  s_cselect_b32 s67, 0, s67
  s_lshl_b32 s56, s61, 18
  s_add_u32 m0, s57, 109824
  s_add_u32 s59, s56, 0
  buffer_load_dwordx4 v10, s[20:23], s59 offen lds
  s_add_u32 m0, s57, 110880
  s_add_u32 s59, s56, 8192
  buffer_load_dwordx4 v10, s[20:23], s59 offen lds
  s_add_u32 m0, s57, 111936
  s_add_u32 s59, s56, 16384
  buffer_load_dwordx4 v10, s[20:23], s59 offen lds
  s_add_u32 m0, s57, 112992
  s_add_u32 s59, s56, 24576
  buffer_load_dwordx4 v10, s[20:23], s59 offen lds
  s_add_u32 m0, s57, 114048
  s_add_u32 s59, s56, 65536
  buffer_load_dwordx4 v10, s[20:23], s59 offen lds
  s_add_u32 m0, s57, 115104
  s_add_u32 s59, s56, 73728
  buffer_load_dwordx4 v10, s[20:23], s59 offen lds
  s_add_u32 m0, s57, 116160
  s_add_u32 s59, s56, 81920
  buffer_load_dwordx4 v10, s[20:23], s59 offen lds
  s_add_u32 m0, s57, 117216
  s_add_u32 s59, s56, 90112
  buffer_load_dwordx4 v10, s[20:23], s59 offen lds
  s_add_u32 s61, s61, 1
  s_cmp_eq_u32 s61, 18
  s_cselect_b32 s61, 0, s61
  s_waitcnt vmcnt(22)
  s_barrier
  s_lshl_b32 s64, s67, 7
  s_add_u32 m0, s58, 126720
  s_add_u32 s59, s64, 0
  buffer_load_dwordx4 v11, s[16:19], s59 offen lds
  s_add_u32 m0, s58, 127744
  s_add_u32 s59, s64, 9216
  buffer_load_dwordx4 v12, s[16:19], s59 offen lds
  s_add_u32 m0, s58, 128768
  s_add_u32 s59, s64, 18432
  buffer_load_dwordx4 v11, s[16:19], s59 offen lds
  s_lshl_b32 s56, s61, 18
  s_add_u32 m0, s57, 33792
  s_add_u32 s59, s56, 0
  buffer_load_dwordx4 v10, s[20:23], s59 offen lds
  s_add_u32 m0, s57, 34848
  s_add_u32 s59, s56, 8192
  buffer_load_dwordx4 v10, s[20:23], s59 offen lds
  s_add_u32 m0, s57, 35904
  s_add_u32 s59, s56, 16384
  buffer_load_dwordx4 v10, s[20:23], s59 offen lds
  s_add_u32 m0, s57, 36960
  s_add_u32 s59, s56, 24576
  buffer_load_dwordx4 v10, s[20:23], s59 offen lds
  s_add_u32 m0, s57, 38016
  s_add_u32 s59, s56, 65536
  buffer_load_dwordx4 v10, s[20:23], s59 offen lds
  s_add_u32 m0, s57, 39072
  s_add_u32 s59, s56, 73728
  buffer_load_dwordx4 v10, s[20:23], s59 offen lds
  s_add_u32 m0, s57, 40128
  s_add_u32 s59, s56, 81920
  buffer_load_dwordx4 v10, s[20:23], s59 offen lds
  s_add_u32 m0, s57, 41184
  s_add_u32 s59, s56, 90112
  buffer_load_dwordx4 v10, s[20:23], s59 offen lds
  s_add_u32 s61, s61, 1
  s_cmp_eq_u32 s61, 18
  s_cselect_b32 s61, 0, s61
  s_waitcnt vmcnt(19)
  s_barrier
  s_lshl_b32 s64, s67, 7
  s_add_u32 m0, s58, 129792
  s_add_u32 s59, s64, 27648
  buffer_load_dwordx4 v12, s[16:19], s59 offen lds
  s_add_u32 m0, s58, 130816
  s_add_u32 s59, s64, 36864
  buffer_load_dwordx4 v11, s[16:19], s59 offen lds
  s_add_u32 m0, s58, 131840
  s_add_u32 s59, s64, 46080
  buffer_load_dwordx4 v12, s[16:19], s59 offen lds
  s_add_u32 s67, s67, 1
  s_cmp_eq_u32 s67, 9
  s_cselect_b32 s67, 0, s67
  s_lshl_b32 s56, s61, 18
  s_add_u32 m0, s57, 50688
  s_add_u32 s59, s56, 0
  buffer_load_dwordx4 v10, s[20:23], s59 offen lds
  s_add_u32 m0, s57, 51744
  s_add_u32 s59, s56, 8192
  buffer_load_dwordx4 v10, s[20:23], s59 offen lds
  s_add_u32 m0, s57, 52800
  s_add_u32 s59, s56, 16384
  buffer_load_dwordx4 v10, s[20:23], s59 offen lds
  s_add_u32 m0, s57, 53856
  s_add_u32 s59, s56, 24576
  buffer_load_dwordx4 v10, s[20:23], s59 offen lds
  s_add_u32 m0, s57, 54912
  s_add_u32 s59, s56, 65536
  buffer_load_dwordx4 v10, s[20:23], s59 offen lds
  s_add_u32 m0, s57, 55968
  s_add_u32 s59, s56, 73728
  buffer_load_dwordx4 v10, s[20:23], s59 offen lds
  s_add_u32 m0, s57, 57024
  s_add_u32 s59, s56, 81920
  buffer_load_dwordx4 v10, s[20:23], s59 offen lds
  s_add_u32 m0, s57, 58080
  s_add_u32 s59, s56, 90112
  buffer_load_dwordx4 v10, s[20:23], s59 offen lds
  s_add_u32 s61, s61, 1
  s_cmp_eq_u32 s61, 18
  s_cselect_b32 s61, 0, s61
  s_waitcnt vmcnt(22)
  s_barrier
  s_waitcnt vmcnt(8)
  s_barrier
  s_waitcnt vmcnt(0)
  s_barrier
  s_barrier
  s_lshl_b32 s56, s2, 1
  s_add_u32 s56, s56, s55
  s_and_b32 s57, s56, 7
  s_lshr_b32 s58, s56, 3
  s_cmp_eq_u32 s54, 6
  s_mov_b32 s66, 153600
  s_cselect_b32 s66, 135168, s66
  s_mul_i32 s67, s58, 73728
  s_mul_i32 s64, s57, 144
  s_add_u32 s67, s67, s64
  s_mov_b32 s65, 0x1c71c71d
  v_add_u32 v20, 0, v0
  v_mul_hi_u32 v21, v20, s65
  v_mul_u32_u24 v22, 9, v21
  v_sub_u32 v22, v20, v22
  v_mul_u32_u24 v21, 1152, v21
  v_lshl_add_u32 v24, v22, 4, v21
  v_add_u32 v20, 64, v0
  v_mul_hi_u32 v21, v20, s65
  v_mul_u32_u24 v22, 9, v21
  v_sub_u32 v22, v20, v22
  v_mul_u32_u24 v21, 1152, v21
  v_lshl_add_u32 v25, v22, 4, v21
  v_add_u32 v20, 128, v0
  v_mul_hi_u32 v21, v20, s65
  v_mul_u32_u24 v22, 9, v21
  v_sub_u32 v22, v20, v22
  v_mul_u32_u24 v21, 1152, v21
  v_lshl_add_u32 v26, v22, 4, v21
  v_add_u32 v20, 192, v0
  v_mul_hi_u32 v21, v20, s65
  v_mul_u32_u24 v22, 9, v21
  v_sub_u32 v22, v20, v22
  v_mul_u32_u24 v21, 1152, v21
  v_lshl_add_u32 v27, v22, 4, v21
  v_add_u32 v20, 256, v0
  v_mul_hi_u32 v21, v20, s65
  v_mul_u32_u24 v22, 9, v21
  v_sub_u32 v22, v20, v22
  v_mul_u32_u24 v21, 1152, v21
  v_lshl_add_u32 v28, v22, 4, v21
  v_add_u32 v20, 320, v0
  v_mul_hi_u32 v21, v20, s65
  v_mul_u32_u24 v22, 9, v21
  v_sub_u32 v22, v20, v22
  v_mul_u32_u24 v21, 1152, v21
  v_lshl_add_u32 v29, v22, 4, v21
  v_add_u32 v20, 384, v0
  v_mul_hi_u32 v21, v20, s65
  v_mul_u32_u24 v22, 9, v21
  v_sub_u32 v22, v20, v22
  v_mul_u32_u24 v21, 1152, v21
  v_lshl_add_u32 v30, v22, 4, v21
  v_add_u32 v20, 448, v0
  v_mul_hi_u32 v21, v20, s65
  v_mul_u32_u24 v22, 9, v21
  v_sub_u32 v22, v20, v22
  v_mul_u32_u24 v21, 1152, v21
  v_lshl_add_u32 v31, v22, 4, v21
  v_add_u32 v20, 512, v0
  v_mul_hi_u32 v21, v20, s65
  v_mul_u32_u24 v22, 9, v21
  v_sub_u32 v22, v20, v22
  v_mul_u32_u24 v21, 1152, v21
  v_lshl_add_u32 v32, v22, 4, v21
  s_add_u32 m0, s66, 0
  s_nop 0
  buffer_load_dwordx4 v24, s[24:27], s67 offen lds
  s_add_u32 m0, s66, 1024
  s_nop 0
  buffer_load_dwordx4 v25, s[24:27], s67 offen lds
  s_add_u32 m0, s66, 2048
  s_nop 0
  buffer_load_dwordx4 v26, s[24:27], s67 offen lds
  s_add_u32 m0, s66, 3072
  s_nop 0
  buffer_load_dwordx4 v27, s[24:27], s67 offen lds
  s_add_u32 m0, s66, 4096
  s_nop 0
  buffer_load_dwordx4 v28, s[24:27], s67 offen lds
  s_add_u32 m0, s66, 5120
  s_nop 0
  buffer_load_dwordx4 v29, s[24:27], s67 offen lds
  s_add_u32 m0, s66, 6144
  s_nop 0
  buffer_load_dwordx4 v30, s[24:27], s67 offen lds
  s_add_u32 m0, s66, 7168
  s_nop 0
  buffer_load_dwordx4 v31, s[24:27], s67 offen lds
  s_add_u32 m0, s66, 8192
  s_nop 0
  buffer_load_dwordx4 v32, s[24:27], s67 offen lds
  v_mov_b32 v14, 0
  global_load_dwordx2 v[12:13], v14, s[48:49] sc1
  v_lshrrev_b32 v1, 4, v0
  v_bfe_u32 v3, v0, 2, 2
  v_and_b32 v4, 3, v0
  v_lshl_add_u32 v5, v1, 2, v3
  v_mul_u32_u24 v5, 144, v5
  v_lshl_add_u32 v6, v4, 3, v5
  v_add_u32 v6, s66, v6
  v_and_b32 v7, 1, v4
  v_lshlrev_b32 v7, 3, v7
  v_lshrrev_b32 v8, 1, v4
  v_mul_u32_u24 v8, 4608, v8
  v_add3_u32 v7, v5, v7, v8
  v_add_u32 v7, 128, v7
  v_add_u32 v7, s66, v7
  s_lshl_b32 s64, s57, 6
  s_add_u32 s64, s64, s58
  s_mul_i32 s64, s64, 9216
  v_lshlrev_b32 v9, 4, v0
  v_add_u32 v9, s64, v9
  s_waitcnt vmcnt(0)
  ds_read_b64_tr_b16 v[34:35], v6 offset:0
  ds_read_b64_tr_b16 v[36:37], v6 offset:2304
  ds_read_b64_tr_b16 v[38:39], v6 offset:32
  ds_read_b64_tr_b16 v[40:41], v6 offset:2336
  ds_read_b64_tr_b16 v[42:43], v6 offset:64
  ds_read_b64_tr_b16 v[44:45], v6 offset:2368
  ds_read_b64_tr_b16 v[46:47], v6 offset:96
  ds_read_b64_tr_b16 v[48:49], v6 offset:2400
  ds_read_b64_tr_b16 v[50:51], v6 offset:4608
  ds_read_b64_tr_b16 v[52:53], v6 offset:6912
  ds_read_b64_tr_b16 v[54:55], v6 offset:4640
  ds_read_b64_tr_b16 v[56:57], v6 offset:6944
  ds_read_b64_tr_b16 v[58:59], v6 offset:4672
  ds_read_b64_tr_b16 v[60:61], v6 offset:6976
  ds_read_b64_tr_b16 v[62:63], v6 offset:4704
  ds_read_b64_tr_b16 v[64:65], v6 offset:7008
  ds_read_b64_tr_b16 v[66:67], v7
  ds_read_b64_tr_b16 v[68:69], v7 offset:2304
  s_waitcnt lgkmcnt(0)
  s_mov_b32 s59, 0
  buffer_store_dwordx4 v[34:37], v9, s[32:35], s59 offen sc1
  s_mov_b32 s59, 1024
  buffer_store_dwordx4 v[38:41], v9, s[32:35], s59 offen sc1
  s_mov_b32 s59, 2048
  buffer_store_dwordx4 v[42:45], v9, s[32:35], s59 offen sc1
  s_mov_b32 s59, 3072
  buffer_store_dwordx4 v[46:49], v9, s[32:35], s59 offen sc1
  s_mov_b32 s59, 4096
  buffer_store_dwordx4 v[50:53], v9, s[32:35], s59 offen sc1
  s_mov_b32 s59, 5120
  buffer_store_dwordx4 v[54:57], v9, s[32:35], s59 offen sc1
  s_mov_b32 s59, 6144
  buffer_store_dwordx4 v[58:61], v9, s[32:35], s59 offen sc1
  s_mov_b32 s59, 7168
  buffer_store_dwordx4 v[62:65], v9, s[32:35], s59 offen sc1
  s_mov_b32 s59, 8192
  buffer_store_dwordx4 v[66:69], v9, s[32:35], s59 offen sc1
  s_waitcnt vmcnt(0)
  v_readfirstlane_b32 s92, v12
  v_readfirstlane_b32 s93, v13
  s_nop 0
  s_cmp_lg_u32 s92, 0
  s_cbranch_scc1 L_wtok_ok
  s_mov_b64 exec, 1
  v_mov_b32 v2, 0
  s_mov_b32 s65, 1048576
L_tokw:
  global_load_dwordx2 v[4:5], v2, s[48:49] sc1
  s_waitcnt vmcnt(0)
  v_readfirstlane_b32 s92, v4
  v_readfirstlane_b32 s93, v5
  s_nop 0
  s_cmp_lg_u32 s92, 0
  s_cbranch_scc1 L_tokw_ok
  s_sleep 2
  s_sub_u32 s65, s65, 1
  s_cmp_lg_u32 s65, 0
  s_cbranch_scc1 L_tokw
L_tokw_ok:
  s_mov_b64 exec, -1
L_wtok_ok:
  s_lshl_b32 s64, s57, 9
  s_lshl_b32 s67, s58, 3
  s_add_u32 s67, s67, s64
  s_add_u32 s67, s67, 12845056
  s_mov_b64 exec, 1
  v_mov_b32 v2, s67
  v_mov_b32 v4, s92
  v_mov_b32 v5, s93
  global_store_dwordx2 v2, v[4:5], s[50:51] sc1
  s_mov_b64 exec, -1
  v_lshlrev_b32 v251, 4, v255
  s_mul_i32 s64, s70, 393216
  s_mul_i32 s65, s54, 49152
  s_add_u32 s64, s64, s65
  v_add_u32 v248, s64, v251
  s_mul_i32 s64, s71, 589824
  s_mul_i32 s65, s54, 73728
  s_add_u32 s64, s64, s65
  v_add_u32 v249, s64, v251
  s_add_u32 s64, s47, 0
  s_and_b32 s64, s64, 7
  s_mul_i32 s36, s64, 6144
  s_mul_i32 s16, s64, 9216
  s_add_u32 s64, s47, 1
  s_and_b32 s64, s64, 7
  s_mul_i32 s37, s64, 6144
  s_mul_i32 s17, s64, 9216
  s_add_u32 s64, s47, 2
  s_and_b32 s64, s64, 7
  s_mul_i32 s38, s64, 6144
  s_mul_i32 s18, s64, 9216
  s_add_u32 s64, s47, 3
  s_and_b32 s64, s64, 7
  s_mul_i32 s39, s64, 6144
  s_mul_i32 s19, s64, 9216
  s_add_u32 s64, s47, 4
  s_and_b32 s64, s64, 7
  s_mul_i32 s40, s64, 6144
  s_mul_i32 s20, s64, 9216
  s_add_u32 s64, s47, 5
  s_and_b32 s64, s64, 7
  s_mul_i32 s41, s64, 6144
  s_mul_i32 s21, s64, 9216
  s_add_u32 s64, s47, 6
  s_and_b32 s64, s64, 7
  s_mul_i32 s42, s64, 6144
  s_mul_i32 s22, s64, 9216
  s_add_u32 s64, s47, 7
  s_and_b32 s64, s64, 7
  s_mul_i32 s43, s64, 6144
  s_mul_i32 s23, s64, 9216
  s_mov_b32 s66, 27648
  s_mov_b32 s67, 36864
  s_cmp_eq_u32 s54, 1
  s_cselect_b32 s66, 46080, s66
  s_cselect_b32 s67, 55296, s67
  s_cmp_eq_u32 s54, 2
  s_cselect_b32 s66, 86016, s66
  s_cselect_b32 s67, 95232, s67
  s_cmp_eq_u32 s54, 3
  s_cselect_b32 s66, 104448, s66
  s_cselect_b32 s67, 113664, s67
  s_cmp_eq_u32 s54, 4
  s_cselect_b32 s66, 9216, s66
  s_cselect_b32 s67, 67584, s67
  s_cmp_eq_u32 s54, 5
  s_cselect_b32 s66, 18432, s66
  s_cselect_b32 s67, 76800, s67
  s_cmp_eq_u32 s54, 6
  s_cselect_b32 s66, 135168, s66
  s_cselect_b32 s67, 144384, s67
  s_cmp_eq_u32 s54, 7
  s_cselect_b32 s66, 153600, s66
  s_cselect_b32 s67, 0, s67
  s_mov_b32 s88, s66
  s_mov_b32 s89, s67
  v_add_u32 v250, s66, v251
  s_lshr_b32 s63, s2, 3
  s_and_b32 s63, s63, 7
  s_mul_i32 s63, s63, 0
  v_and_b32 v8, 3, v255
  v_lshlrev_b32 v8, 6, v8
  v_add_u32 v8, 162816, v8
  s_cmp_eq_u32 s54, 6
  s_cbranch_scc0 L_w7wait
  s_mov_b32 s65, 16777216
L_pollwp:
  ds_read_b32 v9, v8
  s_waitcnt lgkmcnt(0)
L_pollwp_t:
  v_cmp_gt_u32 vcc, 92, v9
  s_nop 1
  s_cbranch_vccz L_pollwp_ok
  s_sleep 4
  s_sub_u32 s65, s65, 1
  s_cmp_lg_u32 s65, 0
  s_cbranch_scc1 L_pollwp
L_pollwp_ok:
  s_lshl_b32 s67, s71, 9
  s_add_u32 s67, s67, 12845056
  s_mov_b64 exec, -1
  v_lshlrev_b32 v2, 3, v255
  v_add_u32 v2, s67, v2
  s_mov_b32 s65, 1048576
L_pollw:
  global_load_dwordx2 v[4:5], v2, s[50:51] sc1
  s_waitcnt vmcnt(0)
  v_cmp_ne_u32 vcc, s92, v4
  v_cmp_ne_u32 s[90:91], s93, v5
  s_nop 1
  s_or_b64 s[90:91], vcc, s[90:91]
  s_cbranch_scc0 L_pollw_ok
  s_sleep 32
  s_sub_u32 s65, s65, 1
  s_cmp_lg_u32 s65, 0
  s_cbranch_scc1 L_pollw
L_pollw_ok:
  s_mov_b64 exec, -1
  v_mov_b32 v2, 163328
  v_mov_b32 v3, 1
  ds_write_b32 v2, v3
  s_waitcnt lgkmcnt(0)
  s_branch L_wgo
L_w7wait:
  v_mov_b32 v2, 163328
  s_mov_b32 s65, 16777216
L_pollw7:
  ds_read_b32 v3, v2
  s_waitcnt lgkmcnt(0)
  v_cmp_eq_u32 vcc, 0, v3
  s_nop 1
  s_cbranch_vccz L_pollw7_ok
  s_sleep 16
  s_sub_u32 s65, s65, 1
  s_cmp_lg_u32 s65, 0
  s_cbranch_scc1 L_pollw7
L_pollw7_ok:
L_wgo:
  s_mov_b32 s65, 16777216
L_pcw0:
  ds_read_b32 v9, v8
  s_waitcnt lgkmcnt(0)
L_pcw0_t:
  v_cmp_gt_u32 vcc, 96, v9
  s_nop 1
  s_cbranch_vccz L_pcw0_ok
  s_sleep 4
  s_sub_u32 s65, s65, 1
  s_cmp_lg_u32 s65, 0
  s_cbranch_scc1 L_pcw0
L_pcw0_ok:
  s_add_u32 s59, s16, 0
  buffer_load_dwordx4 v[72:75], v249, s[32:35], s59 offen sc1
  s_add_u32 s59, s16, 1024
  buffer_load_dwordx4 v[76:79], v249, s[32:35], s59 offen sc1
  s_add_u32 s59, s16, 2048
  buffer_load_dwordx4 v[80:83], v249, s[32:35], s59 offen sc1
  s_add_u32 s59, s16, 3072
  buffer_load_dwordx4 v[84:87], v249, s[32:35], s59 offen sc1
  s_add_u32 s59, s16, 4096
  buffer_load_dwordx4 v[88:91], v249, s[32:35], s59 offen sc1
  s_add_u32 s59, s16, 5120
  buffer_load_dwordx4 v[92:95], v249, s[32:35], s59 offen sc1
  s_add_u32 s59, s16, 6144
  buffer_load_dwordx4 v[96:99], v249, s[32:35], s59 offen sc1
  s_add_u32 s59, s16, 7168
  buffer_load_dwordx4 v[100:103], v249, s[32:35], s59 offen sc1
  s_add_u32 s59, s16, 8192
  buffer_load_dwordx4 v[104:107], v249, s[32:35], s59 offen sc1
  s_mov_b32 s65, 16777216
L_pcw9:
  ds_read_b32 v9, v8
  s_waitcnt lgkmcnt(0)
L_pcw9_t:
  v_cmp_gt_u32 vcc, 100, v9
  s_nop 1
  s_cbranch_vccz L_pcw9_ok
  s_sleep 4
  s_sub_u32 s65, s65, 1
  s_cmp_lg_u32 s65, 0
  s_cbranch_scc1 L_pcw9
L_pcw9_ok:
  s_add_u32 s59, s17, 0
  buffer_load_dwordx4 v[108:111], v249, s[32:35], s59 offen sc1
  s_add_u32 s59, s17, 1024
  buffer_load_dwordx4 v[112:115], v249, s[32:35], s59 offen sc1
  s_add_u32 s59, s17, 2048
  buffer_load_dwordx4 v[116:119], v249, s[32:35], s59 offen sc1
  s_add_u32 s59, s17, 3072
  buffer_load_dwordx4 v[120:123], v249, s[32:35], s59 offen sc1
  s_add_u32 s59, s17, 4096
  buffer_load_dwordx4 v[124:127], v249, s[32:35], s59 offen sc1
  s_add_u32 s59, s17, 5120
  buffer_load_dwordx4 v[128:131], v249, s[32:35], s59 offen sc1
  s_add_u32 s59, s17, 6144
  buffer_load_dwordx4 v[132:135], v249, s[32:35], s59 offen sc1
  s_add_u32 s59, s17, 7168
  buffer_load_dwordx4 v[136:139], v249, s[32:35], s59 offen sc1
  s_add_u32 s59, s17, 8192
  buffer_load_dwordx4 v[140:143], v249, s[32:35], s59 offen sc1
  s_mov_b32 s65, 16777216
L_pcw18:
  ds_read_b32 v9, v8
  s_waitcnt lgkmcnt(0)
L_pcw18_t:
  v_cmp_gt_u32 vcc, 104, v9
  s_nop 1
  s_cbranch_vccz L_pcw18_ok
  s_sleep 4
  s_sub_u32 s65, s65, 1
  s_cmp_lg_u32 s65, 0
  s_cbranch_scc1 L_pcw18
L_pcw18_ok:
  s_add_u32 s59, s18, 0
  buffer_load_dwordx4 v[144:147], v249, s[32:35], s59 offen sc1
  s_add_u32 s59, s18, 1024
  buffer_load_dwordx4 v[148:151], v249, s[32:35], s59 offen sc1
  s_add_u32 s59, s18, 2048
  buffer_load_dwordx4 v[152:155], v249, s[32:35], s59 offen sc1
  s_add_u32 s59, s18, 3072
  buffer_load_dwordx4 v[156:159], v249, s[32:35], s59 offen sc1
  s_add_u32 s59, s18, 4096
  buffer_load_dwordx4 v[160:163], v249, s[32:35], s59 offen sc1
  s_add_u32 s59, s18, 5120
  buffer_load_dwordx4 v[164:167], v249, s[32:35], s59 offen sc1
  s_add_u32 s59, s18, 6144
  buffer_load_dwordx4 v[168:171], v249, s[32:35], s59 offen sc1
  s_add_u32 s59, s18, 7168
  buffer_load_dwordx4 v[172:175], v249, s[32:35], s59 offen sc1
  s_add_u32 s59, s18, 8192
  buffer_load_dwordx4 v[176:179], v249, s[32:35], s59 offen sc1
  s_mov_b32 s65, 16777216
L_pcw27:
  ds_read_b32 v9, v8
  s_waitcnt lgkmcnt(0)
L_pcw27_t:
  v_cmp_gt_u32 vcc, 108, v9
  s_nop 1
  s_cbranch_vccz L_pcw27_ok
  s_sleep 4
  s_sub_u32 s65, s65, 1
  s_cmp_lg_u32 s65, 0
  s_cbranch_scc1 L_pcw27
L_pcw27_ok:
  s_add_u32 s59, s19, 0
  buffer_load_dwordx4 v[180:183], v249, s[32:35], s59 offen sc1
  s_add_u32 s59, s19, 1024
  buffer_load_dwordx4 v[184:187], v249, s[32:35], s59 offen sc1
  s_add_u32 s59, s19, 2048
  buffer_load_dwordx4 v[188:191], v249, s[32:35], s59 offen sc1
  s_add_u32 s59, s19, 3072
  buffer_load_dwordx4 v[192:195], v249, s[32:35], s59 offen sc1
  s_add_u32 s59, s19, 4096
  buffer_load_dwordx4 v[196:199], v249, s[32:35], s59 offen sc1
  s_add_u32 s59, s19, 5120
  buffer_load_dwordx4 v[200:203], v249, s[32:35], s59 offen sc1
  s_add_u32 s59, s19, 6144
  buffer_load_dwordx4 v[204:207], v249, s[32:35], s59 offen sc1
  s_add_u32 s59, s19, 7168
  buffer_load_dwordx4 v[208:211], v249, s[32:35], s59 offen sc1
  s_add_u32 s59, s19, 8192
  buffer_load_dwordx4 v[212:215], v249, s[32:35], s59 offen sc1
  s_add_u32 m0, s88, 0
  s_add_u32 s59, s20, 0
  buffer_load_dwordx4 v249, s[32:35], s59 offen sc1 lds
  s_add_u32 m0, s88, 1024
  s_add_u32 s59, s20, 1024
  buffer_load_dwordx4 v249, s[32:35], s59 offen sc1 lds
  s_add_u32 m0, s88, 2048
  s_add_u32 s59, s20, 2048
  buffer_load_dwordx4 v249, s[32:35], s59 offen sc1 lds
  s_add_u32 m0, s88, 3072
  s_add_u32 s59, s20, 3072
  buffer_load_dwordx4 v249, s[32:35], s59 offen sc1 lds
  s_add_u32 m0, s88, 4096
  s_add_u32 s59, s20, 4096
  buffer_load_dwordx4 v249, s[32:35], s59 offen sc1 lds
  s_add_u32 m0, s88, 5120
  s_add_u32 s59, s20, 5120
  buffer_load_dwordx4 v249, s[32:35], s59 offen sc1 lds
  s_add_u32 m0, s88, 6144
  s_add_u32 s59, s20, 6144
  buffer_load_dwordx4 v249, s[32:35], s59 offen sc1 lds
  s_add_u32 m0, s88, 7168
  s_add_u32 s59, s20, 7168
  buffer_load_dwordx4 v249, s[32:35], s59 offen sc1 lds
  s_add_u32 m0, s88, 8192
  s_add_u32 s59, s20, 8192
  buffer_load_dwordx4 v249, s[32:35], s59 offen sc1 lds
  s_add_u32 m0, s89, 0
  s_add_u32 s59, s21, 0
  buffer_load_dwordx4 v249, s[32:35], s59 offen sc1 lds
  s_add_u32 m0, s89, 1024
  s_add_u32 s59, s21, 1024
  buffer_load_dwordx4 v249, s[32:35], s59 offen sc1 lds
  s_add_u32 m0, s89, 2048
  s_add_u32 s59, s21, 2048
  buffer_load_dwordx4 v249, s[32:35], s59 offen sc1 lds
  s_add_u32 m0, s89, 3072
  s_add_u32 s59, s21, 3072
  buffer_load_dwordx4 v249, s[32:35], s59 offen sc1 lds
  s_add_u32 m0, s89, 4096
  s_add_u32 s59, s21, 4096
  buffer_load_dwordx4 v249, s[32:35], s59 offen sc1 lds
  s_add_u32 m0, s89, 5120
  s_add_u32 s59, s21, 5120
  buffer_load_dwordx4 v249, s[32:35], s59 offen sc1 lds
  s_add_u32 m0, s89, 6144
  s_add_u32 s59, s21, 6144
  buffer_load_dwordx4 v249, s[32:35], s59 offen sc1 lds
  s_add_u32 m0, s89, 7168
  s_add_u32 s59, s21, 7168
  buffer_load_dwordx4 v249, s[32:35], s59 offen sc1 lds
  s_add_u32 m0, s89, 8192
  s_add_u32 s59, s21, 8192
  buffer_load_dwordx4 v249, s[32:35], s59 offen sc1 lds
  s_cmp_eq_u32 s54, 6
  s_cbranch_scc0 L_cl7
  v_lshlrev_b32 v14, 4, v255
  s_mul_i32 s66, s71, 589824
  v_add_u32 v14, s66, v14
  s_mov_b32 s65, 16777216
L_cla20:
  ds_read_b32 v9, v8
  s_waitcnt lgkmcnt(0)
L_cla20_t:
  v_cmp_gt_u32 vcc, 116, v9
  s_nop 1
  s_cbranch_vccz L_cla20_ok
  s_sleep 4
  s_sub_u32 s65, s65, 1
  s_cmp_lg_u32 s65, 0
  s_cbranch_scc1 L_cla20
L_cla20_ok:
  s_mov_b32 m0, 86016
  s_mov_b32 s59, 184320
  buffer_load_dwordx4 v14, s[32:35], s59 offen sc1 lds
  s_mov_b32 m0, 87040
  s_mov_b32 s59, 185344
  buffer_load_dwordx4 v14, s[32:35], s59 offen sc1 lds
  s_mov_b32 m0, 88064
  s_mov_b32 s59, 186368
  buffer_load_dwordx4 v14, s[32:35], s59 offen sc1 lds
  s_mov_b32 m0, 89088
  s_mov_b32 s59, 187392
  buffer_load_dwordx4 v14, s[32:35], s59 offen sc1 lds
  s_mov_b32 m0, 90112
  s_mov_b32 s59, 188416
  buffer_load_dwordx4 v14, s[32:35], s59 offen sc1 lds
  s_mov_b32 m0, 91136
  s_mov_b32 s59, 189440
  buffer_load_dwordx4 v14, s[32:35], s59 offen sc1 lds
  s_mov_b32 m0, 92160
  s_mov_b32 s59, 190464
  s_waitcnt vmcnt(40)
  buffer_load_dwordx4 v14, s[32:35], s59 offen sc1 lds
  s_mov_b32 m0, 93184
  s_mov_b32 s59, 191488
  buffer_load_dwordx4 v14, s[32:35], s59 offen sc1 lds
  s_mov_b32 m0, 94208
  s_mov_b32 s59, 192512
  buffer_load_dwordx4 v14, s[32:35], s59 offen sc1 lds
  s_mov_b32 s65, 16777216
L_cla21:
  ds_read_b32 v9, v8
  s_waitcnt lgkmcnt(0)
L_cla21_t:
  v_cmp_gt_u32 vcc, 120, v9
  s_nop 1
  s_cbranch_vccz L_cla21_ok
  s_sleep 4
  s_sub_u32 s65, s65, 1
  s_cmp_lg_u32 s65, 0
  s_cbranch_scc1 L_cla21
L_cla21_ok:
  s_mov_b32 m0, 95232
  s_mov_b32 s59, 193536
  buffer_load_dwordx4 v14, s[32:35], s59 offen sc1 lds
  s_mov_b32 m0, 96256
  s_mov_b32 s59, 194560
  buffer_load_dwordx4 v14, s[32:35], s59 offen sc1 lds
  s_mov_b32 m0, 97280
  s_mov_b32 s59, 195584
  buffer_load_dwordx4 v14, s[32:35], s59 offen sc1 lds
  s_mov_b32 m0, 98304
  s_mov_b32 s59, 196608
  buffer_load_dwordx4 v14, s[32:35], s59 offen sc1 lds
  s_mov_b32 m0, 99328
  s_mov_b32 s59, 197632
  buffer_load_dwordx4 v14, s[32:35], s59 offen sc1 lds
  s_mov_b32 m0, 100352
  s_mov_b32 s59, 198656
  buffer_load_dwordx4 v14, s[32:35], s59 offen sc1 lds
  s_mov_b32 m0, 101376
  s_mov_b32 s59, 199680
  buffer_load_dwordx4 v14, s[32:35], s59 offen sc1 lds
  s_mov_b32 m0, 102400
  s_mov_b32 s59, 200704
  buffer_load_dwordx4 v14, s[32:35], s59 offen sc1 lds
  s_mov_b32 m0, 103424
  s_mov_b32 s59, 201728
  buffer_load_dwordx4 v14, s[32:35], s59 offen sc1 lds
  s_mov_b32 s65, 16777216
L_cla11:
  ds_read_b32 v9, v8
  s_waitcnt lgkmcnt(0)
L_cla11_t:
  v_cmp_gt_u32 vcc, 128, v9
  s_nop 1
  s_cbranch_vccz L_cla11_ok
  s_sleep 4
  s_sub_u32 s65, s65, 1
  s_cmp_lg_u32 s65, 0
  s_cbranch_scc1 L_cla11
L_cla11_ok:
  s_mov_b32 m0, 55296
  s_mov_b32 s59, 119808
  buffer_load_dwordx4 v14, s[32:35], s59 offen sc1 lds
  s_mov_b32 m0, 56320
  s_mov_b32 s59, 120832
  buffer_load_dwordx4 v14, s[32:35], s59 offen sc1 lds
  s_mov_b32 m0, 57344
  s_mov_b32 s59, 121856
  buffer_load_dwordx4 v14, s[32:35], s59 offen sc1 lds
  s_mov_b32 m0, 58368
  s_mov_b32 s59, 122880
  buffer_load_dwordx4 v14, s[32:35], s59 offen sc1 lds
  s_mov_b32 m0, 59392
  s_mov_b32 s59, 123904
  buffer_load_dwordx4 v14, s[32:35], s59 offen sc1 lds
  s_mov_b32 m0, 60416
  s_mov_b32 s59, 124928
  buffer_load_dwordx4 v14, s[32:35], s59 offen sc1 lds
  s_mov_b32 m0, 61440
  s_mov_b32 s59, 125952
  buffer_load_dwordx4 v14, s[32:35], s59 offen sc1 lds
  s_mov_b32 m0, 62464
  s_mov_b32 s59, 126976
  buffer_load_dwordx4 v14, s[32:35], s59 offen sc1 lds
  s_mov_b32 m0, 63488
  s_mov_b32 s59, 128000
  s_waitcnt vmcnt(40)
  buffer_load_dwordx4 v14, s[32:35], s59 offen sc1 lds
  s_waitcnt vmcnt(0)
  v_mov_b32 v2, 163336
  v_mov_b32 v3, 1
  s_mov_b64 exec, 1
  ds_add_u32 v2, v3
  s_mov_b64 exec, -1
  s_waitcnt lgkmcnt(0)
  s_branch L_cldone
L_cl7:
  v_lshlrev_b32 v14, 4, v255
  s_mul_i32 s66, s71, 589824
  v_add_u32 v14, s66, v14
  s_mov_b32 s65, 16777216
L_clb30:
  ds_read_b32 v9, v8
  s_waitcnt lgkmcnt(0)
L_clb30_t:
  v_cmp_gt_u32 vcc, 124, v9
  s_nop 1
  s_cbranch_vccz L_clb30_ok
  s_sleep 4
  s_sub_u32 s65, s65, 1
  s_cmp_lg_u32 s65, 0
  s_cbranch_scc1 L_clb30
L_clb30_ok:
  s_mov_b32 m0, 104448
  s_mov_b32 s59, 258048
  buffer_load_dwordx4 v14, s[32:35], s59 offen sc1 lds
  s_mov_b32 m0, 105472
  s_mov_b32 s59, 259072
  buffer_load_dwordx4 v14, s[32:35], s59 offen sc1 lds
  s_mov_b32 m0, 106496
  s_mov_b32 s59, 260096
  buffer_load_dwordx4 v14, s[32:35], s59 offen sc1 lds
  s_mov_b32 m0, 107520
  s_mov_b32 s59, 261120
  buffer_load_dwordx4 v14, s[32:35], s59 offen sc1 lds
  s_mov_b32 m0, 108544
  s_mov_b32 s59, 262144
  buffer_load_dwordx4 v14, s[32:35], s59 offen sc1 lds
  s_mov_b32 m0, 109568
  s_mov_b32 s59, 263168
  buffer_load_dwordx4 v14, s[32:35], s59 offen sc1 lds
  s_mov_b32 m0, 110592
  s_mov_b32 s59, 264192
  s_waitcnt vmcnt(40)
  buffer_load_dwordx4 v14, s[32:35], s59 offen sc1 lds
  s_mov_b32 m0, 111616
  s_mov_b32 s59, 265216
  buffer_load_dwordx4 v14, s[32:35], s59 offen sc1 lds
  s_mov_b32 m0, 112640
  s_mov_b32 s59, 266240
  buffer_load_dwordx4 v14, s[32:35], s59 offen sc1 lds
  s_mov_b32 s65, 16777216
L_clb31:
  ds_read_b32 v9, v8
  s_waitcnt lgkmcnt(0)
L_clb31_t:
  v_cmp_gt_u32 vcc, 128, v9
  s_nop 1
  s_cbranch_vccz L_clb31_ok
  s_sleep 4
  s_sub_u32 s65, s65, 1
  s_cmp_lg_u32 s65, 0
  s_cbranch_scc1 L_clb31
L_clb31_ok:
  s_mov_b32 m0, 113664
  s_mov_b32 s59, 267264
  buffer_load_dwordx4 v14, s[32:35], s59 offen sc1 lds
  s_mov_b32 m0, 114688
  s_mov_b32 s59, 268288
  buffer_load_dwordx4 v14, s[32:35], s59 offen sc1 lds
  s_mov_b32 m0, 115712
  s_mov_b32 s59, 269312
  buffer_load_dwordx4 v14, s[32:35], s59 offen sc1 lds
  s_mov_b32 m0, 116736
  s_mov_b32 s59, 270336
  buffer_load_dwordx4 v14, s[32:35], s59 offen sc1 lds
  s_mov_b32 m0, 117760
  s_mov_b32 s59, 271360
  buffer_load_dwordx4 v14, s[32:35], s59 offen sc1 lds
  s_mov_b32 m0, 118784
  s_mov_b32 s59, 272384
  buffer_load_dwordx4 v14, s[32:35], s59 offen sc1 lds
  s_mov_b32 m0, 119808
  s_mov_b32 s59, 273408
  buffer_load_dwordx4 v14, s[32:35], s59 offen sc1 lds
  s_mov_b32 m0, 120832
  s_mov_b32 s59, 274432
  buffer_load_dwordx4 v14, s[32:35], s59 offen sc1 lds
  s_mov_b32 m0, 121856
  s_mov_b32 s59, 275456
  buffer_load_dwordx4 v14, s[32:35], s59 offen sc1 lds
  s_waitcnt vmcnt(0)
  v_mov_b32 v2, 163336
  v_mov_b32 v3, 1
  s_mov_b64 exec, 1
  ds_add_u32 v2, v3
  s_mov_b64 exec, -1
  s_waitcnt lgkmcnt(0)
L_cldone:
  s_branch L_tail
L_nothw:
  s_waitcnt lgkmcnt(0)
  s_mul_i32 s64, s52, 110592
  s_add_u32 s36, s36, s64
  s_addc_u32 s37, s37, 0
  s_mov_b32 s16, s36
  s_and_b32 s17, s37, 0xffff
  s_mov_b32 s18, 110592
  s_mov_b32 s19, 0x20000
  s_lshl_b32 s64, s53, 9
  s_add_u32 s42, s42, s64
  s_addc_u32 s43, s43, 0
  s_mov_b32 s20, s42
  s_and_b32 s21, s43, 0xffff
  s_mov_b32 s22, 0
  s_mov_b32 s23, 0x20000
  s_sub_u32 s22, 4718592, s64
  s_lshl_b32 s64, s52, 4
  s_add_u32 s64, s64, s53
  s_lshl_b32 s64, s64, 18
  s_add_u32 s38, s38, s64
  s_addc_u32 s39, s39, 0
  s_add_u32 s40, s40, s64
  s_addc_u32 s41, s41, 0
  s_mov_b32 s8, s38
  s_and_b32 s9, s39, 0xffff
  s_mov_b32 s10, 262144
  s_mov_b32 s11, 0x20000
  s_mov_b32 s12, s40
  s_and_b32 s13, s41, 0xffff
  s_mov_b32 s14, 262144
  s_mov_b32 s15, 0x20000
  s_mov_b32 s24, s44
  s_and_b32 s25, s45, 0xffff
  s_mov_b32 s26, 4718592
  s_mov_b32 s27, 0x20000
  s_mov_b32 s4, s46
  s_and_b32 s5, s47, 0xffff
  s_mov_b32 s6, 1769472
  s_mov_b32 s7, 0x20000
  s_mov_b32 s47, s62
  s_mov_b32 s28, s50
  s_and_b32 s29, s51, 0xffff
  s_mov_b32 s30, 12582912
  s_mov_b32 s31, 0x20000
  s_add_u32 s50, s50, 12582912
  s_addc_u32 s51, s51, 0
  s_mov_b32 s32, s50
  s_and_b32 s33, s51, 0xffff
  s_mov_b32 s34, 4718592
  s_mov_b32 s35, 0x20000
  s_cmp_eq_u32 s54, 5
  s_cbranch_scc1 L_h5
  s_cmp_eq_u32 s54, 4
  s_cbranch_scc1 L_hk
L_c:
  v_lshrrev_b32 v1, 4, v0
  v_and_b32 v2, 15, v0
  v_bfe_u32 v3, v0, 2, 2
  v_and_b32 v4, 3, v0
  s_lshr_b32 s55, s54, 1
  s_and_b32 s56, s54, 1
  v_and_b32 v5, 7, v2
  v_mul_u32_u24 v5, 1056, v5
  v_lshrrev_b32 v6, 3, v2
  v_lshlrev_b32 v6, 8, v6
  v_lshlrev_b32 v7, 4, v1
  v_add3_u32 v236, v5, v6, v7
  v_add_u32 v237, 8448, v236
  v_and_b32 v5, 1, v1
  v_lshl_add_u32 v5, v5, 2, v3
  v_mul_u32_u24 v5, 1056, v5
  v_lshrrev_b32 v6, 1, v1
  v_lshlrev_b32 v7, 8, v6
  v_lshlrev_b32 v8, 3, v4
  v_add3_u32 v242, v5, v7, v8
  v_add_u32 v242, 67584, v242
  v_lshlrev_b32 v7, 9, v6
  v_add3_u32 v244, v5, v7, v8
  s_mul_i32 s57, s55, 8448
  s_add_u32 s57, s57, 33792
  v_add_u32 v244, s57, v244
  v_add_u32 v245, 59136, v244
  v_lshrrev_b32 v5, 1, v2
  v_xor_b32 v5, v5, v1
  v_lshlrev_b32 v5, 4, v5
  v_lshl_add_u32 v5, v2, 7, v5
  s_mul_i32 s57, s56, 6144
  s_add_u32 s57, s57, 126720
  v_add_u32 v246, s57, v5
  v_xor_b32 v247, 64, v246
  v_mov_b32 v248, 0x3e0293ee
  v_mov_b32 v249, 0x3e0293ee
  v_mov_b32 v216, 0x3f803f80
  v_mov_b32 v217, 0x3f803f80
  v_mov_b32 v218, 0x3f803f80
  v_mov_b32 v219, 0x3f803f80
  s_mov_b32 s60, 0
  v_and_b32 v252, 15, v0
  v_lshlrev_b32 v252, 2, v252
  s_lshl_b32 s57, s54, 6
  s_add_u32 s57, s57, 162816
  v_add_u32 v252, s57, v252
  v_mov_b32 v253, 1
  v_mov_b32 v0, 0
  v_mov_b32 v1, 0
  v_mov_b32 v2, 0
  v_mov_b32 v3, 0
  v_mov_b32 v4, 0
  v_mov_b32 v5, 0
  v_mov_b32 v6, 0
  v_mov_b32 v7, 0
  v_mov_b32 v8, 0
  v_mov_b32 v9, 0
  v_mov_b32 v10, 0
  v_mov_b32 v11, 0
  v_mov_b32 v12, 0
  v_mov_b32 v13, 0
  v_mov_b32 v14, 0
  v_mov_b32 v15, 0
  v_mov_b32 v16, 0
  v_mov_b32 v17, 0
  v_mov_b32 v18, 0
  v_mov_b32 v19, 0
  v_mov_b32 v20, 0
  v_mov_b32 v21, 0
  v_mov_b32 v22, 0
  v_mov_b32 v23, 0
  v_mov_b32 v24, 0
  v_mov_b32 v25, 0
  v_mov_b32 v26, 0
  v_mov_b32 v27, 0
  v_mov_b32 v28, 0
  v_mov_b32 v29, 0
  v_mov_b32 v30, 0
  v_mov_b32 v31, 0
  v_mov_b32 v32, 0
  v_mov_b32 v33, 0
  v_mov_b32 v34, 0
  v_mov_b32 v35, 0
  v_mov_b32 v36, 0
  v_mov_b32 v37, 0
  v_mov_b32 v38, 0
  v_mov_b32 v39, 0
  v_mov_b32 v40, 0
  v_mov_b32 v41, 0
  v_mov_b32 v42, 0
  v_mov_b32 v43, 0
  v_mov_b32 v44, 0
  v_mov_b32 v45, 0
  v_mov_b32 v46, 0
  v_mov_b32 v47, 0
  v_mov_b32 v48, 0
  v_mov_b32 v49, 0
  v_mov_b32 v50, 0
  v_mov_b32 v51, 0
  v_mov_b32 v52, 0
  v_mov_b32 v53, 0
  v_mov_b32 v54, 0
  v_mov_b32 v55, 0
  v_mov_b32 v56, 0
  v_mov_b32 v57, 0
  v_mov_b32 v58, 0
  v_mov_b32 v59, 0
  v_mov_b32 v60, 0
  v_mov_b32 v61, 0
  v_mov_b32 v62, 0
  v_mov_b32 v63, 0
  v_mov_b32 v64, 0
  v_mov_b32 v65, 0
  v_mov_b32 v66, 0
  v_mov_b32 v67, 0
  v_mov_b32 v68, 0
  v_mov_b32 v69, 0
  v_mov_b32 v70, 0
  v_mov_b32 v71, 0
  v_mov_b32 v72, 0
  v_mov_b32 v73, 0
  v_mov_b32 v74, 0
  v_mov_b32 v75, 0
  v_mov_b32 v76, 0
  v_mov_b32 v77, 0
  v_mov_b32 v78, 0
  v_mov_b32 v79, 0
  v_mov_b32 v80, 0
  v_mov_b32 v81, 0
  v_mov_b32 v82, 0
  v_mov_b32 v83, 0
  v_mov_b32 v84, 0
  v_mov_b32 v85, 0
  v_mov_b32 v86, 0
  v_mov_b32 v87, 0
  v_mov_b32 v88, 0
  v_mov_b32 v89, 0
  v_mov_b32 v90, 0
  v_mov_b32 v91, 0
  v_mov_b32 v92, 0
  v_mov_b32 v93, 0
  v_mov_b32 v94, 0
  v_mov_b32 v95, 0
  s_barrier
  ds_read_b128 v[128:131], v246 offset:0
  ds_read_b128 v[132:135], v246 offset:2048
  ds_read_b128 v[136:139], v246 offset:4096
  ds_read_b128 v[172:175], v247 offset:0
  ds_read_b128 v[176:179], v247 offset:2048
  ds_read_b128 v[180:183], v247 offset:4096
  ds_read_b64_tr_b16 v[96:97], v244 offset:0
  ds_read_b64_tr_b16 v[98:99], v244 offset:256
  ds_read_b64_tr_b16 v[100:101], v244 offset:32
  ds_read_b64_tr_b16 v[102:103], v244 offset:288
  ds_read_b64_tr_b16 v[104:105], v244 offset:64
  ds_read_b64_tr_b16 v[106:107], v244 offset:320
  ds_read_b64_tr_b16 v[108:109], v244 offset:96
  ds_read_b64_tr_b16 v[110:111], v244 offset:352
  ds_read_b64_tr_b16 v[112:113], v244 offset:128
  ds_read_b64_tr_b16 v[114:115], v244 offset:384
  ds_read_b64_tr_b16 v[116:117], v244 offset:160
  ds_read_b64_tr_b16 v[118:119], v244 offset:416
  ds_read_b64_tr_b16 v[120:121], v244 offset:192
  ds_read_b64_tr_b16 v[122:123], v244 offset:448
  ds_read_b64_tr_b16 v[124:125], v244 offset:224
  ds_read_b64_tr_b16 v[126:127], v244 offset:480
  s_waitcnt lgkmcnt(0)
  s_barrier
  v_mfma_f32_16x16x32_bf16 v[0:3], v[96:99], v[128:131], v[0:3]
  ds_read_b64_tr_b16 v[140:141], v244 offset:16896
  v_mfma_f32_16x16x32_bf16 v[4:7], v[96:99], v[132:135], v[4:7]
  v_mfma_f32_16x16x32_bf16 v[8:11], v[96:99], v[136:139], v[8:11]
  ds_read_b64_tr_b16 v[142:143], v244 offset:17152
  v_mfma_f32_16x16x32_bf16 v[12:15], v[100:103], v[128:131], v[12:15]
  ds_read_b64_tr_b16 v[144:145], v244 offset:16928
  v_mfma_f32_16x16x32_bf16 v[16:19], v[100:103], v[132:135], v[16:19]
  v_mfma_f32_16x16x32_bf16 v[20:23], v[100:103], v[136:139], v[20:23]
  ds_read_b64_tr_b16 v[146:147], v244 offset:17184
  v_mfma_f32_16x16x32_bf16 v[24:27], v[104:107], v[128:131], v[24:27]
  ds_read_b64_tr_b16 v[148:149], v244 offset:16960
  v_mfma_f32_16x16x32_bf16 v[28:31], v[104:107], v[132:135], v[28:31]
  v_mfma_f32_16x16x32_bf16 v[32:35], v[104:107], v[136:139], v[32:35]
  ds_read_b64_tr_b16 v[150:151], v244 offset:17216
  v_mfma_f32_16x16x32_bf16 v[36:39], v[108:111], v[128:131], v[36:39]
  ds_read_b64_tr_b16 v[152:153], v244 offset:16992
  v_mfma_f32_16x16x32_bf16 v[40:43], v[108:111], v[132:135], v[40:43]
  v_mfma_f32_16x16x32_bf16 v[44:47], v[108:111], v[136:139], v[44:47]
  ds_read_b64_tr_b16 v[154:155], v244 offset:17248
  v_mfma_f32_16x16x32_bf16 v[48:51], v[112:115], v[128:131], v[48:51]
  ds_read_b64_tr_b16 v[156:157], v244 offset:17024
  v_mfma_f32_16x16x32_bf16 v[52:55], v[112:115], v[132:135], v[52:55]
  v_mfma_f32_16x16x32_bf16 v[56:59], v[112:115], v[136:139], v[56:59]
  ds_read_b64_tr_b16 v[158:159], v244 offset:17280
  v_mfma_f32_16x16x32_bf16 v[60:63], v[116:119], v[128:131], v[60:63]
  ds_read_b64_tr_b16 v[160:161], v244 offset:17056
  v_mfma_f32_16x16x32_bf16 v[64:67], v[116:119], v[132:135], v[64:67]
  v_mfma_f32_16x16x32_bf16 v[68:71], v[116:119], v[136:139], v[68:71]
  ds_read_b64_tr_b16 v[162:163], v244 offset:17312
  v_mfma_f32_16x16x32_bf16 v[72:75], v[120:123], v[128:131], v[72:75]
  ds_read_b64_tr_b16 v[164:165], v244 offset:17088
  v_mfma_f32_16x16x32_bf16 v[76:79], v[120:123], v[132:135], v[76:79]
  v_mfma_f32_16x16x32_bf16 v[80:83], v[120:123], v[136:139], v[80:83]
  ds_read_b64_tr_b16 v[166:167], v244 offset:17344
  v_mfma_f32_16x16x32_bf16 v[84:87], v[124:127], v[128:131], v[84:87]
  ds_read_b64_tr_b16 v[168:169], v244 offset:17120
  v_mfma_f32_16x16x32_bf16 v[88:91], v[124:127], v[132:135], v[88:91]
  v_mfma_f32_16x16x32_bf16 v[92:95], v[124:127], v[136:139], v[92:95]
  ds_read_b64_tr_b16 v[170:171], v244 offset:17376
  s_waitcnt lgkmcnt(0)
  s_barrier
  v_mfma_f32_16x16x32_bf16 v[0:3], v[140:143], v[172:175], v[0:3]
  ds_read_b128 v[184:187], v246 offset:12288
  v_mfma_f32_16x16x32_bf16 v[4:7], v[140:143], v[176:179], v[4:7]
  ds_read_b128 v[188:191], v246 offset:14336
  v_mfma_f32_16x16x32_bf16 v[8:11], v[140:143], v[180:183], v[8:11]
  ds_read_b128 v[192:195], v246 offset:16384
  v_mfma_f32_16x16x32_bf16 v[12:15], v[144:147], v[172:175], v[12:15]
  ds_read_b128 v[196:199], v247 offset:12288
  v_mfma_f32_16x16x32_bf16 v[16:19], v[144:147], v[176:179], v[16:19]
  ds_read_b128 v[200:203], v247 offset:14336
  v_mfma_f32_16x16x32_bf16 v[20:23], v[144:147], v[180:183], v[20:23]
  ds_read_b128 v[204:207], v247 offset:16384
  v_mfma_f32_16x16x32_bf16 v[24:27], v[148:151], v[172:175], v[24:27]
  v_mfma_f32_16x16x32_bf16 v[28:31], v[148:151], v[176:179], v[28:31]
  ds_read_b64_tr_b16 v[96:97], v245 offset:0
  v_mfma_f32_16x16x32_bf16 v[32:35], v[148:151], v[180:183], v[32:35]
  ds_read_b64_tr_b16 v[98:99], v245 offset:256
  v_mfma_f32_16x16x32_bf16 v[36:39], v[152:155], v[172:175], v[36:39]
  ds_read_b64_tr_b16 v[100:101], v245 offset:32
  v_mfma_f32_16x16x32_bf16 v[40:43], v[152:155], v[176:179], v[40:43]
  ds_read_b64_tr_b16 v[102:103], v245 offset:288
  v_mfma_f32_16x16x32_bf16 v[44:47], v[152:155], v[180:183], v[44:47]
  ds_read_b64_tr_b16 v[104:105], v245 offset:64
  v_mfma_f32_16x16x32_bf16 v[48:51], v[156:159], v[172:175], v[48:51]
  ds_read_b64_tr_b16 v[106:107], v245 offset:320
  v_mfma_f32_16x16x32_bf16 v[52:55], v[156:159], v[176:179], v[52:55]
  ds_read_b64_tr_b16 v[108:109], v245 offset:96
  v_mfma_f32_16x16x32_bf16 v[56:59], v[156:159], v[180:183], v[56:59]
  ds_read_b64_tr_b16 v[110:111], v245 offset:352
  v_mfma_f32_16x16x32_bf16 v[60:63], v[160:163], v[172:175], v[60:63]
  ds_read_b64_tr_b16 v[112:113], v245 offset:128
  v_mfma_f32_16x16x32_bf16 v[64:67], v[160:163], v[176:179], v[64:67]
  ds_read_b64_tr_b16 v[114:115], v245 offset:384
  v_mfma_f32_16x16x32_bf16 v[68:71], v[160:163], v[180:183], v[68:71]
  ds_read_b64_tr_b16 v[116:117], v245 offset:160
  v_mfma_f32_16x16x32_bf16 v[72:75], v[164:167], v[172:175], v[72:75]
  v_mfma_f32_16x16x32_bf16 v[76:79], v[164:167], v[176:179], v[76:79]
  ds_read_b64_tr_b16 v[118:119], v245 offset:416
  v_mfma_f32_16x16x32_bf16 v[80:83], v[164:167], v[180:183], v[80:83]
  ds_read_b64_tr_b16 v[120:121], v245 offset:192
  v_mfma_f32_16x16x32_bf16 v[84:87], v[168:171], v[172:175], v[84:87]
  ds_read_b64_tr_b16 v[122:123], v245 offset:448
  v_mfma_f32_16x16x32_bf16 v[88:91], v[168:171], v[176:179], v[88:91]
  ds_read_b64_tr_b16 v[124:125], v245 offset:224
  v_mfma_f32_16x16x32_bf16 v[92:95], v[168:171], v[180:183], v[92:95]
  ds_read_b64_tr_b16 v[126:127], v245 offset:480
  s_waitcnt lgkmcnt(0)
  s_barrier
  v_mfma_f32_16x16x32_bf16 v[0:3], v[96:99], v[184:187], v[0:3]
  ds_read_b64_tr_b16 v[140:141], v245 offset:16896
  v_mfma_f32_16x16x32_bf16 v[4:7], v[96:99], v[188:191], v[4:7]
  v_mfma_f32_16x16x32_bf16 v[8:11], v[96:99], v[192:195], v[8:11]
  ds_read_b64_tr_b16 v[142:143], v245 offset:17152
  v_mfma_f32_16x16x32_bf16 v[12:15], v[100:103], v[184:187], v[12:15]
  ds_read_b64_tr_b16 v[144:145], v245 offset:16928
  v_mfma_f32_16x16x32_bf16 v[16:19], v[100:103], v[188:191], v[16:19]
  v_mfma_f32_16x16x32_bf16 v[20:23], v[100:103], v[192:195], v[20:23]
  ds_read_b64_tr_b16 v[146:147], v245 offset:17184
  v_mfma_f32_16x16x32_bf16 v[24:27], v[104:107], v[184:187], v[24:27]
  ds_read_b64_tr_b16 v[148:149], v245 offset:16960
  v_mfma_f32_16x16x32_bf16 v[28:31], v[104:107], v[188:191], v[28:31]
  v_mfma_f32_16x16x32_bf16 v[32:35], v[104:107], v[192:195], v[32:35]
  ds_read_b64_tr_b16 v[150:151], v245 offset:17216
  v_mfma_f32_16x16x32_bf16 v[36:39], v[108:111], v[184:187], v[36:39]
  ds_read_b64_tr_b16 v[152:153], v245 offset:16992
  v_mfma_f32_16x16x32_bf16 v[40:43], v[108:111], v[188:191], v[40:43]
  v_mfma_f32_16x16x32_bf16 v[44:47], v[108:111], v[192:195], v[44:47]
  ds_read_b64_tr_b16 v[154:155], v245 offset:17248
  v_mfma_f32_16x16x32_bf16 v[48:51], v[112:115], v[184:187], v[48:51]
  ds_read_b64_tr_b16 v[156:157], v245 offset:17024
  v_mfma_f32_16x16x32_bf16 v[52:55], v[112:115], v[188:191], v[52:55]
  v_mfma_f32_16x16x32_bf16 v[56:59], v[112:115], v[192:195], v[56:59]
  ds_read_b64_tr_b16 v[158:159], v245 offset:17280
  v_mfma_f32_16x16x32_bf16 v[60:63], v[116:119], v[184:187], v[60:63]
  ds_read_b64_tr_b16 v[160:161], v245 offset:17056
  v_mfma_f32_16x16x32_bf16 v[64:67], v[116:119], v[188:191], v[64:67]
  v_mfma_f32_16x16x32_bf16 v[68:71], v[116:119], v[192:195], v[68:71]
  ds_read_b64_tr_b16 v[162:163], v245 offset:17312
  v_mfma_f32_16x16x32_bf16 v[72:75], v[120:123], v[184:187], v[72:75]
  ds_read_b64_tr_b16 v[164:165], v245 offset:17088
  v_mfma_f32_16x16x32_bf16 v[76:79], v[120:123], v[188:191], v[76:79]
  v_mfma_f32_16x16x32_bf16 v[80:83], v[120:123], v[192:195], v[80:83]
  ds_read_b64_tr_b16 v[166:167], v245 offset:17344
  v_mfma_f32_16x16x32_bf16 v[84:87], v[124:127], v[184:187], v[84:87]
  ds_read_b64_tr_b16 v[168:169], v245 offset:17120
  v_mfma_f32_16x16x32_bf16 v[88:91], v[124:127], v[188:191], v[88:91]
  v_mfma_f32_16x16x32_bf16 v[92:95], v[124:127], v[192:195], v[92:95]
  ds_read_b64_tr_b16 v[170:171], v245 offset:17376
  s_waitcnt lgkmcnt(0)
  s_barrier
  v_mfma_f32_16x16x32_bf16 v[0:3], v[140:143], v[196:199], v[0:3]
  ds_read_b128 v[128:131], v246 offset:0
  v_mfma_f32_16x16x32_bf16 v[4:7], v[140:143], v[200:203], v[4:7]
  ds_read_b128 v[132:135], v246 offset:2048
  v_mfma_f32_16x16x32_bf16 v[8:11], v[140:143], v[204:207], v[8:11]
  ds_read_b128 v[136:139], v246 offset:4096
  v_mfma_f32_16x16x32_bf16 v[12:15], v[144:147], v[196:199], v[12:15]
  ds_read_b128 v[172:175], v247 offset:0
  v_mfma_f32_16x16x32_bf16 v[16:19], v[144:147], v[200:203], v[16:19]
  ds_read_b128 v[176:179], v247 offset:2048
  v_mfma_f32_16x16x32_bf16 v[20:23], v[144:147], v[204:207], v[20:23]
  ds_read_b128 v[180:183], v247 offset:4096
  v_mfma_f32_16x16x32_bf16 v[24:27], v[148:151], v[196:199], v[24:27]
  v_mfma_f32_16x16x32_bf16 v[28:31], v[148:151], v[200:203], v[28:31]
  ds_read_b64_tr_b16 v[96:97], v244 offset:0
  v_mfma_f32_16x16x32_bf16 v[32:35], v[148:151], v[204:207], v[32:35]
  ds_read_b64_tr_b16 v[98:99], v244 offset:256
  v_mfma_f32_16x16x32_bf16 v[36:39], v[152:155], v[196:199], v[36:39]
  ds_read_b64_tr_b16 v[100:101], v244 offset:32
  v_mfma_f32_16x16x32_bf16 v[40:43], v[152:155], v[200:203], v[40:43]
  ds_read_b64_tr_b16 v[102:103], v244 offset:288
  v_mfma_f32_16x16x32_bf16 v[44:47], v[152:155], v[204:207], v[44:47]
  ds_read_b64_tr_b16 v[104:105], v244 offset:64
  v_mfma_f32_16x16x32_bf16 v[48:51], v[156:159], v[196:199], v[48:51]
  ds_read_b64_tr_b16 v[106:107], v244 offset:320
  v_mfma_f32_16x16x32_bf16 v[52:55], v[156:159], v[200:203], v[52:55]
  ds_read_b64_tr_b16 v[108:109], v244 offset:96
  v_mfma_f32_16x16x32_bf16 v[56:59], v[156:159], v[204:207], v[56:59]
  ds_read_b64_tr_b16 v[110:111], v244 offset:352
  v_mfma_f32_16x16x32_bf16 v[60:63], v[160:163], v[196:199], v[60:63]
  ds_read_b64_tr_b16 v[112:113], v244 offset:128
  v_mfma_f32_16x16x32_bf16 v[64:67], v[160:163], v[200:203], v[64:67]
  ds_read_b64_tr_b16 v[114:115], v244 offset:384
  v_mfma_f32_16x16x32_bf16 v[68:71], v[160:163], v[204:207], v[68:71]
  ds_read_b64_tr_b16 v[116:117], v244 offset:160
  v_mfma_f32_16x16x32_bf16 v[72:75], v[164:167], v[196:199], v[72:75]
  v_mfma_f32_16x16x32_bf16 v[76:79], v[164:167], v[200:203], v[76:79]
  ds_read_b64_tr_b16 v[118:119], v244 offset:416
  v_mfma_f32_16x16x32_bf16 v[80:83], v[164:167], v[204:207], v[80:83]
  ds_read_b64_tr_b16 v[120:121], v244 offset:192
  v_mfma_f32_16x16x32_bf16 v[84:87], v[168:171], v[196:199], v[84:87]
  ds_read_b64_tr_b16 v[122:123], v244 offset:448
  v_mfma_f32_16x16x32_bf16 v[88:91], v[168:171], v[200:203], v[88:91]
  ds_read_b64_tr_b16 v[124:125], v244 offset:224
  v_mfma_f32_16x16x32_bf16 v[92:95], v[168:171], v[204:207], v[92:95]
  ds_read_b64_tr_b16 v[126:127], v244 offset:480
  s_waitcnt lgkmcnt(0)
  s_barrier
  v_mfma_f32_16x16x32_bf16 v[0:3], v[96:99], v[128:131], v[0:3]
  ds_read_b64_tr_b16 v[140:141], v244 offset:16896
  v_mfma_f32_16x16x32_bf16 v[4:7], v[96:99], v[132:135], v[4:7]
  v_mfma_f32_16x16x32_bf16 v[8:11], v[96:99], v[136:139], v[8:11]
  ds_read_b64_tr_b16 v[142:143], v244 offset:17152
  v_mfma_f32_16x16x32_bf16 v[12:15], v[100:103], v[128:131], v[12:15]
  ds_read_b64_tr_b16 v[144:145], v244 offset:16928
  v_mfma_f32_16x16x32_bf16 v[16:19], v[100:103], v[132:135], v[16:19]
  v_mfma_f32_16x16x32_bf16 v[20:23], v[100:103], v[136:139], v[20:23]
  ds_read_b64_tr_b16 v[146:147], v244 offset:17184
  v_mfma_f32_16x16x32_bf16 v[24:27], v[104:107], v[128:131], v[24:27]
  ds_read_b64_tr_b16 v[148:149], v244 offset:16960
  v_mfma_f32_16x16x32_bf16 v[28:31], v[104:107], v[132:135], v[28:31]
  v_mfma_f32_16x16x32_bf16 v[32:35], v[104:107], v[136:139], v[32:35]
  ds_read_b64_tr_b16 v[150:151], v244 offset:17216
  v_mfma_f32_16x16x32_bf16 v[36:39], v[108:111], v[128:131], v[36:39]
  ds_read_b64_tr_b16 v[152:153], v244 offset:16992
  v_mfma_f32_16x16x32_bf16 v[40:43], v[108:111], v[132:135], v[40:43]
  v_mfma_f32_16x16x32_bf16 v[44:47], v[108:111], v[136:139], v[44:47]
  ds_read_b64_tr_b16 v[154:155], v244 offset:17248
  v_mfma_f32_16x16x32_bf16 v[48:51], v[112:115], v[128:131], v[48:51]
  ds_read_b64_tr_b16 v[156:157], v244 offset:17024
  v_mfma_f32_16x16x32_bf16 v[52:55], v[112:115], v[132:135], v[52:55]
  v_mfma_f32_16x16x32_bf16 v[56:59], v[112:115], v[136:139], v[56:59]
  ds_read_b64_tr_b16 v[158:159], v244 offset:17280
  v_mfma_f32_16x16x32_bf16 v[60:63], v[116:119], v[128:131], v[60:63]
  ds_read_b64_tr_b16 v[160:161], v244 offset:17056
  v_mfma_f32_16x16x32_bf16 v[64:67], v[116:119], v[132:135], v[64:67]
  v_mfma_f32_16x16x32_bf16 v[68:71], v[116:119], v[136:139], v[68:71]
  ds_read_b64_tr_b16 v[162:163], v244 offset:17312
  v_mfma_f32_16x16x32_bf16 v[72:75], v[120:123], v[128:131], v[72:75]
  ds_read_b64_tr_b16 v[164:165], v244 offset:17088
  v_mfma_f32_16x16x32_bf16 v[76:79], v[120:123], v[132:135], v[76:79]
  v_mfma_f32_16x16x32_bf16 v[80:83], v[120:123], v[136:139], v[80:83]
  ds_read_b64_tr_b16 v[166:167], v244 offset:17344
  v_mfma_f32_16x16x32_bf16 v[84:87], v[124:127], v[128:131], v[84:87]
  ds_read_b64_tr_b16 v[168:169], v244 offset:17120
  v_mfma_f32_16x16x32_bf16 v[88:91], v[124:127], v[132:135], v[88:91]
  v_mfma_f32_16x16x32_bf16 v[92:95], v[124:127], v[136:139], v[92:95]
  ds_read_b64_tr_b16 v[170:171], v244 offset:17376
  s_waitcnt lgkmcnt(0)
  s_barrier
  v_mfma_f32_16x16x32_bf16 v[0:3], v[140:143], v[172:175], v[0:3]
  ds_read_b128 v[184:187], v246 offset:12288
  v_mfma_f32_16x16x32_bf16 v[4:7], v[140:143], v[176:179], v[4:7]
  ds_read_b128 v[188:191], v246 offset:14336
  v_mfma_f32_16x16x32_bf16 v[8:11], v[140:143], v[180:183], v[8:11]
  ds_read_b128 v[192:195], v246 offset:16384
  v_mfma_f32_16x16x32_bf16 v[12:15], v[144:147], v[172:175], v[12:15]
  ds_read_b128 v[196:199], v247 offset:12288
  v_mfma_f32_16x16x32_bf16 v[16:19], v[144:147], v[176:179], v[16:19]
  ds_read_b128 v[200:203], v247 offset:14336
  v_mfma_f32_16x16x32_bf16 v[20:23], v[144:147], v[180:183], v[20:23]
  ds_read_b128 v[204:207], v247 offset:16384
  v_mfma_f32_16x16x32_bf16 v[24:27], v[148:151], v[172:175], v[24:27]
  v_mfma_f32_16x16x32_bf16 v[28:31], v[148:151], v[176:179], v[28:31]
  ds_read_b64_tr_b16 v[96:97], v245 offset:0
  v_mfma_f32_16x16x32_bf16 v[32:35], v[148:151], v[180:183], v[32:35]
  ds_read_b64_tr_b16 v[98:99], v245 offset:256
  v_mfma_f32_16x16x32_bf16 v[36:39], v[152:155], v[172:175], v[36:39]
  ds_read_b64_tr_b16 v[100:101], v245 offset:32
  v_mfma_f32_16x16x32_bf16 v[40:43], v[152:155], v[176:179], v[40:43]
  ds_read_b64_tr_b16 v[102:103], v245 offset:288
  v_mfma_f32_16x16x32_bf16 v[44:47], v[152:155], v[180:183], v[44:47]
  ds_read_b64_tr_b16 v[104:105], v245 offset:64
  v_mfma_f32_16x16x32_bf16 v[48:51], v[156:159], v[172:175], v[48:51]
  ds_read_b64_tr_b16 v[106:107], v245 offset:320
  v_mfma_f32_16x16x32_bf16 v[52:55], v[156:159], v[176:179], v[52:55]
  ds_read_b64_tr_b16 v[108:109], v245 offset:96
  v_mfma_f32_16x16x32_bf16 v[56:59], v[156:159], v[180:183], v[56:59]
  ds_read_b64_tr_b16 v[110:111], v245 offset:352
  v_mfma_f32_16x16x32_bf16 v[60:63], v[160:163], v[172:175], v[60:63]
  ds_read_b64_tr_b16 v[112:113], v245 offset:128
  v_mfma_f32_16x16x32_bf16 v[64:67], v[160:163], v[176:179], v[64:67]
  ds_read_b64_tr_b16 v[114:115], v245 offset:384
  v_mfma_f32_16x16x32_bf16 v[68:71], v[160:163], v[180:183], v[68:71]
  ds_read_b64_tr_b16 v[116:117], v245 offset:160
  v_mfma_f32_16x16x32_bf16 v[72:75], v[164:167], v[172:175], v[72:75]
  v_mfma_f32_16x16x32_bf16 v[76:79], v[164:167], v[176:179], v[76:79]
  ds_read_b64_tr_b16 v[118:119], v245 offset:416
  v_mfma_f32_16x16x32_bf16 v[80:83], v[164:167], v[180:183], v[80:83]
  ds_read_b64_tr_b16 v[120:121], v245 offset:192
  v_mfma_f32_16x16x32_bf16 v[84:87], v[168:171], v[172:175], v[84:87]
  ds_read_b64_tr_b16 v[122:123], v245 offset:448
  v_mfma_f32_16x16x32_bf16 v[88:91], v[168:171], v[176:179], v[88:91]
  ds_read_b64_tr_b16 v[124:125], v245 offset:224
  v_mfma_f32_16x16x32_bf16 v[92:95], v[168:171], v[180:183], v[92:95]
  ds_read_b64_tr_b16 v[126:127], v245 offset:480
  s_waitcnt lgkmcnt(0)
  s_barrier
  v_mfma_f32_16x16x32_bf16 v[0:3], v[96:99], v[184:187], v[0:3]
  ds_read_b64_tr_b16 v[140:141], v245 offset:16896
  v_mfma_f32_16x16x32_bf16 v[4:7], v[96:99], v[188:191], v[4:7]
  v_mfma_f32_16x16x32_bf16 v[8:11], v[96:99], v[192:195], v[8:11]
  ds_read_b64_tr_b16 v[142:143], v245 offset:17152
  v_mfma_f32_16x16x32_bf16 v[12:15], v[100:103], v[184:187], v[12:15]
  ds_read_b64_tr_b16 v[144:145], v245 offset:16928
  v_mfma_f32_16x16x32_bf16 v[16:19], v[100:103], v[188:191], v[16:19]
  v_mfma_f32_16x16x32_bf16 v[20:23], v[100:103], v[192:195], v[20:23]
  ds_read_b64_tr_b16 v[146:147], v245 offset:17184
  v_mfma_f32_16x16x32_bf16 v[24:27], v[104:107], v[184:187], v[24:27]
  ds_read_b64_tr_b16 v[148:149], v245 offset:16960
  v_mfma_f32_16x16x32_bf16 v[28:31], v[104:107], v[188:191], v[28:31]
  v_mfma_f32_16x16x32_bf16 v[32:35], v[104:107], v[192:195], v[32:35]
  ds_read_b64_tr_b16 v[150:151], v245 offset:17216
  v_mfma_f32_16x16x32_bf16 v[36:39], v[108:111], v[184:187], v[36:39]
  ds_read_b64_tr_b16 v[152:153], v245 offset:16992
  v_mfma_f32_16x16x32_bf16 v[40:43], v[108:111], v[188:191], v[40:43]
  v_mfma_f32_16x16x32_bf16 v[44:47], v[108:111], v[192:195], v[44:47]
  ds_read_b64_tr_b16 v[154:155], v245 offset:17248
  v_mfma_f32_16x16x32_bf16 v[48:51], v[112:115], v[184:187], v[48:51]
  ds_read_b64_tr_b16 v[156:157], v245 offset:17024
  v_mfma_f32_16x16x32_bf16 v[52:55], v[112:115], v[188:191], v[52:55]
  v_mfma_f32_16x16x32_bf16 v[56:59], v[112:115], v[192:195], v[56:59]
  ds_read_b64_tr_b16 v[158:159], v245 offset:17280
  v_mfma_f32_16x16x32_bf16 v[60:63], v[116:119], v[184:187], v[60:63]
  ds_read_b64_tr_b16 v[160:161], v245 offset:17056
  v_mfma_f32_16x16x32_bf16 v[64:67], v[116:119], v[188:191], v[64:67]
  v_mfma_f32_16x16x32_bf16 v[68:71], v[116:119], v[192:195], v[68:71]
  ds_read_b64_tr_b16 v[162:163], v245 offset:17312
  v_mfma_f32_16x16x32_bf16 v[72:75], v[120:123], v[184:187], v[72:75]
  ds_read_b64_tr_b16 v[164:165], v245 offset:17088
  v_mfma_f32_16x16x32_bf16 v[76:79], v[120:123], v[188:191], v[76:79]
  v_mfma_f32_16x16x32_bf16 v[80:83], v[120:123], v[192:195], v[80:83]
  ds_read_b64_tr_b16 v[166:167], v245 offset:17344
  v_mfma_f32_16x16x32_bf16 v[84:87], v[124:127], v[184:187], v[84:87]
  ds_read_b64_tr_b16 v[168:169], v245 offset:17120
  v_mfma_f32_16x16x32_bf16 v[88:91], v[124:127], v[188:191], v[88:91]
  v_mfma_f32_16x16x32_bf16 v[92:95], v[124:127], v[192:195], v[92:95]
  ds_read_b64_tr_b16 v[170:171], v245 offset:17376
  s_waitcnt lgkmcnt(0)
  s_barrier
  v_mfma_f32_16x16x32_bf16 v[0:3], v[140:143], v[196:199], v[0:3]
  ds_read_b128 v[128:131], v246 offset:0
  v_mfma_f32_16x16x32_bf16 v[4:7], v[140:143], v[200:203], v[4:7]
  ds_read_b128 v[132:135], v246 offset:2048
  v_mfma_f32_16x16x32_bf16 v[8:11], v[140:143], v[204:207], v[8:11]
  ds_read_b128 v[136:139], v246 offset:4096
  v_mfma_f32_16x16x32_bf16 v[12:15], v[144:147], v[196:199], v[12:15]
  ds_read_b128 v[172:175], v247 offset:0
  v_mfma_f32_16x16x32_bf16 v[16:19], v[144:147], v[200:203], v[16:19]
  ds_read_b128 v[176:179], v247 offset:2048
  v_mfma_f32_16x16x32_bf16 v[20:23], v[144:147], v[204:207], v[20:23]
  ds_read_b128 v[180:183], v247 offset:4096
  v_mfma_f32_16x16x32_bf16 v[24:27], v[148:151], v[196:199], v[24:27]
  v_mfma_f32_16x16x32_bf16 v[28:31], v[148:151], v[200:203], v[28:31]
  ds_read_b64_tr_b16 v[96:97], v244 offset:0
  v_mfma_f32_16x16x32_bf16 v[32:35], v[148:151], v[204:207], v[32:35]
  ds_read_b64_tr_b16 v[98:99], v244 offset:256
  v_mfma_f32_16x16x32_bf16 v[36:39], v[152:155], v[196:199], v[36:39]
  ds_read_b64_tr_b16 v[100:101], v244 offset:32
  v_mfma_f32_16x16x32_bf16 v[40:43], v[152:155], v[200:203], v[40:43]
  ds_read_b64_tr_b16 v[102:103], v244 offset:288
  v_mfma_f32_16x16x32_bf16 v[44:47], v[152:155], v[204:207], v[44:47]
  ds_read_b64_tr_b16 v[104:105], v244 offset:64
  v_mfma_f32_16x16x32_bf16 v[48:51], v[156:159], v[196:199], v[48:51]
  ds_read_b64_tr_b16 v[106:107], v244 offset:320
  v_mfma_f32_16x16x32_bf16 v[52:55], v[156:159], v[200:203], v[52:55]
  ds_read_b64_tr_b16 v[108:109], v244 offset:96
  v_mfma_f32_16x16x32_bf16 v[56:59], v[156:159], v[204:207], v[56:59]
  ds_read_b64_tr_b16 v[110:111], v244 offset:352
  v_mfma_f32_16x16x32_bf16 v[60:63], v[160:163], v[196:199], v[60:63]
  ds_read_b64_tr_b16 v[112:113], v244 offset:128
  v_mfma_f32_16x16x32_bf16 v[64:67], v[160:163], v[200:203], v[64:67]
  ds_read_b64_tr_b16 v[114:115], v244 offset:384
  v_mfma_f32_16x16x32_bf16 v[68:71], v[160:163], v[204:207], v[68:71]
  ds_read_b64_tr_b16 v[116:117], v244 offset:160
  v_mfma_f32_16x16x32_bf16 v[72:75], v[164:167], v[196:199], v[72:75]
  v_mfma_f32_16x16x32_bf16 v[76:79], v[164:167], v[200:203], v[76:79]
  ds_read_b64_tr_b16 v[118:119], v244 offset:416
  v_mfma_f32_16x16x32_bf16 v[80:83], v[164:167], v[204:207], v[80:83]
  ds_read_b64_tr_b16 v[120:121], v244 offset:192
  v_mfma_f32_16x16x32_bf16 v[84:87], v[168:171], v[196:199], v[84:87]
  ds_read_b64_tr_b16 v[122:123], v244 offset:448
  v_mfma_f32_16x16x32_bf16 v[88:91], v[168:171], v[200:203], v[88:91]
  ds_read_b64_tr_b16 v[124:125], v244 offset:224
  v_mfma_f32_16x16x32_bf16 v[92:95], v[168:171], v[204:207], v[92:95]
  ds_read_b64_tr_b16 v[126:127], v244 offset:480
  s_waitcnt lgkmcnt(0)
  s_barrier
  v_mfma_f32_16x16x32_bf16 v[0:3], v[96:99], v[128:131], v[0:3]
  ds_read_b64_tr_b16 v[140:141], v244 offset:16896
  v_mfma_f32_16x16x32_bf16 v[4:7], v[96:99], v[132:135], v[4:7]
  v_mfma_f32_16x16x32_bf16 v[8:11], v[96:99], v[136:139], v[8:11]
  ds_read_b64_tr_b16 v[142:143], v244 offset:17152
  v_mfma_f32_16x16x32_bf16 v[12:15], v[100:103], v[128:131], v[12:15]
  ds_read_b64_tr_b16 v[144:145], v244 offset:16928
  v_mfma_f32_16x16x32_bf16 v[16:19], v[100:103], v[132:135], v[16:19]
  v_mfma_f32_16x16x32_bf16 v[20:23], v[100:103], v[136:139], v[20:23]
  ds_read_b64_tr_b16 v[146:147], v244 offset:17184
  v_mfma_f32_16x16x32_bf16 v[24:27], v[104:107], v[128:131], v[24:27]
  ds_read_b64_tr_b16 v[148:149], v244 offset:16960
  v_mfma_f32_16x16x32_bf16 v[28:31], v[104:107], v[132:135], v[28:31]
  v_mfma_f32_16x16x32_bf16 v[32:35], v[104:107], v[136:139], v[32:35]
  ds_read_b64_tr_b16 v[150:151], v244 offset:17216
  v_mfma_f32_16x16x32_bf16 v[36:39], v[108:111], v[128:131], v[36:39]
  ds_read_b64_tr_b16 v[152:153], v244 offset:16992
  v_mfma_f32_16x16x32_bf16 v[40:43], v[108:111], v[132:135], v[40:43]
  v_mfma_f32_16x16x32_bf16 v[44:47], v[108:111], v[136:139], v[44:47]
  ds_read_b64_tr_b16 v[154:155], v244 offset:17248
  v_mfma_f32_16x16x32_bf16 v[48:51], v[112:115], v[128:131], v[48:51]
  ds_read_b64_tr_b16 v[156:157], v244 offset:17024
  v_mfma_f32_16x16x32_bf16 v[52:55], v[112:115], v[132:135], v[52:55]
  v_mfma_f32_16x16x32_bf16 v[56:59], v[112:115], v[136:139], v[56:59]
  ds_read_b64_tr_b16 v[158:159], v244 offset:17280
  v_mfma_f32_16x16x32_bf16 v[60:63], v[116:119], v[128:131], v[60:63]
  ds_read_b64_tr_b16 v[160:161], v244 offset:17056
  v_mfma_f32_16x16x32_bf16 v[64:67], v[116:119], v[132:135], v[64:67]
  v_mfma_f32_16x16x32_bf16 v[68:71], v[116:119], v[136:139], v[68:71]
  ds_read_b64_tr_b16 v[162:163], v244 offset:17312
  v_mfma_f32_16x16x32_bf16 v[72:75], v[120:123], v[128:131], v[72:75]
  ds_read_b64_tr_b16 v[164:165], v244 offset:17088
  v_mfma_f32_16x16x32_bf16 v[76:79], v[120:123], v[132:135], v[76:79]
  v_mfma_f32_16x16x32_bf16 v[80:83], v[120:123], v[136:139], v[80:83]
  ds_read_b64_tr_b16 v[166:167], v244 offset:17344
  v_mfma_f32_16x16x32_bf16 v[84:87], v[124:127], v[128:131], v[84:87]
  ds_read_b64_tr_b16 v[168:169], v244 offset:17120
  v_mfma_f32_16x16x32_bf16 v[88:91], v[124:127], v[132:135], v[88:91]
  v_mfma_f32_16x16x32_bf16 v[92:95], v[124:127], v[136:139], v[92:95]
  ds_read_b64_tr_b16 v[170:171], v244 offset:17376
  s_waitcnt lgkmcnt(0)
  s_barrier
  v_mfma_f32_16x16x32_bf16 v[0:3], v[140:143], v[172:175], v[0:3]
  ds_read_b128 v[184:187], v246 offset:12288
  v_mfma_f32_16x16x32_bf16 v[4:7], v[140:143], v[176:179], v[4:7]
  ds_read_b128 v[188:191], v246 offset:14336
  v_mfma_f32_16x16x32_bf16 v[8:11], v[140:143], v[180:183], v[8:11]
  ds_read_b128 v[192:195], v246 offset:16384
  v_mfma_f32_16x16x32_bf16 v[12:15], v[144:147], v[172:175], v[12:15]
  ds_read_b128 v[196:199], v247 offset:12288
  v_mfma_f32_16x16x32_bf16 v[16:19], v[144:147], v[176:179], v[16:19]
  ds_read_b128 v[200:203], v247 offset:14336
  v_mfma_f32_16x16x32_bf16 v[20:23], v[144:147], v[180:183], v[20:23]
  ds_read_b128 v[204:207], v247 offset:16384
  v_mfma_f32_16x16x32_bf16 v[24:27], v[148:151], v[172:175], v[24:27]
  v_mfma_f32_16x16x32_bf16 v[28:31], v[148:151], v[176:179], v[28:31]
  ds_read_b64_tr_b16 v[96:97], v245 offset:0
  v_mfma_f32_16x16x32_bf16 v[32:35], v[148:151], v[180:183], v[32:35]
  ds_read_b64_tr_b16 v[98:99], v245 offset:256
  v_mfma_f32_16x16x32_bf16 v[36:39], v[152:155], v[172:175], v[36:39]
  ds_read_b64_tr_b16 v[100:101], v245 offset:32
  v_mfma_f32_16x16x32_bf16 v[40:43], v[152:155], v[176:179], v[40:43]
  ds_read_b64_tr_b16 v[102:103], v245 offset:288
  v_mfma_f32_16x16x32_bf16 v[44:47], v[152:155], v[180:183], v[44:47]
  ds_read_b64_tr_b16 v[104:105], v245 offset:64
  v_mfma_f32_16x16x32_bf16 v[48:51], v[156:159], v[172:175], v[48:51]
  ds_read_b64_tr_b16 v[106:107], v245 offset:320
  v_mfma_f32_16x16x32_bf16 v[52:55], v[156:159], v[176:179], v[52:55]
  ds_read_b64_tr_b16 v[108:109], v245 offset:96
  v_mfma_f32_16x16x32_bf16 v[56:59], v[156:159], v[180:183], v[56:59]
  ds_read_b64_tr_b16 v[110:111], v245 offset:352
  v_mfma_f32_16x16x32_bf16 v[60:63], v[160:163], v[172:175], v[60:63]
  ds_read_b64_tr_b16 v[112:113], v245 offset:128
  v_mfma_f32_16x16x32_bf16 v[64:67], v[160:163], v[176:179], v[64:67]
  ds_read_b64_tr_b16 v[114:115], v245 offset:384
  v_mfma_f32_16x16x32_bf16 v[68:71], v[160:163], v[180:183], v[68:71]
  ds_read_b64_tr_b16 v[116:117], v245 offset:160
  v_mfma_f32_16x16x32_bf16 v[72:75], v[164:167], v[172:175], v[72:75]
  v_mfma_f32_16x16x32_bf16 v[76:79], v[164:167], v[176:179], v[76:79]
  ds_read_b64_tr_b16 v[118:119], v245 offset:416
  v_mfma_f32_16x16x32_bf16 v[80:83], v[164:167], v[180:183], v[80:83]
  ds_read_b64_tr_b16 v[120:121], v245 offset:192
  v_mfma_f32_16x16x32_bf16 v[84:87], v[168:171], v[172:175], v[84:87]
  ds_read_b64_tr_b16 v[122:123], v245 offset:448
  v_mfma_f32_16x16x32_bf16 v[88:91], v[168:171], v[176:179], v[88:91]
  ds_read_b64_tr_b16 v[124:125], v245 offset:224
  v_mfma_f32_16x16x32_bf16 v[92:95], v[168:171], v[180:183], v[92:95]
  ds_read_b64_tr_b16 v[126:127], v245 offset:480
  s_waitcnt lgkmcnt(0)
  s_barrier
  v_mfma_f32_16x16x32_bf16 v[0:3], v[96:99], v[184:187], v[0:3]
  ds_read_b64_tr_b16 v[140:141], v245 offset:16896
  v_mfma_f32_16x16x32_bf16 v[4:7], v[96:99], v[188:191], v[4:7]
  v_mfma_f32_16x16x32_bf16 v[8:11], v[96:99], v[192:195], v[8:11]
  ds_read_b64_tr_b16 v[142:143], v245 offset:17152
  v_mfma_f32_16x16x32_bf16 v[12:15], v[100:103], v[184:187], v[12:15]
  ds_read_b64_tr_b16 v[144:145], v245 offset:16928
  v_mfma_f32_16x16x32_bf16 v[16:19], v[100:103], v[188:191], v[16:19]
  v_mfma_f32_16x16x32_bf16 v[20:23], v[100:103], v[192:195], v[20:23]
  ds_read_b64_tr_b16 v[146:147], v245 offset:17184
  v_mfma_f32_16x16x32_bf16 v[24:27], v[104:107], v[184:187], v[24:27]
  ds_read_b64_tr_b16 v[148:149], v245 offset:16960
  v_mfma_f32_16x16x32_bf16 v[28:31], v[104:107], v[188:191], v[28:31]
  v_mfma_f32_16x16x32_bf16 v[32:35], v[104:107], v[192:195], v[32:35]
  ds_read_b64_tr_b16 v[150:151], v245 offset:17216
  v_mfma_f32_16x16x32_bf16 v[36:39], v[108:111], v[184:187], v[36:39]
  ds_read_b64_tr_b16 v[152:153], v245 offset:16992
  v_mfma_f32_16x16x32_bf16 v[40:43], v[108:111], v[188:191], v[40:43]
  v_mfma_f32_16x16x32_bf16 v[44:47], v[108:111], v[192:195], v[44:47]
  ds_read_b64_tr_b16 v[154:155], v245 offset:17248
  v_mfma_f32_16x16x32_bf16 v[48:51], v[112:115], v[184:187], v[48:51]
  ds_read_b64_tr_b16 v[156:157], v245 offset:17024
  v_mfma_f32_16x16x32_bf16 v[52:55], v[112:115], v[188:191], v[52:55]
  v_mfma_f32_16x16x32_bf16 v[56:59], v[112:115], v[192:195], v[56:59]
  ds_read_b64_tr_b16 v[158:159], v245 offset:17280
  v_mfma_f32_16x16x32_bf16 v[60:63], v[116:119], v[184:187], v[60:63]
  ds_read_b64_tr_b16 v[160:161], v245 offset:17056
  v_mfma_f32_16x16x32_bf16 v[64:67], v[116:119], v[188:191], v[64:67]
  v_mfma_f32_16x16x32_bf16 v[68:71], v[116:119], v[192:195], v[68:71]
  ds_read_b64_tr_b16 v[162:163], v245 offset:17312
  v_mfma_f32_16x16x32_bf16 v[72:75], v[120:123], v[184:187], v[72:75]
  ds_read_b64_tr_b16 v[164:165], v245 offset:17088
  v_mfma_f32_16x16x32_bf16 v[76:79], v[120:123], v[188:191], v[76:79]
  v_mfma_f32_16x16x32_bf16 v[80:83], v[120:123], v[192:195], v[80:83]
  ds_read_b64_tr_b16 v[166:167], v245 offset:17344
  v_mfma_f32_16x16x32_bf16 v[84:87], v[124:127], v[184:187], v[84:87]
  ds_read_b64_tr_b16 v[168:169], v245 offset:17120
  v_mfma_f32_16x16x32_bf16 v[88:91], v[124:127], v[188:191], v[88:91]
  v_mfma_f32_16x16x32_bf16 v[92:95], v[124:127], v[192:195], v[92:95]
  ds_read_b64_tr_b16 v[170:171], v245 offset:17376
  s_waitcnt lgkmcnt(0)
  s_barrier
  v_mfma_f32_16x16x32_bf16 v[0:3], v[140:143], v[196:199], v[0:3]
  ds_read_b128 v[128:131], v246 offset:0
  v_mfma_f32_16x16x32_bf16 v[4:7], v[140:143], v[200:203], v[4:7]
  ds_read_b128 v[132:135], v246 offset:2048
  v_mfma_f32_16x16x32_bf16 v[8:11], v[140:143], v[204:207], v[8:11]
  ds_read_b128 v[136:139], v246 offset:4096
  v_mfma_f32_16x16x32_bf16 v[12:15], v[144:147], v[196:199], v[12:15]
  ds_read_b128 v[172:175], v247 offset:0
  v_mfma_f32_16x16x32_bf16 v[16:19], v[144:147], v[200:203], v[16:19]
  ds_read_b128 v[176:179], v247 offset:2048
  v_mfma_f32_16x16x32_bf16 v[20:23], v[144:147], v[204:207], v[20:23]
  ds_read_b128 v[180:183], v247 offset:4096
  v_mfma_f32_16x16x32_bf16 v[24:27], v[148:151], v[196:199], v[24:27]
  v_mfma_f32_16x16x32_bf16 v[28:31], v[148:151], v[200:203], v[28:31]
  ds_read_b64_tr_b16 v[96:97], v244 offset:0
  v_mfma_f32_16x16x32_bf16 v[32:35], v[148:151], v[204:207], v[32:35]
  ds_read_b64_tr_b16 v[98:99], v244 offset:256
  v_mfma_f32_16x16x32_bf16 v[36:39], v[152:155], v[196:199], v[36:39]
  ds_read_b64_tr_b16 v[100:101], v244 offset:32
  v_mfma_f32_16x16x32_bf16 v[40:43], v[152:155], v[200:203], v[40:43]
  ds_read_b64_tr_b16 v[102:103], v244 offset:288
  v_mfma_f32_16x16x32_bf16 v[44:47], v[152:155], v[204:207], v[44:47]
  ds_read_b64_tr_b16 v[104:105], v244 offset:64
  v_mfma_f32_16x16x32_bf16 v[48:51], v[156:159], v[196:199], v[48:51]
  ds_read_b64_tr_b16 v[106:107], v244 offset:320
  v_mfma_f32_16x16x32_bf16 v[52:55], v[156:159], v[200:203], v[52:55]
  ds_read_b64_tr_b16 v[108:109], v244 offset:96
  v_mfma_f32_16x16x32_bf16 v[56:59], v[156:159], v[204:207], v[56:59]
  ds_read_b64_tr_b16 v[110:111], v244 offset:352
  v_mfma_f32_16x16x32_bf16 v[60:63], v[160:163], v[196:199], v[60:63]
  ds_read_b64_tr_b16 v[112:113], v244 offset:128
  v_mfma_f32_16x16x32_bf16 v[64:67], v[160:163], v[200:203], v[64:67]
  ds_read_b64_tr_b16 v[114:115], v244 offset:384
  v_mfma_f32_16x16x32_bf16 v[68:71], v[160:163], v[204:207], v[68:71]
  ds_read_b64_tr_b16 v[116:117], v244 offset:160
  v_mfma_f32_16x16x32_bf16 v[72:75], v[164:167], v[196:199], v[72:75]
  v_mfma_f32_16x16x32_bf16 v[76:79], v[164:167], v[200:203], v[76:79]
  ds_read_b64_tr_b16 v[118:119], v244 offset:416
  v_mfma_f32_16x16x32_bf16 v[80:83], v[164:167], v[204:207], v[80:83]
  ds_read_b64_tr_b16 v[120:121], v244 offset:192
  v_mfma_f32_16x16x32_bf16 v[84:87], v[168:171], v[196:199], v[84:87]
  ds_read_b64_tr_b16 v[122:123], v244 offset:448
  v_mfma_f32_16x16x32_bf16 v[88:91], v[168:171], v[200:203], v[88:91]
  ds_read_b64_tr_b16 v[124:125], v244 offset:224
  v_mfma_f32_16x16x32_bf16 v[92:95], v[168:171], v[204:207], v[92:95]
  ds_read_b64_tr_b16 v[126:127], v244 offset:480
  s_waitcnt lgkmcnt(0)
  s_barrier
  v_mfma_f32_16x16x32_bf16 v[0:3], v[96:99], v[128:131], v[0:3]
  ds_read_b64_tr_b16 v[140:141], v244 offset:16896
  v_mfma_f32_16x16x32_bf16 v[4:7], v[96:99], v[132:135], v[4:7]
  v_mfma_f32_16x16x32_bf16 v[8:11], v[96:99], v[136:139], v[8:11]
  ds_read_b64_tr_b16 v[142:143], v244 offset:17152
  v_mfma_f32_16x16x32_bf16 v[12:15], v[100:103], v[128:131], v[12:15]
  ds_read_b64_tr_b16 v[144:145], v244 offset:16928
  v_mfma_f32_16x16x32_bf16 v[16:19], v[100:103], v[132:135], v[16:19]
  v_mfma_f32_16x16x32_bf16 v[20:23], v[100:103], v[136:139], v[20:23]
  ds_read_b64_tr_b16 v[146:147], v244 offset:17184
  v_mfma_f32_16x16x32_bf16 v[24:27], v[104:107], v[128:131], v[24:27]
  ds_read_b64_tr_b16 v[148:149], v244 offset:16960
  v_mfma_f32_16x16x32_bf16 v[28:31], v[104:107], v[132:135], v[28:31]
  v_mfma_f32_16x16x32_bf16 v[32:35], v[104:107], v[136:139], v[32:35]
  ds_read_b64_tr_b16 v[150:151], v244 offset:17216
  v_mfma_f32_16x16x32_bf16 v[36:39], v[108:111], v[128:131], v[36:39]
  ds_read_b64_tr_b16 v[152:153], v244 offset:16992
  v_mfma_f32_16x16x32_bf16 v[40:43], v[108:111], v[132:135], v[40:43]
  v_mfma_f32_16x16x32_bf16 v[44:47], v[108:111], v[136:139], v[44:47]
  ds_read_b64_tr_b16 v[154:155], v244 offset:17248
  v_mfma_f32_16x16x32_bf16 v[48:51], v[112:115], v[128:131], v[48:51]
  ds_read_b64_tr_b16 v[156:157], v244 offset:17024
  v_mfma_f32_16x16x32_bf16 v[52:55], v[112:115], v[132:135], v[52:55]
  v_mfma_f32_16x16x32_bf16 v[56:59], v[112:115], v[136:139], v[56:59]
  ds_read_b64_tr_b16 v[158:159], v244 offset:17280
  v_mfma_f32_16x16x32_bf16 v[60:63], v[116:119], v[128:131], v[60:63]
  ds_read_b64_tr_b16 v[160:161], v244 offset:17056
  v_mfma_f32_16x16x32_bf16 v[64:67], v[116:119], v[132:135], v[64:67]
  v_mfma_f32_16x16x32_bf16 v[68:71], v[116:119], v[136:139], v[68:71]
  ds_read_b64_tr_b16 v[162:163], v244 offset:17312
  v_mfma_f32_16x16x32_bf16 v[72:75], v[120:123], v[128:131], v[72:75]
  ds_read_b64_tr_b16 v[164:165], v244 offset:17088
  v_mfma_f32_16x16x32_bf16 v[76:79], v[120:123], v[132:135], v[76:79]
  v_mfma_f32_16x16x32_bf16 v[80:83], v[120:123], v[136:139], v[80:83]
  ds_read_b64_tr_b16 v[166:167], v244 offset:17344
  v_mfma_f32_16x16x32_bf16 v[84:87], v[124:127], v[128:131], v[84:87]
  ds_read_b64_tr_b16 v[168:169], v244 offset:17120
  v_mfma_f32_16x16x32_bf16 v[88:91], v[124:127], v[132:135], v[88:91]
  v_mfma_f32_16x16x32_bf16 v[92:95], v[124:127], v[136:139], v[92:95]
  ds_read_b64_tr_b16 v[170:171], v244 offset:17376
  s_waitcnt lgkmcnt(0)
  s_barrier
  v_mfma_f32_16x16x32_bf16 v[0:3], v[140:143], v[172:175], v[0:3]
  ds_read_b128 v[184:187], v246 offset:12288
  v_mfma_f32_16x16x32_bf16 v[4:7], v[140:143], v[176:179], v[4:7]
  ds_read_b128 v[188:191], v246 offset:14336
  v_mfma_f32_16x16x32_bf16 v[8:11], v[140:143], v[180:183], v[8:11]
  ds_read_b128 v[192:195], v246 offset:16384
  v_mfma_f32_16x16x32_bf16 v[12:15], v[144:147], v[172:175], v[12:15]
  ds_read_b128 v[196:199], v247 offset:12288
  v_mfma_f32_16x16x32_bf16 v[16:19], v[144:147], v[176:179], v[16:19]
  ds_read_b128 v[200:203], v247 offset:14336
  v_mfma_f32_16x16x32_bf16 v[20:23], v[144:147], v[180:183], v[20:23]
  ds_read_b128 v[204:207], v247 offset:16384
  v_mfma_f32_16x16x32_bf16 v[24:27], v[148:151], v[172:175], v[24:27]
  v_mfma_f32_16x16x32_bf16 v[28:31], v[148:151], v[176:179], v[28:31]
  ds_read_b64_tr_b16 v[96:97], v245 offset:0
  v_mfma_f32_16x16x32_bf16 v[32:35], v[148:151], v[180:183], v[32:35]
  ds_read_b64_tr_b16 v[98:99], v245 offset:256
  v_mfma_f32_16x16x32_bf16 v[36:39], v[152:155], v[172:175], v[36:39]
  ds_read_b64_tr_b16 v[100:101], v245 offset:32
  v_mfma_f32_16x16x32_bf16 v[40:43], v[152:155], v[176:179], v[40:43]
  ds_read_b64_tr_b16 v[102:103], v245 offset:288
  v_mfma_f32_16x16x32_bf16 v[44:47], v[152:155], v[180:183], v[44:47]
  ds_read_b64_tr_b16 v[104:105], v245 offset:64
  v_mfma_f32_16x16x32_bf16 v[48:51], v[156:159], v[172:175], v[48:51]
  ds_read_b64_tr_b16 v[106:107], v245 offset:320
  v_mfma_f32_16x16x32_bf16 v[52:55], v[156:159], v[176:179], v[52:55]
  ds_read_b64_tr_b16 v[108:109], v245 offset:96
  v_mfma_f32_16x16x32_bf16 v[56:59], v[156:159], v[180:183], v[56:59]
  ds_read_b64_tr_b16 v[110:111], v245 offset:352
  v_mfma_f32_16x16x32_bf16 v[60:63], v[160:163], v[172:175], v[60:63]
  ds_read_b64_tr_b16 v[112:113], v245 offset:128
  v_mfma_f32_16x16x32_bf16 v[64:67], v[160:163], v[176:179], v[64:67]
  ds_read_b64_tr_b16 v[114:115], v245 offset:384
  v_mfma_f32_16x16x32_bf16 v[68:71], v[160:163], v[180:183], v[68:71]
  ds_read_b64_tr_b16 v[116:117], v245 offset:160
  v_mfma_f32_16x16x32_bf16 v[72:75], v[164:167], v[172:175], v[72:75]
  v_mfma_f32_16x16x32_bf16 v[76:79], v[164:167], v[176:179], v[76:79]
  ds_read_b64_tr_b16 v[118:119], v245 offset:416
  v_mfma_f32_16x16x32_bf16 v[80:83], v[164:167], v[180:183], v[80:83]
  ds_read_b64_tr_b16 v[120:121], v245 offset:192
  v_mfma_f32_16x16x32_bf16 v[84:87], v[168:171], v[172:175], v[84:87]
  ds_read_b64_tr_b16 v[122:123], v245 offset:448
  v_mfma_f32_16x16x32_bf16 v[88:91], v[168:171], v[176:179], v[88:91]
  ds_read_b64_tr_b16 v[124:125], v245 offset:224
  v_mfma_f32_16x16x32_bf16 v[92:95], v[168:171], v[180:183], v[92:95]
  ds_read_b64_tr_b16 v[126:127], v245 offset:480
  s_waitcnt lgkmcnt(0)
  s_barrier
  v_mfma_f32_16x16x32_bf16 v[0:3], v[96:99], v[184:187], v[0:3]
  ds_read_b64_tr_b16 v[140:141], v245 offset:16896
  v_mfma_f32_16x16x32_bf16 v[4:7], v[96:99], v[188:191], v[4:7]
  v_mfma_f32_16x16x32_bf16 v[8:11], v[96:99], v[192:195], v[8:11]
  ds_read_b64_tr_b16 v[142:143], v245 offset:17152
  v_mfma_f32_16x16x32_bf16 v[12:15], v[100:103], v[184:187], v[12:15]
  ds_read_b64_tr_b16 v[144:145], v245 offset:16928
  v_mfma_f32_16x16x32_bf16 v[16:19], v[100:103], v[188:191], v[16:19]
  v_mfma_f32_16x16x32_bf16 v[20:23], v[100:103], v[192:195], v[20:23]
  ds_read_b64_tr_b16 v[146:147], v245 offset:17184
  v_mfma_f32_16x16x32_bf16 v[24:27], v[104:107], v[184:187], v[24:27]
  ds_read_b64_tr_b16 v[148:149], v245 offset:16960
  v_mfma_f32_16x16x32_bf16 v[28:31], v[104:107], v[188:191], v[28:31]
  v_mfma_f32_16x16x32_bf16 v[32:35], v[104:107], v[192:195], v[32:35]
  ds_read_b64_tr_b16 v[150:151], v245 offset:17216
  v_mfma_f32_16x16x32_bf16 v[36:39], v[108:111], v[184:187], v[36:39]
  ds_read_b64_tr_b16 v[152:153], v245 offset:16992
  v_mfma_f32_16x16x32_bf16 v[40:43], v[108:111], v[188:191], v[40:43]
  v_mfma_f32_16x16x32_bf16 v[44:47], v[108:111], v[192:195], v[44:47]
  ds_read_b64_tr_b16 v[154:155], v245 offset:17248
  v_mfma_f32_16x16x32_bf16 v[48:51], v[112:115], v[184:187], v[48:51]
  ds_read_b64_tr_b16 v[156:157], v245 offset:17024
  v_mfma_f32_16x16x32_bf16 v[52:55], v[112:115], v[188:191], v[52:55]
  v_mfma_f32_16x16x32_bf16 v[56:59], v[112:115], v[192:195], v[56:59]
  ds_read_b64_tr_b16 v[158:159], v245 offset:17280
  v_mfma_f32_16x16x32_bf16 v[60:63], v[116:119], v[184:187], v[60:63]
  ds_read_b64_tr_b16 v[160:161], v245 offset:17056
  v_mfma_f32_16x16x32_bf16 v[64:67], v[116:119], v[188:191], v[64:67]
  v_mfma_f32_16x16x32_bf16 v[68:71], v[116:119], v[192:195], v[68:71]
  ds_read_b64_tr_b16 v[162:163], v245 offset:17312
  v_mfma_f32_16x16x32_bf16 v[72:75], v[120:123], v[184:187], v[72:75]
  ds_read_b64_tr_b16 v[164:165], v245 offset:17088
  v_mfma_f32_16x16x32_bf16 v[76:79], v[120:123], v[188:191], v[76:79]
  v_mfma_f32_16x16x32_bf16 v[80:83], v[120:123], v[192:195], v[80:83]
  ds_read_b64_tr_b16 v[166:167], v245 offset:17344
  v_mfma_f32_16x16x32_bf16 v[84:87], v[124:127], v[184:187], v[84:87]
  ds_read_b64_tr_b16 v[168:169], v245 offset:17120
  v_mfma_f32_16x16x32_bf16 v[88:91], v[124:127], v[188:191], v[88:91]
  v_mfma_f32_16x16x32_bf16 v[92:95], v[124:127], v[192:195], v[92:95]
  ds_read_b64_tr_b16 v[170:171], v245 offset:17376
  s_waitcnt lgkmcnt(0)
  s_barrier
  v_mfma_f32_16x16x32_bf16 v[0:3], v[140:143], v[196:199], v[0:3]
  ds_read_b128 v[128:131], v246 offset:0
  v_mfma_f32_16x16x32_bf16 v[4:7], v[140:143], v[200:203], v[4:7]
  ds_read_b128 v[132:135], v246 offset:2048
  v_mfma_f32_16x16x32_bf16 v[8:11], v[140:143], v[204:207], v[8:11]
  ds_read_b128 v[136:139], v246 offset:4096
  v_mfma_f32_16x16x32_bf16 v[12:15], v[144:147], v[196:199], v[12:15]
  ds_read_b128 v[172:175], v247 offset:0
  v_mfma_f32_16x16x32_bf16 v[16:19], v[144:147], v[200:203], v[16:19]
  ds_read_b128 v[176:179], v247 offset:2048
  v_mfma_f32_16x16x32_bf16 v[20:23], v[144:147], v[204:207], v[20:23]
  ds_read_b128 v[180:183], v247 offset:4096
  v_mfma_f32_16x16x32_bf16 v[24:27], v[148:151], v[196:199], v[24:27]
  v_mfma_f32_16x16x32_bf16 v[28:31], v[148:151], v[200:203], v[28:31]
  ds_read_b64_tr_b16 v[96:97], v244 offset:0
  v_mfma_f32_16x16x32_bf16 v[32:35], v[148:151], v[204:207], v[32:35]
  ds_read_b64_tr_b16 v[98:99], v244 offset:256
  v_mfma_f32_16x16x32_bf16 v[36:39], v[152:155], v[196:199], v[36:39]
  ds_read_b64_tr_b16 v[100:101], v244 offset:32
  v_mfma_f32_16x16x32_bf16 v[40:43], v[152:155], v[200:203], v[40:43]
  ds_read_b64_tr_b16 v[102:103], v244 offset:288
  v_mfma_f32_16x16x32_bf16 v[44:47], v[152:155], v[204:207], v[44:47]
  ds_read_b64_tr_b16 v[104:105], v244 offset:64
  v_mfma_f32_16x16x32_bf16 v[48:51], v[156:159], v[196:199], v[48:51]
  ds_read_b64_tr_b16 v[106:107], v244 offset:320
  v_mfma_f32_16x16x32_bf16 v[52:55], v[156:159], v[200:203], v[52:55]
  ds_read_b64_tr_b16 v[108:109], v244 offset:96
  v_mfma_f32_16x16x32_bf16 v[56:59], v[156:159], v[204:207], v[56:59]
  ds_read_b64_tr_b16 v[110:111], v244 offset:352
  v_mfma_f32_16x16x32_bf16 v[60:63], v[160:163], v[196:199], v[60:63]
  ds_read_b64_tr_b16 v[112:113], v244 offset:128
  v_mfma_f32_16x16x32_bf16 v[64:67], v[160:163], v[200:203], v[64:67]
  ds_read_b64_tr_b16 v[114:115], v244 offset:384
  v_mfma_f32_16x16x32_bf16 v[68:71], v[160:163], v[204:207], v[68:71]
  ds_read_b64_tr_b16 v[116:117], v244 offset:160
  v_mfma_f32_16x16x32_bf16 v[72:75], v[164:167], v[196:199], v[72:75]
  v_mfma_f32_16x16x32_bf16 v[76:79], v[164:167], v[200:203], v[76:79]
  ds_read_b64_tr_b16 v[118:119], v244 offset:416
  v_mfma_f32_16x16x32_bf16 v[80:83], v[164:167], v[204:207], v[80:83]
  ds_read_b64_tr_b16 v[120:121], v244 offset:192
  v_mfma_f32_16x16x32_bf16 v[84:87], v[168:171], v[196:199], v[84:87]
  ds_read_b64_tr_b16 v[122:123], v244 offset:448
  v_mfma_f32_16x16x32_bf16 v[88:91], v[168:171], v[200:203], v[88:91]
  ds_read_b64_tr_b16 v[124:125], v244 offset:224
  v_mfma_f32_16x16x32_bf16 v[92:95], v[168:171], v[204:207], v[92:95]
  ds_read_b64_tr_b16 v[126:127], v244 offset:480
  s_waitcnt lgkmcnt(0)
  s_barrier
  v_mfma_f32_16x16x32_bf16 v[0:3], v[96:99], v[128:131], v[0:3]
  ds_read_b64_tr_b16 v[140:141], v244 offset:16896
  v_mfma_f32_16x16x32_bf16 v[4:7], v[96:99], v[132:135], v[4:7]
  v_mfma_f32_16x16x32_bf16 v[8:11], v[96:99], v[136:139], v[8:11]
  ds_read_b64_tr_b16 v[142:143], v244 offset:17152
  v_mfma_f32_16x16x32_bf16 v[12:15], v[100:103], v[128:131], v[12:15]
  ds_read_b64_tr_b16 v[144:145], v244 offset:16928
  v_mfma_f32_16x16x32_bf16 v[16:19], v[100:103], v[132:135], v[16:19]
  v_mfma_f32_16x16x32_bf16 v[20:23], v[100:103], v[136:139], v[20:23]
  ds_read_b64_tr_b16 v[146:147], v244 offset:17184
  v_mfma_f32_16x16x32_bf16 v[24:27], v[104:107], v[128:131], v[24:27]
  ds_read_b64_tr_b16 v[148:149], v244 offset:16960
  v_mfma_f32_16x16x32_bf16 v[28:31], v[104:107], v[132:135], v[28:31]
  v_mfma_f32_16x16x32_bf16 v[32:35], v[104:107], v[136:139], v[32:35]
  ds_read_b64_tr_b16 v[150:151], v244 offset:17216
  v_mfma_f32_16x16x32_bf16 v[36:39], v[108:111], v[128:131], v[36:39]
  ds_read_b64_tr_b16 v[152:153], v244 offset:16992
  v_mfma_f32_16x16x32_bf16 v[40:43], v[108:111], v[132:135], v[40:43]
  v_mfma_f32_16x16x32_bf16 v[44:47], v[108:111], v[136:139], v[44:47]
  ds_read_b64_tr_b16 v[154:155], v244 offset:17248
  v_mfma_f32_16x16x32_bf16 v[48:51], v[112:115], v[128:131], v[48:51]
  ds_read_b64_tr_b16 v[156:157], v244 offset:17024
  v_mfma_f32_16x16x32_bf16 v[52:55], v[112:115], v[132:135], v[52:55]
  v_mfma_f32_16x16x32_bf16 v[56:59], v[112:115], v[136:139], v[56:59]
  ds_read_b64_tr_b16 v[158:159], v244 offset:17280
  v_mfma_f32_16x16x32_bf16 v[60:63], v[116:119], v[128:131], v[60:63]
  ds_read_b64_tr_b16 v[160:161], v244 offset:17056
  v_mfma_f32_16x16x32_bf16 v[64:67], v[116:119], v[132:135], v[64:67]
  v_mfma_f32_16x16x32_bf16 v[68:71], v[116:119], v[136:139], v[68:71]
  ds_read_b64_tr_b16 v[162:163], v244 offset:17312
  v_mfma_f32_16x16x32_bf16 v[72:75], v[120:123], v[128:131], v[72:75]
  ds_read_b64_tr_b16 v[164:165], v244 offset:17088
  v_mfma_f32_16x16x32_bf16 v[76:79], v[120:123], v[132:135], v[76:79]
  v_mfma_f32_16x16x32_bf16 v[80:83], v[120:123], v[136:139], v[80:83]
  ds_read_b64_tr_b16 v[166:167], v244 offset:17344
  v_mfma_f32_16x16x32_bf16 v[84:87], v[124:127], v[128:131], v[84:87]
  ds_read_b64_tr_b16 v[168:169], v244 offset:17120
  v_mfma_f32_16x16x32_bf16 v[88:91], v[124:127], v[132:135], v[88:91]
  v_mfma_f32_16x16x32_bf16 v[92:95], v[124:127], v[136:139], v[92:95]
  ds_read_b64_tr_b16 v[170:171], v244 offset:17376
  s_waitcnt lgkmcnt(0)
  v_mfma_f32_16x16x32_bf16 v[0:3], v[140:143], v[172:175], v[0:3]
  v_mfma_f32_16x16x32_bf16 v[4:7], v[140:143], v[176:179], v[4:7]
  v_mfma_f32_16x16x32_bf16 v[8:11], v[140:143], v[180:183], v[8:11]
  v_mfma_f32_16x16x32_bf16 v[12:15], v[144:147], v[172:175], v[12:15]
  v_mfma_f32_16x16x32_bf16 v[16:19], v[144:147], v[176:179], v[16:19]
  v_mfma_f32_16x16x32_bf16 v[20:23], v[144:147], v[180:183], v[20:23]
  v_mfma_f32_16x16x32_bf16 v[24:27], v[148:151], v[172:175], v[24:27]
  v_mfma_f32_16x16x32_bf16 v[28:31], v[148:151], v[176:179], v[28:31]
  s_nop 0
  v_pk_mul_f32 v[0:1], v[0:1], v[248:249]
  v_pk_mul_f32 v[2:3], v[2:3], v[248:249]
  s_nop 0
  v_pk_mul_f32 v[12:13], v[12:13], v[248:249]
  v_pk_mul_f32 v[14:15], v[14:15], v[248:249]
  v_cvt_pk_bf16_f32 v96, v0, v1
  v_cvt_pk_bf16_f32 v97, v2, v3
  v_cvt_pk_bf16_f32 v98, v12, v13
  v_cvt_pk_bf16_f32 v99, v14, v15
  v_pk_mul_f32 v[4:5], v[4:5], v[248:249]
  v_pk_mul_f32 v[6:7], v[6:7], v[248:249]
  v_pk_mul_f32 v[16:17], v[16:17], v[248:249]
  v_pk_mul_f32 v[18:19], v[18:19], v[248:249]
  v_cvt_pk_bf16_f32 v112, v4, v5
  v_cvt_pk_bf16_f32 v113, v6, v7
  v_cvt_pk_bf16_f32 v114, v16, v17
  v_cvt_pk_bf16_f32 v115, v18, v19
  v_pk_mul_f32 v[8:9], v[8:9], v[248:249]
  v_pk_mul_f32 v[10:11], v[10:11], v[248:249]
  v_pk_mul_f32 v[20:21], v[20:21], v[248:249]
  v_pk_mul_f32 v[22:23], v[22:23], v[248:249]
  v_cvt_pk_bf16_f32 v128, v8, v9
  v_cvt_pk_bf16_f32 v129, v10, v11
  v_cvt_pk_bf16_f32 v130, v20, v21
  v_cvt_pk_bf16_f32 v131, v22, v23
  v_permlane32_swap_b32 v96, v98
  v_permlane32_swap_b32 v97, v99
  v_permlane32_swap_b32 v112, v114
  v_permlane32_swap_b32 v113, v115
  v_permlane32_swap_b32 v128, v130
  v_permlane32_swap_b32 v129, v131
  v_permlane16_swap_b32 v96, v98
  v_permlane16_swap_b32 v97, v99
  v_permlane16_swap_b32 v112, v114
  v_permlane16_swap_b32 v113, v115
  v_permlane16_swap_b32 v128, v130
  v_permlane16_swap_b32 v129, v131
  v_mfma_f32_16x16x32_bf16 v[32:35], v[148:151], v[180:183], v[32:35]
  v_mfma_f32_16x16x32_bf16 v[36:39], v[152:155], v[172:175], v[36:39]
  v_mfma_f32_16x16x32_bf16 v[40:43], v[152:155], v[176:179], v[40:43]
  v_mfma_f32_16x16x32_bf16 v[44:47], v[152:155], v[180:183], v[44:47]
  v_mfma_f32_16x16x32_bf16 v[48:51], v[156:159], v[172:175], v[48:51]
  v_mfma_f32_16x16x32_bf16 v[52:55], v[156:159], v[176:179], v[52:55]
  v_pk_mul_f32 v[24:25], v[24:25], v[248:249]
  v_pk_mul_f32 v[26:27], v[26:27], v[248:249]
  s_nop 1
  v_pk_mul_f32 v[36:37], v[36:37], v[248:249]
  v_pk_mul_f32 v[38:39], v[38:39], v[248:249]
  v_cvt_pk_bf16_f32 v100, v24, v25
  v_cvt_pk_bf16_f32 v101, v26, v27
  v_cvt_pk_bf16_f32 v102, v36, v37
  v_cvt_pk_bf16_f32 v103, v38, v39
  v_pk_mul_f32 v[28:29], v[28:29], v[248:249]
  v_pk_mul_f32 v[30:31], v[30:31], v[248:249]
  v_pk_mul_f32 v[40:41], v[40:41], v[248:249]
  v_pk_mul_f32 v[42:43], v[42:43], v[248:249]
  v_cvt_pk_bf16_f32 v116, v28, v29
  v_cvt_pk_bf16_f32 v117, v30, v31
  v_cvt_pk_bf16_f32 v118, v40, v41
  v_cvt_pk_bf16_f32 v119, v42, v43
  v_pk_mul_f32 v[32:33], v[32:33], v[248:249]
  v_pk_mul_f32 v[34:35], v[34:35], v[248:249]
  v_pk_mul_f32 v[44:45], v[44:45], v[248:249]
  v_pk_mul_f32 v[46:47], v[46:47], v[248:249]
  v_cvt_pk_bf16_f32 v132, v32, v33
  v_cvt_pk_bf16_f32 v133, v34, v35
  v_cvt_pk_bf16_f32 v134, v44, v45
  v_cvt_pk_bf16_f32 v135, v46, v47
  v_permlane32_swap_b32 v100, v102
  v_permlane32_swap_b32 v101, v103
  v_permlane32_swap_b32 v116, v118
  v_permlane32_swap_b32 v117, v119
  v_permlane32_swap_b32 v132, v134
  v_permlane32_swap_b32 v133, v135
  v_permlane16_swap_b32 v100, v102
  v_permlane16_swap_b32 v101, v103
  v_permlane16_swap_b32 v116, v118
  v_permlane16_swap_b32 v117, v119
  v_permlane16_swap_b32 v132, v134
  v_permlane16_swap_b32 v133, v135
  v_mfma_f32_16x16x32_bf16 v[56:59], v[156:159], v[180:183], v[56:59]
  v_mfma_f32_16x16x32_bf16 v[60:63], v[160:163], v[172:175], v[60:63]
  v_mfma_f32_16x16x32_bf16 v[64:67], v[160:163], v[176:179], v[64:67]
  v_mfma_f32_16x16x32_bf16 v[68:71], v[160:163], v[180:183], v[68:71]
  v_mfma_f32_16x16x32_bf16 v[72:75], v[164:167], v[172:175], v[72:75]
  v_mfma_f32_16x16x32_bf16 v[76:79], v[164:167], v[176:179], v[76:79]
  v_pk_mul_f32 v[48:49], v[48:49], v[248:249]
  v_pk_mul_f32 v[50:51], v[50:51], v[248:249]
  s_nop 1
  v_pk_mul_f32 v[60:61], v[60:61], v[248:249]
  v_pk_mul_f32 v[62:63], v[62:63], v[248:249]
  v_cvt_pk_bf16_f32 v104, v48, v49
  v_cvt_pk_bf16_f32 v105, v50, v51
  v_cvt_pk_bf16_f32 v106, v60, v61
  v_cvt_pk_bf16_f32 v107, v62, v63
  v_pk_mul_f32 v[52:53], v[52:53], v[248:249]
  v_pk_mul_f32 v[54:55], v[54:55], v[248:249]
  v_pk_mul_f32 v[64:65], v[64:65], v[248:249]
  v_pk_mul_f32 v[66:67], v[66:67], v[248:249]
  v_cvt_pk_bf16_f32 v120, v52, v53
  v_cvt_pk_bf16_f32 v121, v54, v55
  v_cvt_pk_bf16_f32 v122, v64, v65
  v_cvt_pk_bf16_f32 v123, v66, v67
  v_pk_mul_f32 v[56:57], v[56:57], v[248:249]
  v_pk_mul_f32 v[58:59], v[58:59], v[248:249]
  v_pk_mul_f32 v[68:69], v[68:69], v[248:249]
  v_pk_mul_f32 v[70:71], v[70:71], v[248:249]
  v_cvt_pk_bf16_f32 v136, v56, v57
  v_cvt_pk_bf16_f32 v137, v58, v59
  v_cvt_pk_bf16_f32 v138, v68, v69
  v_cvt_pk_bf16_f32 v139, v70, v71
  v_permlane32_swap_b32 v104, v106
  v_permlane32_swap_b32 v105, v107
  v_permlane32_swap_b32 v120, v122
  v_permlane32_swap_b32 v121, v123
  v_permlane32_swap_b32 v136, v138
  v_permlane32_swap_b32 v137, v139
  v_permlane16_swap_b32 v104, v106
  v_permlane16_swap_b32 v105, v107
  v_permlane16_swap_b32 v120, v122
  v_permlane16_swap_b32 v121, v123
  v_permlane16_swap_b32 v136, v138
  v_permlane16_swap_b32 v137, v139
  v_mfma_f32_16x16x32_bf16 v[80:83], v[164:167], v[180:183], v[80:83]
  v_mfma_f32_16x16x32_bf16 v[84:87], v[168:171], v[172:175], v[84:87]
  v_mfma_f32_16x16x32_bf16 v[88:91], v[168:171], v[176:179], v[88:91]
  v_mfma_f32_16x16x32_bf16 v[92:95], v[168:171], v[180:183], v[92:95]
  v_pk_mul_f32 v[72:73], v[72:73], v[248:249]
  v_pk_mul_f32 v[74:75], v[74:75], v[248:249]
  s_nop 3
  v_pk_mul_f32 v[84:85], v[84:85], v[248:249]
  v_pk_mul_f32 v[86:87], v[86:87], v[248:249]
  v_cvt_pk_bf16_f32 v108, v72, v73
  v_cvt_pk_bf16_f32 v109, v74, v75
  v_cvt_pk_bf16_f32 v110, v84, v85
  v_cvt_pk_bf16_f32 v111, v86, v87
  v_pk_mul_f32 v[76:77], v[76:77], v[248:249]
  v_pk_mul_f32 v[78:79], v[78:79], v[248:249]
  v_pk_mul_f32 v[88:89], v[88:89], v[248:249]
  v_pk_mul_f32 v[90:91], v[90:91], v[248:249]
  v_cvt_pk_bf16_f32 v124, v76, v77
  v_cvt_pk_bf16_f32 v125, v78, v79
  v_cvt_pk_bf16_f32 v126, v88, v89
  v_cvt_pk_bf16_f32 v127, v90, v91
  v_pk_mul_f32 v[80:81], v[80:81], v[248:249]
  v_pk_mul_f32 v[82:83], v[82:83], v[248:249]
  v_pk_mul_f32 v[92:93], v[92:93], v[248:249]
  v_pk_mul_f32 v[94:95], v[94:95], v[248:249]
  v_cvt_pk_bf16_f32 v140, v80, v81
  v_cvt_pk_bf16_f32 v141, v82, v83
  v_cvt_pk_bf16_f32 v142, v92, v93
  v_cvt_pk_bf16_f32 v143, v94, v95
  v_permlane32_swap_b32 v108, v110
  v_permlane32_swap_b32 v109, v111
  v_permlane32_swap_b32 v124, v126
  v_permlane32_swap_b32 v125, v127
  v_permlane32_swap_b32 v140, v142
  v_permlane32_swap_b32 v141, v143
  v_permlane16_swap_b32 v108, v110
  v_permlane16_swap_b32 v109, v111
  v_permlane16_swap_b32 v124, v126
  v_permlane16_swap_b32 v125, v127
  v_permlane16_swap_b32 v140, v142
  v_permlane16_swap_b32 v141, v143
  s_waitcnt vmcnt(0) lgkmcnt(0)
  s_barrier
  ds_read_b128 v[220:223], v236 offset:0
  ds_read_b128 v[224:227], v236 offset:64
  ds_read_b128 v[228:231], v236 offset:128
  ds_read_b128 v[232:235], v236 offset:192
  ds_read_b128 v[244:247], v236 offset:512
  ds_read_b128 v[248:251], v236 offset:576
  s_waitcnt lgkmcnt(5)
  v_mfma_f32_16x16x32_bf16 v[144:147], v[220:223], v[96:99], 0
  v_mfma_f32_16x16x32_bf16 v[152:155], v[220:223], v[112:115], 0
  v_mfma_f32_16x16x32_bf16 v[160:163], v[220:223], v[128:131], 0
  ds_read_b128 v[220:223], v236 offset:640
  s_waitcnt lgkmcnt(5)
  v_mfma_f32_16x16x32_bf16 v[144:147], v[224:227], v[100:103], v[144:147]
  v_mfma_f32_16x16x32_bf16 v[152:155], v[224:227], v[116:119], v[152:155]
  v_mfma_f32_16x16x32_bf16 v[160:163], v[224:227], v[132:135], v[160:163]
  ds_read_b128 v[224:227], v236 offset:704
  s_waitcnt lgkmcnt(5)
  v_mfma_f32_16x16x32_bf16 v[144:147], v[228:231], v[104:107], v[144:147]
  v_mfma_f32_16x16x32_bf16 v[152:155], v[228:231], v[120:123], v[152:155]
  v_mfma_f32_16x16x32_bf16 v[160:163], v[228:231], v[136:139], v[160:163]
  s_waitcnt lgkmcnt(4)
  v_mfma_f32_16x16x32_bf16 v[144:147], v[232:235], v[108:111], v[144:147]
  v_mfma_f32_16x16x32_bf16 v[152:155], v[232:235], v[124:127], v[152:155]
  v_mfma_f32_16x16x32_bf16 v[160:163], v[232:235], v[140:143], v[160:163]
  s_waitcnt lgkmcnt(3)
  v_mfma_f32_16x16x32_bf16 v[148:151], v[244:247], v[96:99], 0
  v_mfma_f32_16x16x32_bf16 v[156:159], v[244:247], v[112:115], 0
  v_mfma_f32_16x16x32_bf16 v[164:167], v[244:247], v[128:131], 0
  s_waitcnt lgkmcnt(2)
  v_mfma_f32_16x16x32_bf16 v[148:151], v[248:251], v[100:103], v[148:151]
  v_mfma_f32_16x16x32_bf16 v[156:159], v[248:251], v[116:119], v[156:159]
  v_mfma_f32_16x16x32_bf16 v[164:167], v[248:251], v[132:135], v[164:167]
  s_waitcnt lgkmcnt(1)
  v_mfma_f32_16x16x32_bf16 v[148:151], v[220:223], v[104:107], v[148:151]
  v_mfma_f32_16x16x32_bf16 v[156:159], v[220:223], v[120:123], v[156:159]
  v_mfma_f32_16x16x32_bf16 v[164:167], v[220:223], v[136:139], v[164:167]
  s_waitcnt lgkmcnt(0)
  v_mfma_f32_16x16x32_bf16 v[148:151], v[224:227], v[108:111], v[148:151]
  v_mfma_f32_16x16x32_bf16 v[156:159], v[224:227], v[124:127], v[156:159]
  v_mfma_f32_16x16x32_bf16 v[164:167], v[224:227], v[140:143], v[164:167]
  ds_read_b128 v[220:223], v237 offset:0
  ds_read_b128 v[224:227], v237 offset:64
  ds_read_b128 v[228:231], v237 offset:128
  ds_read_b128 v[232:235], v237 offset:192
  v_max3_f32 v238, v144, v145, v146
  v_max3_f32 v239, v152, v153, v154
  v_max3_f32 v240, v160, v161, v162
  v_max3_f32 v238, v238, v147, v148
  v_max3_f32 v239, v239, v155, v156
  v_max3_f32 v240, v240, v163, v164
  v_max3_f32 v238, v238, v149, v150
  v_max3_f32 v239, v239, v157, v158
  v_max3_f32 v240, v240, v165, v166
  v_max_f32 v238, v238, v151
  v_max_f32 v239, v239, v159
  v_max_f32 v240, v240, v167
  v_mov_b32 v241, v238
  s_nop 1
  v_permlane32_swap_b32 v238, v241
  v_max_f32 v238, v238, v241
  v_mov_b32 v241, v238
  s_nop 1
  v_permlane16_swap_b32 v238, v241
  v_max_f32 v238, v238, v241
  v_sub_f32 v144, v144, v238
  v_sub_f32 v145, v145, v238
  v_sub_f32 v146, v146, v238
  v_sub_f32 v147, v147, v238
  v_sub_f32 v148, v148, v238
  v_sub_f32 v149, v149, v238
  v_sub_f32 v150, v150, v238
  v_sub_f32 v151, v151, v238
  v_sub_f32 v192, 0, v238
  v_sub_f32 v193, 0, v238
  v_sub_f32 v194, 0, v238
  v_sub_f32 v195, 0, v238
  v_mov_b32 v241, v239
  s_nop 1
  v_permlane32_swap_b32 v239, v241
  v_max_f32 v239, v239, v241
  v_mov_b32 v241, v239
  s_nop 1
  v_permlane16_swap_b32 v239, v241
  v_max_f32 v239, v239, v241
  v_sub_f32 v152, v152, v239
  v_sub_f32 v153, v153, v239
  v_sub_f32 v154, v154, v239
  v_sub_f32 v155, v155, v239
  v_sub_f32 v156, v156, v239
  v_sub_f32 v157, v157, v239
  v_sub_f32 v158, v158, v239
  v_sub_f32 v159, v159, v239
  v_sub_f32 v196, 0, v239
  v_sub_f32 v197, 0, v239
  v_sub_f32 v198, 0, v239
  v_sub_f32 v199, 0, v239
  v_mov_b32 v241, v240
  s_nop 1
  v_permlane32_swap_b32 v240, v241
  v_max_f32 v240, v240, v241
  v_mov_b32 v241, v240
  s_nop 1
  v_permlane16_swap_b32 v240, v241
  v_max_f32 v240, v240, v241
  v_sub_f32 v160, v160, v240
  v_sub_f32 v161, v161, v240
  v_sub_f32 v162, v162, v240
  v_sub_f32 v163, v163, v240
  v_sub_f32 v164, v164, v240
  v_sub_f32 v165, v165, v240
  v_sub_f32 v166, v166, v240
  v_sub_f32 v167, v167, v240
  v_sub_f32 v200, 0, v240
  v_sub_f32 v201, 0, v240
  v_sub_f32 v202, 0, v240
  v_sub_f32 v203, 0, v240
  ds_read_b32 v241, v252 offset:256
  v_exp_f32 v144, v144
  v_exp_f32 v145, v145
  v_exp_f32 v146, v146
  v_exp_f32 v147, v147
  v_exp_f32 v148, v148
  v_exp_f32 v149, v149
  v_exp_f32 v150, v150
  v_exp_f32 v151, v151
  v_exp_f32 v152, v152
  v_exp_f32 v153, v153
  v_exp_f32 v154, v154
  v_exp_f32 v155, v155
  s_mov_b32 s64, 0
  s_mov_b32 s94, 3
  v_add_u32 v243, 8448, v242
  s_mov_b32 s68, -50688
  s_mov_b32 s69, -59136
  ds_add_u32 v252, v253
  v_mov_b32 v253, 2
  ds_read_b128 v[244:247], v237 offset:512
  ds_read_b128 v[248:251], v237 offset:576
  s_waitcnt lgkmcnt(6)
  s_waitcnt lgkmcnt(3)
  v_cmp_ge_u32 vcc, s64, v241
  s_mov_b32 s65, 0
  s_nop 0
  s_cbranch_vccnz L_stall1
L_go1:
  s_mov_b32 s64, 2
  v_mfma_f32_16x16x32_bf16 v[168:171], v[220:223], v[96:99], v[192:195]
  v_exp_f32 v156, v156
  v_mfma_f32_16x16x32_bf16 v[176:179], v[220:223], v[112:115], v[196:199]
  v_exp_f32 v157, v157
  v_mfma_f32_16x16x32_bf16 v[184:187], v[220:223], v[128:131], v[200:203]
  v_exp_f32 v158, v158
  v_mfma_f32_16x16x32_bf16 v[168:171], v[224:227], v[100:103], v[168:171]
  ds_read_b128 v[220:223], v237 offset:640
  v_exp_f32 v159, v159
  v_mfma_f32_16x16x32_bf16 v[176:179], v[224:227], v[116:119], v[176:179]
  v_cvt_pk_bf16_f32 v144, v144, v145
  v_mfma_f32_16x16x32_bf16 v[184:187], v[224:227], v[132:135], v[184:187]
  v_cvt_pk_bf16_f32 v145, v146, v147
  v_cvt_pk_bf16_f32 v146, v148, v149
  v_mfma_f32_16x16x32_bf16 v[168:171], v[228:231], v[104:107], v[168:171]
  ds_read_b128 v[224:227], v237 offset:704
  v_cvt_pk_bf16_f32 v147, v150, v151
  v_mfma_f32_16x16x32_bf16 v[176:179], v[228:231], v[120:123], v[176:179]
  v_exp_f32 v160, v160
  v_mfma_f32_16x16x32_bf16 v[184:187], v[228:231], v[136:139], v[184:187]
  v_exp_f32 v161, v161
  v_mfma_f32_16x16x32_bf16 v[168:171], v[232:235], v[108:111], v[168:171]
  ds_read_b64_tr_b16 v[228:229], v242 offset:0
  ds_read_b64_tr_b16 v[230:231], v242 offset:512
  v_mfma_f32_16x16x32_bf16 v[176:179], v[232:235], v[124:127], v[176:179]
  v_exp_f32 v162, v162
  v_mfma_f32_16x16x32_bf16 v[184:187], v[232:235], v[140:143], v[184:187]
  v_exp_f32 v163, v163
  s_waitcnt lgkmcnt(4)
  v_mfma_f32_16x16x32_bf16 v[172:175], v[244:247], v[96:99], v[192:195]
  ds_read_b64_tr_b16 v[232:233], v242 offset:32
  ds_read_b64_tr_b16 v[234:235], v242 offset:544
  v_mfma_f32_16x16x32_bf16 v[180:183], v[244:247], v[112:115], v[196:199]
  v_cvt_pk_bf16_f32 v152, v152, v153
  v_cvt_pk_bf16_f32 v153, v154, v155
  v_mfma_f32_16x16x32_bf16 v[188:191], v[244:247], v[128:131], v[200:203]
  v_cvt_pk_bf16_f32 v154, v156, v157
  v_cvt_pk_bf16_f32 v155, v158, v159
  v_mfma_f32_16x16x32_bf16 v[172:175], v[248:251], v[100:103], v[172:175]
  ds_read_b64_tr_b16 v[244:245], v242 offset:64
  ds_read_b64_tr_b16 v[246:247], v242 offset:576
  v_mfma_f32_16x16x32_bf16 v[180:183], v[248:251], v[116:119], v[180:183]
  v_exp_f32 v164, v164
  v_mfma_f32_16x16x32_bf16 v[188:191], v[248:251], v[132:135], v[188:191]
  v_exp_f32 v165, v165
  s_waitcnt lgkmcnt(6)
  v_mfma_f32_16x16x32_bf16 v[172:175], v[220:223], v[104:107], v[172:175]
  ds_read_b64_tr_b16 v[248:249], v242 offset:224
  ds_read_b64_tr_b16 v[250:251], v242 offset:736
  v_mfma_f32_16x16x32_bf16 v[180:183], v[220:223], v[120:123], v[180:183]
  v_exp_f32 v166, v166
  v_mfma_f32_16x16x32_bf16 v[188:191], v[220:223], v[136:139], v[188:191]
  v_exp_f32 v167, v167
  v_mfma_f32_16x16x32_bf16 v[172:175], v[224:227], v[108:111], v[172:175]
  ds_read_b64_tr_b16 v[220:221], v242 offset:96
  ds_read_b64_tr_b16 v[222:223], v242 offset:608
  v_mfma_f32_16x16x32_bf16 v[180:183], v[224:227], v[124:127], v[180:183]
  v_cvt_pk_bf16_f32 v160, v160, v161
  v_cvt_pk_bf16_f32 v161, v162, v163
  v_mfma_f32_16x16x32_bf16 v[188:191], v[224:227], v[140:143], v[188:191]
  v_cvt_pk_bf16_f32 v162, v164, v165
  v_cvt_pk_bf16_f32 v163, v166, v167
  v_mfma_f32_16x16x32_bf16 v[204:207], v[216:219], v[144:147], 0
  ds_read_b64_tr_b16 v[224:225], v242 offset:128
  ds_read_b64_tr_b16 v[226:227], v242 offset:640
  v_mfma_f32_16x16x32_bf16 v[208:211], v[216:219], v[152:155], 0
  v_max3_f32 v238, v168, v169, v170
  v_max3_f32 v239, v171, v176, v177
  v_mfma_f32_16x16x32_bf16 v[212:215], v[216:219], v[160:163], 0
  v_max3_f32 v238, v238, v178, v179
  v_max3_f32 v239, v239, v184, v185
  s_waitcnt lgkmcnt(8)
  v_mfma_f32_16x16x32_bf16 v[0:3], v[228:231], v[144:147], 0
  v_max3_f32 v238, v238, v186, v187
  v_max3_f32 v239, v239, v174, v175
  v_mfma_f32_16x16x32_bf16 v[4:7], v[228:231], v[152:155], 0
  v_max3_f32 v238, v238, v172, v173
  v_mfma_f32_16x16x32_bf16 v[8:11], v[228:231], v[160:163], 0
  v_max3_f32 v239, v239, v182, v183
  v_max3_f32 v238, v238, v180, v181
  v_mfma_f32_16x16x32_bf16 v[12:15], v[232:235], v[144:147], 0
  ds_read_b64_tr_b16 v[228:229], v242 offset:160
  ds_read_b64_tr_b16 v[230:231], v242 offset:672
  v_mfma_f32_16x16x32_bf16 v[16:19], v[232:235], v[152:155], 0
  v_max3_f32 v239, v239, v188, v189
  v_max3_f32 v239, v239, v190, v191
  v_mfma_f32_16x16x32_bf16 v[20:23], v[232:235], v[160:163], 0
  v_max_f32 v241, v238, v239
  v_cmp_lt_f32 vcc, 0x41000000, v241
  s_waitcnt lgkmcnt(4)
  v_mfma_f32_16x16x32_bf16 v[24:27], v[244:247], v[144:147], 0
  ds_read_b64_tr_b16 v[232:233], v242 offset:192
  ds_read_b64_tr_b16 v[234:235], v242 offset:704
  v_mfma_f32_16x16x32_bf16 v[28:31], v[244:247], v[152:155], 0
  s_cbranch_vccnz L_rare1
L_back1:
  v_mfma_f32_16x16x32_bf16 v[32:35], v[244:247], v[160:163], 0
  v_add_u32 v236, 16896, v236
  v_add_u32 v242, 16896, v242
  v_mfma_f32_16x16x32_bf16 v[36:39], v[220:223], v[144:147], 0
  v_exp_f32 v168, v168
  ds_read_b32 v241, v252 offset:256
  v_mfma_f32_16x16x32_bf16 v[40:43], v[220:223], v[152:155], 0
  v_exp_f32 v169, v169
  v_mfma_f32_16x16x32_bf16 v[44:47], v[220:223], v[160:163], 0
  v_exp_f32 v170, v170
  s_waitcnt lgkmcnt(3)
  v_mfma_f32_16x16x32_bf16 v[48:51], v[224:227], v[144:147], 0
  ds_read_b128 v[220:223], v236 offset:0
  v_mfma_f32_16x16x32_bf16 v[52:55], v[224:227], v[152:155], 0
  v_exp_f32 v171, v171
  v_mfma_f32_16x16x32_bf16 v[56:59], v[224:227], v[160:163], 0
  v_exp_f32 v172, v172
  v_mfma_f32_16x16x32_bf16 v[60:63], v[228:231], v[144:147], 0
  ds_read_b128 v[224:227], v236 offset:64
  v_mfma_f32_16x16x32_bf16 v[64:67], v[228:231], v[152:155], 0
  v_exp_f32 v173, v173
  v_mfma_f32_16x16x32_bf16 v[68:71], v[228:231], v[160:163], 0
  v_exp_f32 v174, v174
  s_waitcnt lgkmcnt(3)
  v_mfma_f32_16x16x32_bf16 v[72:75], v[232:235], v[144:147], 0
  ds_read_b128 v[228:231], v236 offset:128
  v_exp_f32 v175, v175
  v_mfma_f32_16x16x32_bf16 v[76:79], v[232:235], v[152:155], 0
  v_exp_f32 v176, v176
  v_mfma_f32_16x16x32_bf16 v[80:83], v[232:235], v[160:163], 0
  v_exp_f32 v177, v177
  v_mfma_f32_16x16x32_bf16 v[84:87], v[248:251], v[144:147], 0
  ds_read_b128 v[232:235], v236 offset:192
  v_mfma_f32_16x16x32_bf16 v[88:91], v[248:251], v[152:155], 0
  v_exp_f32 v178, v178
  v_mfma_f32_16x16x32_bf16 v[92:95], v[248:251], v[160:163], 0
  v_exp_f32 v179, v179
  s_cmp_lg_u32 s60, 0
  s_cbranch_scc1 L_resc1
L_rback1:
  s_mov_b32 s55, 14
L_loop:
  s_add_u32 s94, s94, 1
  s_and_b32 s94, s94, 3
  s_cmp_eq_u32 s94, 3
  s_cselect_b32 s95, s68, 16896
  s_cmp_eq_u32 s94, 2
  s_cselect_b32 s3, s68, 16896
  ds_read_b128 v[244:247], v236 offset:512
  ds_read_b128 v[248:251], v236 offset:576
  s_waitcnt lgkmcnt(4)
  v_cmp_ge_u32 vcc, s64, v241
  s_nop 1
  s_cbranch_vccnz L_stall2
L_go2:
  v_mfma_f32_16x16x32_bf16 v[144:147], v[220:223], v[96:99], v[192:195]
  v_exp_f32 v180, v180
  v_mfma_f32_16x16x32_bf16 v[152:155], v[220:223], v[112:115], v[196:199]
  v_exp_f32 v181, v181
  v_mfma_f32_16x16x32_bf16 v[160:163], v[220:223], v[128:131], v[200:203]
  v_exp_f32 v182, v182
  v_mfma_f32_16x16x32_bf16 v[144:147], v[224:227], v[100:103], v[144:147]
  ds_read_b128 v[220:223], v236 offset:640
  v_exp_f32 v183, v183
  v_mfma_f32_16x16x32_bf16 v[152:155], v[224:227], v[116:119], v[152:155]
  v_cvt_pk_bf16_f32 v168, v168, v169
  v_mfma_f32_16x16x32_bf16 v[160:163], v[224:227], v[132:135], v[160:163]
  v_cvt_pk_bf16_f32 v169, v170, v171
  v_cvt_pk_bf16_f32 v170, v172, v173
  s_waitcnt lgkmcnt(3)
  v_mfma_f32_16x16x32_bf16 v[144:147], v[228:231], v[104:107], v[144:147]
  ds_read_b128 v[224:227], v236 offset:704
  v_cvt_pk_bf16_f32 v171, v174, v175
  v_mfma_f32_16x16x32_bf16 v[152:155], v[228:231], v[120:123], v[152:155]
  v_exp_f32 v184, v184
  v_mfma_f32_16x16x32_bf16 v[160:163], v[228:231], v[136:139], v[160:163]
  v_exp_f32 v185, v185
  v_mfma_f32_16x16x32_bf16 v[144:147], v[232:235], v[108:111], v[144:147]
  ds_read_b64_tr_b16 v[228:229], v243 offset:0
  ds_read_b64_tr_b16 v[230:231], v243 offset:512
  v_mfma_f32_16x16x32_bf16 v[152:155], v[232:235], v[124:127], v[152:155]
  v_exp_f32 v186, v186
  v_mfma_f32_16x16x32_bf16 v[160:163], v[232:235], v[140:143], v[160:163]
  v_exp_f32 v187, v187
  s_waitcnt lgkmcnt(4)
  v_mfma_f32_16x16x32_bf16 v[148:151], v[244:247], v[96:99], v[192:195]
  ds_read_b64_tr_b16 v[232:233], v243 offset:32
  ds_read_b64_tr_b16 v[234:235], v243 offset:544
  v_mfma_f32_16x16x32_bf16 v[156:159], v[244:247], v[112:115], v[196:199]
  v_cvt_pk_bf16_f32 v176, v176, v177
  v_cvt_pk_bf16_f32 v177, v178, v179
  v_mfma_f32_16x16x32_bf16 v[164:167], v[244:247], v[128:131], v[200:203]
  v_cvt_pk_bf16_f32 v178, v180, v181
  v_cvt_pk_bf16_f32 v179, v182, v183
  v_mfma_f32_16x16x32_bf16 v[148:151], v[248:251], v[100:103], v[148:151]
  ds_read_b64_tr_b16 v[244:245], v243 offset:64
  ds_read_b64_tr_b16 v[246:247], v243 offset:576
  v_mfma_f32_16x16x32_bf16 v[156:159], v[248:251], v[116:119], v[156:159]
  v_exp_f32 v188, v188
  v_mfma_f32_16x16x32_bf16 v[164:167], v[248:251], v[132:135], v[164:167]
  v_exp_f32 v189, v189
  s_waitcnt lgkmcnt(6)
  v_mfma_f32_16x16x32_bf16 v[148:151], v[220:223], v[104:107], v[148:151]
  ds_read_b64_tr_b16 v[248:249], v243 offset:224
  ds_read_b64_tr_b16 v[250:251], v243 offset:736
  v_mfma_f32_16x16x32_bf16 v[156:159], v[220:223], v[120:123], v[156:159]
  v_exp_f32 v190, v190
  v_mfma_f32_16x16x32_bf16 v[164:167], v[220:223], v[136:139], v[164:167]
  v_exp_f32 v191, v191
  v_mfma_f32_16x16x32_bf16 v[148:151], v[224:227], v[108:111], v[148:151]
  ds_read_b64_tr_b16 v[220:221], v243 offset:96
  ds_read_b64_tr_b16 v[222:223], v243 offset:608
  v_mfma_f32_16x16x32_bf16 v[156:159], v[224:227], v[124:127], v[156:159]
  v_cvt_pk_bf16_f32 v184, v184, v185
  v_cvt_pk_bf16_f32 v185, v186, v187
  v_mfma_f32_16x16x32_bf16 v[164:167], v[224:227], v[140:143], v[164:167]
  v_cvt_pk_bf16_f32 v186, v188, v189
  v_cvt_pk_bf16_f32 v187, v190, v191
  v_mfma_f32_16x16x32_bf16 v[204:207], v[216:219], v[168:171], v[204:207]
  ds_read_b64_tr_b16 v[224:225], v243 offset:128
  ds_read_b64_tr_b16 v[226:227], v243 offset:640
  v_mfma_f32_16x16x32_bf16 v[208:211], v[216:219], v[176:179], v[208:211]
  v_max3_f32 v238, v144, v145, v146
  v_max3_f32 v239, v147, v152, v153
  v_mfma_f32_16x16x32_bf16 v[212:215], v[216:219], v[184:187], v[212:215]
  v_max3_f32 v238, v238, v154, v155
  v_max3_f32 v239, v239, v160, v161
  s_waitcnt lgkmcnt(8)
  v_mfma_f32_16x16x32_bf16 v[0:3], v[228:231], v[168:171], v[0:3]
  v_max3_f32 v238, v238, v162, v163
  v_mfma_f32_16x16x32_bf16 v[4:7], v[228:231], v[176:179], v[4:7]
  v_max3_f32 v239, v239, v150, v151
  v_max3_f32 v238, v238, v148, v149
  v_mfma_f32_16x16x32_bf16 v[8:11], v[228:231], v[184:187], v[8:11]
  v_max3_f32 v239, v239, v158, v159
  v_max3_f32 v238, v238, v156, v157
  v_mfma_f32_16x16x32_bf16 v[12:15], v[232:235], v[168:171], v[12:15]
  ds_read_b64_tr_b16 v[228:229], v243 offset:160
  ds_read_b64_tr_b16 v[230:231], v243 offset:672
  v_mfma_f32_16x16x32_bf16 v[16:19], v[232:235], v[176:179], v[16:19]
  v_max3_f32 v239, v239, v164, v165
  v_max3_f32 v239, v239, v166, v167
  v_mfma_f32_16x16x32_bf16 v[20:23], v[232:235], v[184:187], v[20:23]
  v_max_f32 v241, v238, v239
  v_cmp_lt_f32 vcc, 0x41000000, v241
  s_waitcnt lgkmcnt(4)
  v_mfma_f32_16x16x32_bf16 v[24:27], v[244:247], v[168:171], v[24:27]
  ds_read_b64_tr_b16 v[232:233], v243 offset:192
  ds_read_b64_tr_b16 v[234:235], v243 offset:704
  v_mfma_f32_16x16x32_bf16 v[28:31], v[244:247], v[176:179], v[28:31]
  s_cbranch_vccnz L_rare2
L_back2:
  v_mfma_f32_16x16x32_bf16 v[32:35], v[244:247], v[184:187], v[32:35]
  v_add_u32 v237, s95, v237
  v_add_u32 v243, s95, v243
  v_mfma_f32_16x16x32_bf16 v[36:39], v[220:223], v[168:171], v[36:39]
  v_exp_f32 v144, v144
  v_mfma_f32_16x16x32_bf16 v[40:43], v[220:223], v[176:179], v[40:43]
  v_exp_f32 v145, v145
  v_mfma_f32_16x16x32_bf16 v[44:47], v[220:223], v[184:187], v[44:47]
  v_exp_f32 v146, v146
  s_waitcnt lgkmcnt(2)
  v_mfma_f32_16x16x32_bf16 v[48:51], v[224:227], v[168:171], v[48:51]
  ds_read_b128 v[220:223], v237 offset:0
  v_mfma_f32_16x16x32_bf16 v[52:55], v[224:227], v[176:179], v[52:55]
  v_exp_f32 v147, v147
  v_mfma_f32_16x16x32_bf16 v[56:59], v[224:227], v[184:187], v[56:59]
  v_exp_f32 v148, v148
  v_mfma_f32_16x16x32_bf16 v[60:63], v[228:231], v[168:171], v[60:63]
  ds_read_b128 v[224:227], v237 offset:64
  v_exp_f32 v149, v149
  v_mfma_f32_16x16x32_bf16 v[64:67], v[228:231], v[176:179], v[64:67]
  v_exp_f32 v150, v150
  v_mfma_f32_16x16x32_bf16 v[68:71], v[228:231], v[184:187], v[68:71]
  s_waitcnt lgkmcnt(2)
  v_mfma_f32_16x16x32_bf16 v[72:75], v[232:235], v[168:171], v[72:75]
  ds_read_b128 v[228:231], v237 offset:128
  v_exp_f32 v151, v151
  v_mfma_f32_16x16x32_bf16 v[76:79], v[232:235], v[176:179], v[76:79]
  v_exp_f32 v152, v152
  v_mfma_f32_16x16x32_bf16 v[80:83], v[232:235], v[184:187], v[80:83]
  v_exp_f32 v153, v153
  v_mfma_f32_16x16x32_bf16 v[84:87], v[248:251], v[168:171], v[84:87]
  ds_read_b128 v[232:235], v237 offset:192
  v_mfma_f32_16x16x32_bf16 v[88:91], v[248:251], v[176:179], v[88:91]
  v_exp_f32 v154, v154
  v_mfma_f32_16x16x32_bf16 v[92:95], v[248:251], v[184:187], v[92:95]
  v_exp_f32 v155, v155
  s_cmp_lg_u32 s60, 0
  s_cbranch_scc1 L_resc2
L_rback2:
  ds_add_u32 v252, v253
  s_add_u32 s64, s64, 2
  ds_read_b128 v[244:247], v237 offset:512
  ds_read_b128 v[248:251], v237 offset:576
  s_waitcnt lgkmcnt(5)
  v_mfma_f32_16x16x32_bf16 v[168:171], v[220:223], v[96:99], v[192:195]
  v_exp_f32 v156, v156
  v_mfma_f32_16x16x32_bf16 v[176:179], v[220:223], v[112:115], v[196:199]
  v_exp_f32 v157, v157
  v_mfma_f32_16x16x32_bf16 v[184:187], v[220:223], v[128:131], v[200:203]
  v_exp_f32 v158, v158
  v_mfma_f32_16x16x32_bf16 v[168:171], v[224:227], v[100:103], v[168:171]
  ds_read_b128 v[220:223], v237 offset:640
  v_exp_f32 v159, v159
  v_mfma_f32_16x16x32_bf16 v[176:179], v[224:227], v[116:119], v[176:179]
  v_cvt_pk_bf16_f32 v144, v144, v145
  v_mfma_f32_16x16x32_bf16 v[184:187], v[224:227], v[132:135], v[184:187]
  v_cvt_pk_bf16_f32 v145, v146, v147
  v_cvt_pk_bf16_f32 v146, v148, v149
  s_waitcnt lgkmcnt(4)
  v_mfma_f32_16x16x32_bf16 v[168:171], v[228:231], v[104:107], v[168:171]
  ds_read_b128 v[224:227], v237 offset:704
  v_cvt_pk_bf16_f32 v147, v150, v151
  v_mfma_f32_16x16x32_bf16 v[176:179], v[228:231], v[120:123], v[176:179]
  v_exp_f32 v160, v160
  v_mfma_f32_16x16x32_bf16 v[184:187], v[228:231], v[136:139], v[184:187]
  v_exp_f32 v161, v161
  v_mfma_f32_16x16x32_bf16 v[168:171], v[232:235], v[108:111], v[168:171]
  ds_read_b64_tr_b16 v[228:229], v242 offset:0
  ds_read_b64_tr_b16 v[230:231], v242 offset:512
  v_mfma_f32_16x16x32_bf16 v[176:179], v[232:235], v[124:127], v[176:179]
  v_exp_f32 v162, v162
  v_mfma_f32_16x16x32_bf16 v[184:187], v[232:235], v[140:143], v[184:187]
  v_exp_f32 v163, v163
  s_waitcnt lgkmcnt(4)
  v_mfma_f32_16x16x32_bf16 v[172:175], v[244:247], v[96:99], v[192:195]
  ds_read_b64_tr_b16 v[232:233], v242 offset:32
  ds_read_b64_tr_b16 v[234:235], v242 offset:544
  v_mfma_f32_16x16x32_bf16 v[180:183], v[244:247], v[112:115], v[196:199]
  v_cvt_pk_bf16_f32 v152, v152, v153
  v_cvt_pk_bf16_f32 v153, v154, v155
  v_mfma_f32_16x16x32_bf16 v[188:191], v[244:247], v[128:131], v[200:203]
  v_cvt_pk_bf16_f32 v154, v156, v157
  v_cvt_pk_bf16_f32 v155, v158, v159
  v_mfma_f32_16x16x32_bf16 v[172:175], v[248:251], v[100:103], v[172:175]
  ds_read_b64_tr_b16 v[244:245], v242 offset:64
  ds_read_b64_tr_b16 v[246:247], v242 offset:576
  v_mfma_f32_16x16x32_bf16 v[180:183], v[248:251], v[116:119], v[180:183]
  v_exp_f32 v164, v164
  v_mfma_f32_16x16x32_bf16 v[188:191], v[248:251], v[132:135], v[188:191]
  v_exp_f32 v165, v165
  s_waitcnt lgkmcnt(6)
  v_mfma_f32_16x16x32_bf16 v[172:175], v[220:223], v[104:107], v[172:175]
  ds_read_b64_tr_b16 v[248:249], v242 offset:224
  ds_read_b64_tr_b16 v[250:251], v242 offset:736
  v_mfma_f32_16x16x32_bf16 v[180:183], v[220:223], v[120:123], v[180:183]
  v_exp_f32 v166, v166
  v_mfma_f32_16x16x32_bf16 v[188:191], v[220:223], v[136:139], v[188:191]
  v_exp_f32 v167, v167
  v_mfma_f32_16x16x32_bf16 v[172:175], v[224:227], v[108:111], v[172:175]
  ds_read_b64_tr_b16 v[220:221], v242 offset:96
  ds_read_b64_tr_b16 v[222:223], v242 offset:608
  v_mfma_f32_16x16x32_bf16 v[180:183], v[224:227], v[124:127], v[180:183]
  v_cvt_pk_bf16_f32 v160, v160, v161
  v_cvt_pk_bf16_f32 v161, v162, v163
  v_mfma_f32_16x16x32_bf16 v[188:191], v[224:227], v[140:143], v[188:191]
  v_cvt_pk_bf16_f32 v162, v164, v165
  v_cvt_pk_bf16_f32 v163, v166, v167
  v_mfma_f32_16x16x32_bf16 v[204:207], v[216:219], v[144:147], v[204:207]
  ds_read_b64_tr_b16 v[224:225], v242 offset:128
  ds_read_b64_tr_b16 v[226:227], v242 offset:640
  v_mfma_f32_16x16x32_bf16 v[208:211], v[216:219], v[152:155], v[208:211]
  v_max3_f32 v238, v168, v169, v170
  v_max3_f32 v239, v171, v176, v177
  v_mfma_f32_16x16x32_bf16 v[212:215], v[216:219], v[160:163], v[212:215]
  v_max3_f32 v238, v238, v178, v179
  v_max3_f32 v239, v239, v184, v185
  s_waitcnt lgkmcnt(8)
  v_mfma_f32_16x16x32_bf16 v[0:3], v[228:231], v[144:147], v[0:3]
  v_max3_f32 v238, v238, v186, v187
  v_max3_f32 v239, v239, v174, v175
  v_mfma_f32_16x16x32_bf16 v[4:7], v[228:231], v[152:155], v[4:7]
  v_max3_f32 v238, v238, v172, v173
  v_mfma_f32_16x16x32_bf16 v[8:11], v[228:231], v[160:163], v[8:11]
  v_max3_f32 v239, v239, v182, v183
  v_max3_f32 v238, v238, v180, v181
  v_mfma_f32_16x16x32_bf16 v[12:15], v[232:235], v[144:147], v[12:15]
  ds_read_b64_tr_b16 v[228:229], v242 offset:160
  ds_read_b64_tr_b16 v[230:231], v242 offset:672
  v_mfma_f32_16x16x32_bf16 v[16:19], v[232:235], v[152:155], v[16:19]
  v_max3_f32 v239, v239, v188, v189
  v_max3_f32 v239, v239, v190, v191
  v_mfma_f32_16x16x32_bf16 v[20:23], v[232:235], v[160:163], v[20:23]
  v_max_f32 v241, v238, v239
  v_cmp_lt_f32 vcc, 0x41000000, v241
  s_waitcnt lgkmcnt(4)
  v_mfma_f32_16x16x32_bf16 v[24:27], v[244:247], v[144:147], v[24:27]
  ds_read_b64_tr_b16 v[232:233], v242 offset:192
  ds_read_b64_tr_b16 v[234:235], v242 offset:704
  v_mfma_f32_16x16x32_bf16 v[28:31], v[244:247], v[152:155], v[28:31]
  s_cbranch_vccnz L_rare3
L_back3:
  v_mfma_f32_16x16x32_bf16 v[32:35], v[244:247], v[160:163], v[32:35]
  v_add_u32 v236, s3, v236
  v_add_u32 v242, s3, v242
  v_mfma_f32_16x16x32_bf16 v[36:39], v[220:223], v[144:147], v[36:39]
  v_exp_f32 v168, v168
  ds_read_b32 v241, v252 offset:256
  v_mfma_f32_16x16x32_bf16 v[40:43], v[220:223], v[152:155], v[40:43]
  v_exp_f32 v169, v169
  v_mfma_f32_16x16x32_bf16 v[44:47], v[220:223], v[160:163], v[44:47]
  v_exp_f32 v170, v170
  s_waitcnt lgkmcnt(3)
  v_mfma_f32_16x16x32_bf16 v[48:51], v[224:227], v[144:147], v[48:51]
  ds_read_b128 v[220:223], v236 offset:0
  v_mfma_f32_16x16x32_bf16 v[52:55], v[224:227], v[152:155], v[52:55]
  v_exp_f32 v171, v171
  v_mfma_f32_16x16x32_bf16 v[56:59], v[224:227], v[160:163], v[56:59]
  v_exp_f32 v172, v172
  v_mfma_f32_16x16x32_bf16 v[60:63], v[228:231], v[144:147], v[60:63]
  ds_read_b128 v[224:227], v236 offset:64
  v_mfma_f32_16x16x32_bf16 v[64:67], v[228:231], v[152:155], v[64:67]
  v_exp_f32 v173, v173
  v_mfma_f32_16x16x32_bf16 v[68:71], v[228:231], v[160:163], v[68:71]
  v_exp_f32 v174, v174
  s_waitcnt lgkmcnt(3)
  v_mfma_f32_16x16x32_bf16 v[72:75], v[232:235], v[144:147], v[72:75]
  ds_read_b128 v[228:231], v236 offset:128
  v_exp_f32 v175, v175
  v_mfma_f32_16x16x32_bf16 v[76:79], v[232:235], v[152:155], v[76:79]
  v_exp_f32 v176, v176
  v_mfma_f32_16x16x32_bf16 v[80:83], v[232:235], v[160:163], v[80:83]
  v_exp_f32 v177, v177
  v_mfma_f32_16x16x32_bf16 v[84:87], v[248:251], v[144:147], v[84:87]
  ds_read_b128 v[232:235], v236 offset:192
  v_mfma_f32_16x16x32_bf16 v[88:91], v[248:251], v[152:155], v[88:91]
  v_exp_f32 v178, v178
  v_mfma_f32_16x16x32_bf16 v[92:95], v[248:251], v[160:163], v[92:95]
  v_exp_f32 v179, v179
  s_cmp_lg_u32 s60, 0
  s_cbranch_scc1 L_resc3
L_rback3:
  s_sub_u32 s55, s55, 1
  s_cmp_lg_u32 s55, 0
  s_cbranch_scc1 L_loop
  ds_read_b128 v[244:247], v236 offset:512
  ds_read_b128 v[248:251], v236 offset:576
  s_waitcnt lgkmcnt(4)
  v_cmp_ge_u32 vcc, s64, v241
  s_nop 1
  s_cbranch_vccnz L_stall3
L_go3:
  v_mfma_f32_16x16x32_bf16 v[144:147], v[220:223], v[96:99], v[192:195]
  v_exp_f32 v180, v180
  v_mfma_f32_16x16x32_bf16 v[152:155], v[220:223], v[112:115], v[196:199]
  v_exp_f32 v181, v181
  v_mfma_f32_16x16x32_bf16 v[160:163], v[220:223], v[128:131], v[200:203]
  v_exp_f32 v182, v182
  v_mfma_f32_16x16x32_bf16 v[144:147], v[224:227], v[100:103], v[144:147]
  ds_read_b128 v[220:223], v236 offset:640
  v_exp_f32 v183, v183
  v_mfma_f32_16x16x32_bf16 v[152:155], v[224:227], v[116:119], v[152:155]
  v_cvt_pk_bf16_f32 v168, v168, v169
  v_mfma_f32_16x16x32_bf16 v[160:163], v[224:227], v[132:135], v[160:163]
  v_cvt_pk_bf16_f32 v169, v170, v171
  v_cvt_pk_bf16_f32 v170, v172, v173
  s_waitcnt lgkmcnt(3)
  v_mfma_f32_16x16x32_bf16 v[144:147], v[228:231], v[104:107], v[144:147]
  ds_read_b128 v[224:227], v236 offset:704
  v_cvt_pk_bf16_f32 v171, v174, v175
  v_mfma_f32_16x16x32_bf16 v[152:155], v[228:231], v[120:123], v[152:155]
  v_exp_f32 v184, v184
  v_mfma_f32_16x16x32_bf16 v[160:163], v[228:231], v[136:139], v[160:163]
  v_exp_f32 v185, v185
  v_mfma_f32_16x16x32_bf16 v[144:147], v[232:235], v[108:111], v[144:147]
  ds_read_b64_tr_b16 v[228:229], v243 offset:0
  ds_read_b64_tr_b16 v[230:231], v243 offset:512
  v_mfma_f32_16x16x32_bf16 v[152:155], v[232:235], v[124:127], v[152:155]
  v_exp_f32 v186, v186
  v_mfma_f32_16x16x32_bf16 v[160:163], v[232:235], v[140:143], v[160:163]
  v_exp_f32 v187, v187
  s_waitcnt lgkmcnt(4)
  v_mfma_f32_16x16x32_bf16 v[148:151], v[244:247], v[96:99], v[192:195]
  ds_read_b64_tr_b16 v[232:233], v243 offset:32
  ds_read_b64_tr_b16 v[234:235], v243 offset:544
  v_mfma_f32_16x16x32_bf16 v[156:159], v[244:247], v[112:115], v[196:199]
  v_cvt_pk_bf16_f32 v176, v176, v177
  v_cvt_pk_bf16_f32 v177, v178, v179
  v_mfma_f32_16x16x32_bf16 v[164:167], v[244:247], v[128:131], v[200:203]
  v_cvt_pk_bf16_f32 v178, v180, v181
  v_cvt_pk_bf16_f32 v179, v182, v183
  v_mfma_f32_16x16x32_bf16 v[148:151], v[248:251], v[100:103], v[148:151]
  ds_read_b64_tr_b16 v[244:245], v243 offset:64
  ds_read_b64_tr_b16 v[246:247], v243 offset:576
  v_mfma_f32_16x16x32_bf16 v[156:159], v[248:251], v[116:119], v[156:159]
  v_exp_f32 v188, v188
  v_mfma_f32_16x16x32_bf16 v[164:167], v[248:251], v[132:135], v[164:167]
  v_exp_f32 v189, v189
  s_waitcnt lgkmcnt(6)
  v_mfma_f32_16x16x32_bf16 v[148:151], v[220:223], v[104:107], v[148:151]
  ds_read_b64_tr_b16 v[248:249], v243 offset:224
  ds_read_b64_tr_b16 v[250:251], v243 offset:736
  v_mfma_f32_16x16x32_bf16 v[156:159], v[220:223], v[120:123], v[156:159]
  v_exp_f32 v190, v190
  v_mfma_f32_16x16x32_bf16 v[164:167], v[220:223], v[136:139], v[164:167]
  v_exp_f32 v191, v191
  v_mfma_f32_16x16x32_bf16 v[148:151], v[224:227], v[108:111], v[148:151]
  ds_read_b64_tr_b16 v[220:221], v243 offset:96
  ds_read_b64_tr_b16 v[222:223], v243 offset:608
  v_mfma_f32_16x16x32_bf16 v[156:159], v[224:227], v[124:127], v[156:159]
  v_cvt_pk_bf16_f32 v184, v184, v185
  v_cvt_pk_bf16_f32 v185, v186, v187
  v_mfma_f32_16x16x32_bf16 v[164:167], v[224:227], v[140:143], v[164:167]
  v_cvt_pk_bf16_f32 v186, v188, v189
  v_cvt_pk_bf16_f32 v187, v190, v191
  v_mfma_f32_16x16x32_bf16 v[204:207], v[216:219], v[168:171], v[204:207]
  ds_read_b64_tr_b16 v[224:225], v243 offset:128
  ds_read_b64_tr_b16 v[226:227], v243 offset:640
  v_mfma_f32_16x16x32_bf16 v[208:211], v[216:219], v[176:179], v[208:211]
  v_max3_f32 v238, v144, v145, v146
  v_max3_f32 v239, v147, v152, v153
  v_mfma_f32_16x16x32_bf16 v[212:215], v[216:219], v[184:187], v[212:215]
  v_max3_f32 v238, v238, v154, v155
  v_max3_f32 v239, v239, v160, v161
  s_waitcnt lgkmcnt(8)
  v_mfma_f32_16x16x32_bf16 v[0:3], v[228:231], v[168:171], v[0:3]
  v_max3_f32 v238, v238, v162, v163
  v_mfma_f32_16x16x32_bf16 v[4:7], v[228:231], v[176:179], v[4:7]
  v_max3_f32 v239, v239, v150, v151
  v_max3_f32 v238, v238, v148, v149
  v_mfma_f32_16x16x32_bf16 v[8:11], v[228:231], v[184:187], v[8:11]
  v_max3_f32 v239, v239, v158, v159
  v_max3_f32 v238, v238, v156, v157
  v_mfma_f32_16x16x32_bf16 v[12:15], v[232:235], v[168:171], v[12:15]
  ds_read_b64_tr_b16 v[228:229], v243 offset:160
  ds_read_b64_tr_b16 v[230:231], v243 offset:672
  v_mfma_f32_16x16x32_bf16 v[16:19], v[232:235], v[176:179], v[16:19]
  v_max3_f32 v239, v239, v164, v165
  v_max3_f32 v239, v239, v166, v167
  v_mfma_f32_16x16x32_bf16 v[20:23], v[232:235], v[184:187], v[20:23]
  v_max_f32 v241, v238, v239
  v_cmp_lt_f32 vcc, 0x41000000, v241
  s_waitcnt lgkmcnt(4)
  v_mfma_f32_16x16x32_bf16 v[24:27], v[244:247], v[168:171], v[24:27]
  ds_read_b64_tr_b16 v[232:233], v243 offset:192
  ds_read_b64_tr_b16 v[234:235], v243 offset:704
  v_mfma_f32_16x16x32_bf16 v[28:31], v[244:247], v[176:179], v[28:31]
  s_cbranch_vccnz L_rare4
L_back4:
  v_mfma_f32_16x16x32_bf16 v[32:35], v[244:247], v[184:187], v[32:35]
  v_add_u32 v237, 16896, v237
  v_add_u32 v243, 16896, v243
  v_mfma_f32_16x16x32_bf16 v[36:39], v[220:223], v[168:171], v[36:39]
  v_exp_f32 v144, v144
  v_mfma_f32_16x16x32_bf16 v[40:43], v[220:223], v[176:179], v[40:43]
  v_exp_f32 v145, v145
  v_mfma_f32_16x16x32_bf16 v[44:47], v[220:223], v[184:187], v[44:47]
  v_exp_f32 v146, v146
  s_waitcnt lgkmcnt(2)
  v_mfma_f32_16x16x32_bf16 v[48:51], v[224:227], v[168:171], v[48:51]
  ds_read_b128 v[220:223], v237 offset:0
  v_mfma_f32_16x16x32_bf16 v[52:55], v[224:227], v[176:179], v[52:55]
  v_exp_f32 v147, v147
  v_mfma_f32_16x16x32_bf16 v[56:59], v[224:227], v[184:187], v[56:59]
  v_exp_f32 v148, v148
  v_mfma_f32_16x16x32_bf16 v[60:63], v[228:231], v[168:171], v[60:63]
  ds_read_b128 v[224:227], v237 offset:64
  v_exp_f32 v149, v149
  v_mfma_f32_16x16x32_bf16 v[64:67], v[228:231], v[176:179], v[64:67]
  v_exp_f32 v150, v150
  v_mfma_f32_16x16x32_bf16 v[68:71], v[228:231], v[184:187], v[68:71]
  s_waitcnt lgkmcnt(2)
  v_mfma_f32_16x16x32_bf16 v[72:75], v[232:235], v[168:171], v[72:75]
  ds_read_b128 v[228:231], v237 offset:128
  v_exp_f32 v151, v151
  v_mfma_f32_16x16x32_bf16 v[76:79], v[232:235], v[176:179], v[76:79]
  v_exp_f32 v152, v152
  v_mfma_f32_16x16x32_bf16 v[80:83], v[232:235], v[184:187], v[80:83]
  v_exp_f32 v153, v153
  v_mfma_f32_16x16x32_bf16 v[84:87], v[248:251], v[168:171], v[84:87]
  ds_read_b128 v[232:235], v237 offset:192
  v_mfma_f32_16x16x32_bf16 v[88:91], v[248:251], v[176:179], v[88:91]
  v_exp_f32 v154, v154
  v_mfma_f32_16x16x32_bf16 v[92:95], v[248:251], v[184:187], v[92:95]
  v_exp_f32 v155, v155
  s_cmp_lg_u32 s60, 0
  s_cbranch_scc1 L_resc4
L_rback4:
  ds_add_u32 v252, v253
  s_mov_b32 s64, 31
  ds_read_b128 v[244:247], v237 offset:512
  ds_read_b128 v[248:251], v237 offset:576
  s_waitcnt lgkmcnt(5)
  v_mfma_f32_16x16x32_bf16 v[168:171], v[220:223], v[96:99], v[192:195]
  v_exp_f32 v156, v156
  v_mfma_f32_16x16x32_bf16 v[176:179], v[220:223], v[112:115], v[196:199]
  v_exp_f32 v157, v157
  v_mfma_f32_16x16x32_bf16 v[184:187], v[220:223], v[128:131], v[200:203]
  v_exp_f32 v158, v158
  v_mfma_f32_16x16x32_bf16 v[168:171], v[224:227], v[100:103], v[168:171]
  ds_read_b128 v[220:223], v237 offset:640
  v_exp_f32 v159, v159
  v_mfma_f32_16x16x32_bf16 v[176:179], v[224:227], v[116:119], v[176:179]
  v_cvt_pk_bf16_f32 v144, v144, v145
  v_mfma_f32_16x16x32_bf16 v[184:187], v[224:227], v[132:135], v[184:187]
  v_cvt_pk_bf16_f32 v145, v146, v147
  v_cvt_pk_bf16_f32 v146, v148, v149
  s_waitcnt lgkmcnt(4)
  v_mfma_f32_16x16x32_bf16 v[168:171], v[228:231], v[104:107], v[168:171]
  ds_read_b128 v[224:227], v237 offset:704
  v_cvt_pk_bf16_f32 v147, v150, v151
  v_mfma_f32_16x16x32_bf16 v[176:179], v[228:231], v[120:123], v[176:179]
  v_exp_f32 v160, v160
  v_mfma_f32_16x16x32_bf16 v[184:187], v[228:231], v[136:139], v[184:187]
  v_exp_f32 v161, v161
  v_mfma_f32_16x16x32_bf16 v[168:171], v[232:235], v[108:111], v[168:171]
  ds_read_b64_tr_b16 v[228:229], v242 offset:0
  ds_read_b64_tr_b16 v[230:231], v242 offset:512
  v_mfma_f32_16x16x32_bf16 v[176:179], v[232:235], v[124:127], v[176:179]
  v_exp_f32 v162, v162
  v_mfma_f32_16x16x32_bf16 v[184:187], v[232:235], v[140:143], v[184:187]
  v_exp_f32 v163, v163
  s_waitcnt lgkmcnt(4)
  v_mfma_f32_16x16x32_bf16 v[172:175], v[244:247], v[96:99], v[192:195]
  ds_read_b64_tr_b16 v[232:233], v242 offset:32
  ds_read_b64_tr_b16 v[234:235], v242 offset:544
  v_mfma_f32_16x16x32_bf16 v[180:183], v[244:247], v[112:115], v[196:199]
  v_cvt_pk_bf16_f32 v152, v152, v153
  v_cvt_pk_bf16_f32 v153, v154, v155
  v_mfma_f32_16x16x32_bf16 v[188:191], v[244:247], v[128:131], v[200:203]
  v_cvt_pk_bf16_f32 v154, v156, v157
  v_cvt_pk_bf16_f32 v155, v158, v159
  v_mfma_f32_16x16x32_bf16 v[172:175], v[248:251], v[100:103], v[172:175]
  ds_read_b64_tr_b16 v[244:245], v242 offset:64
  ds_read_b64_tr_b16 v[246:247], v242 offset:576
  v_mfma_f32_16x16x32_bf16 v[180:183], v[248:251], v[116:119], v[180:183]
  v_exp_f32 v164, v164
  v_mfma_f32_16x16x32_bf16 v[188:191], v[248:251], v[132:135], v[188:191]
  v_exp_f32 v165, v165
  s_waitcnt lgkmcnt(6)
  v_mfma_f32_16x16x32_bf16 v[172:175], v[220:223], v[104:107], v[172:175]
  ds_read_b64_tr_b16 v[248:249], v242 offset:224
  ds_read_b64_tr_b16 v[250:251], v242 offset:736
  v_mfma_f32_16x16x32_bf16 v[180:183], v[220:223], v[120:123], v[180:183]
  v_exp_f32 v166, v166
  v_mfma_f32_16x16x32_bf16 v[188:191], v[220:223], v[136:139], v[188:191]
  v_exp_f32 v167, v167
  v_mfma_f32_16x16x32_bf16 v[172:175], v[224:227], v[108:111], v[172:175]
  ds_read_b64_tr_b16 v[220:221], v242 offset:96
  ds_read_b64_tr_b16 v[222:223], v242 offset:608
  v_mfma_f32_16x16x32_bf16 v[180:183], v[224:227], v[124:127], v[180:183]
  v_cvt_pk_bf16_f32 v160, v160, v161
  v_cvt_pk_bf16_f32 v161, v162, v163
  v_mfma_f32_16x16x32_bf16 v[188:191], v[224:227], v[140:143], v[188:191]
  v_cvt_pk_bf16_f32 v162, v164, v165
  v_cvt_pk_bf16_f32 v163, v166, v167
  v_mfma_f32_16x16x32_bf16 v[204:207], v[216:219], v[144:147], v[204:207]
  ds_read_b64_tr_b16 v[224:225], v242 offset:128
  ds_read_b64_tr_b16 v[226:227], v242 offset:640
  v_mfma_f32_16x16x32_bf16 v[208:211], v[216:219], v[152:155], v[208:211]
  v_max3_f32 v238, v168, v169, v170
  v_mfma_f32_16x16x32_bf16 v[212:215], v[216:219], v[160:163], v[212:215]
  v_max3_f32 v239, v171, v176, v177
  v_max3_f32 v238, v238, v178, v179
  s_waitcnt lgkmcnt(8)
  v_mfma_f32_16x16x32_bf16 v[0:3], v[228:231], v[144:147], v[0:3]
  v_max3_f32 v239, v239, v184, v185
  v_max3_f32 v238, v238, v186, v187
  v_mfma_f32_16x16x32_bf16 v[4:7], v[228:231], v[152:155], v[4:7]
  v_max3_f32 v239, v239, v174, v175
  v_mfma_f32_16x16x32_bf16 v[8:11], v[228:231], v[160:163], v[8:11]
  v_max3_f32 v238, v238, v172, v173
  v_max3_f32 v239, v239, v182, v183
  v_mfma_f32_16x16x32_bf16 v[12:15], v[232:235], v[144:147], v[12:15]
  ds_read_b64_tr_b16 v[228:229], v242 offset:160
  ds_read_b64_tr_b16 v[230:231], v242 offset:672
  v_mfma_f32_16x16x32_bf16 v[16:19], v[232:235], v[152:155], v[16:19]
  v_max3_f32 v238, v238, v180, v181
  v_mfma_f32_16x16x32_bf16 v[20:23], v[232:235], v[160:163], v[20:23]
  v_max3_f32 v239, v239, v188, v189
  v_max3_f32 v239, v239, v190, v191
  s_waitcnt lgkmcnt(4)
  v_mfma_f32_16x16x32_bf16 v[24:27], v[244:247], v[144:147], v[24:27]
  ds_read_b64_tr_b16 v[232:233], v242 offset:192
  ds_read_b64_tr_b16 v[234:235], v242 offset:704
  v_mfma_f32_16x16x32_bf16 v[28:31], v[244:247], v[152:155], v[28:31]
  v_max_f32 v241, v238, v239
  v_mfma_f32_16x16x32_bf16 v[32:35], v[244:247], v[160:163], v[32:35]
  v_cmp_lt_f32 vcc, 0x41000000, v241
  s_nop 1
  s_cbranch_vccnz L_rare5
L_back5:
  v_mfma_f32_16x16x32_bf16 v[36:39], v[220:223], v[144:147], v[36:39]
  v_exp_f32 v168, v168
  v_mfma_f32_16x16x32_bf16 v[40:43], v[220:223], v[152:155], v[40:43]
  ds_read_b32 v241, v252 offset:256
  v_mfma_f32_16x16x32_bf16 v[44:47], v[220:223], v[160:163], v[44:47]
  v_exp_f32 v169, v169
  s_waitcnt lgkmcnt(3)
  v_mfma_f32_16x16x32_bf16 v[48:51], v[224:227], v[144:147], v[48:51]
  v_exp_f32 v170, v170
  v_mfma_f32_16x16x32_bf16 v[52:55], v[224:227], v[152:155], v[52:55]
  v_exp_f32 v171, v171
  v_mfma_f32_16x16x32_bf16 v[56:59], v[224:227], v[160:163], v[56:59]
  v_exp_f32 v172, v172
  v_mfma_f32_16x16x32_bf16 v[60:63], v[228:231], v[144:147], v[60:63]
  v_mfma_f32_16x16x32_bf16 v[64:67], v[228:231], v[152:155], v[64:67]
  v_exp_f32 v173, v173
  v_mfma_f32_16x16x32_bf16 v[68:71], v[228:231], v[160:163], v[68:71]
  v_exp_f32 v174, v174
  s_waitcnt lgkmcnt(1)
  v_mfma_f32_16x16x32_bf16 v[72:75], v[232:235], v[144:147], v[72:75]
  v_exp_f32 v175, v175
  v_mfma_f32_16x16x32_bf16 v[76:79], v[232:235], v[152:155], v[76:79]
  v_exp_f32 v176, v176
  v_mfma_f32_16x16x32_bf16 v[80:83], v[232:235], v[160:163], v[80:83]
  v_exp_f32 v177, v177
  v_mfma_f32_16x16x32_bf16 v[84:87], v[248:251], v[144:147], v[84:87]
  v_mfma_f32_16x16x32_bf16 v[88:91], v[248:251], v[152:155], v[88:91]
  v_exp_f32 v178, v178
  v_mfma_f32_16x16x32_bf16 v[92:95], v[248:251], v[160:163], v[92:95]
  v_exp_f32 v179, v179
  s_cmp_lg_u32 s60, 0
  s_cbranch_scc1 L_resc5
L_rback5:
  v_mov_b32 v253, 1
  ds_add_u32 v252, v253
  s_waitcnt lgkmcnt(1)
  v_cmp_ge_u32 vcc, s64, v241
  s_nop 1
  s_cbranch_vccnz L_stall4
L_go4:
  ds_read_b64_tr_b16 v[228:229], v243 offset:0
  ds_read_b64_tr_b16 v[230:231], v243 offset:512
  ds_read_b64_tr_b16 v[232:233], v243 offset:32
  ds_read_b64_tr_b16 v[234:235], v243 offset:544
  ds_read_b64_tr_b16 v[244:245], v243 offset:64
  ds_read_b64_tr_b16 v[246:247], v243 offset:576
  ds_read_b64_tr_b16 v[248:249], v243 offset:224
  ds_read_b64_tr_b16 v[250:251], v243 offset:736
  ds_read_b64_tr_b16 v[220:221], v243 offset:96
  ds_read_b64_tr_b16 v[222:223], v243 offset:608
  ds_read_b64_tr_b16 v[224:225], v243 offset:128
  ds_read_b64_tr_b16 v[226:227], v243 offset:640
  s_lshr_b32 s55, s54, 1
  s_and_b32 s56, s54, 1
  s_lshl_b32 s57, s52, 1
  s_add_u32 s57, s57, s56
  s_lshl_b32 s57, s57, 7
  s_lshl_b32 s58, s53, 1
  s_add_u32 s58, s58, s55
  s_lshl_b32 s58, s58, 2
  s_add_u32 s57, s57, s58
  s_mul_i32 s57, s57, 3072
  v_lshlrev_b32 v241, 4, v255
  v_add_u32 v238, s57, v241
  v_exp_f32 v180, v180
  v_exp_f32 v181, v181
  v_exp_f32 v182, v182
  v_exp_f32 v183, v183
  v_cvt_pk_bf16_f32 v168, v168, v169
  v_cvt_pk_bf16_f32 v169, v170, v171
  v_cvt_pk_bf16_f32 v170, v172, v173
  v_cvt_pk_bf16_f32 v171, v174, v175
  v_exp_f32 v184, v184
  v_exp_f32 v185, v185
  v_exp_f32 v186, v186
  v_exp_f32 v187, v187
  v_cvt_pk_bf16_f32 v176, v176, v177
  v_cvt_pk_bf16_f32 v177, v178, v179
  v_cvt_pk_bf16_f32 v178, v180, v181
  v_cvt_pk_bf16_f32 v179, v182, v183
  v_exp_f32 v188, v188
  v_exp_f32 v189, v189
  v_exp_f32 v190, v190
  v_exp_f32 v191, v191
  v_cvt_pk_bf16_f32 v184, v184, v185
  v_cvt_pk_bf16_f32 v185, v186, v187
  v_cvt_pk_bf16_f32 v186, v188, v189
  v_cvt_pk_bf16_f32 v187, v190, v191
  v_mfma_f32_16x16x32_bf16 v[204:207], v[216:219], v[168:171], v[204:207]
  v_mfma_f32_16x16x32_bf16 v[208:211], v[216:219], v[176:179], v[208:211]
  v_mfma_f32_16x16x32_bf16 v[212:215], v[216:219], v[184:187], v[212:215]
  s_waitcnt lgkmcnt(8)
  v_mfma_f32_16x16x32_bf16 v[0:3], v[228:231], v[168:171], v[0:3]
  v_mfma_f32_16x16x32_bf16 v[4:7], v[228:231], v[176:179], v[4:7]
  v_mfma_f32_16x16x32_bf16 v[8:11], v[228:231], v[184:187], v[8:11]
  s_nop 1
  v_rcp_f32 v192, v204
  v_rcp_f32 v194, v208
  v_rcp_f32 v196, v212
  v_mov_b32 v193, v192
  v_mov_b32 v195, v194
  v_mov_b32 v197, v196
  v_mfma_f32_16x16x32_bf16 v[12:15], v[232:235], v[168:171], v[12:15]
  ds_read_b64_tr_b16 v[228:229], v243 offset:160
  ds_read_b64_tr_b16 v[230:231], v243 offset:672
  v_mfma_f32_16x16x32_bf16 v[16:19], v[232:235], v[176:179], v[16:19]
  v_mfma_f32_16x16x32_bf16 v[20:23], v[232:235], v[184:187], v[20:23]
  s_waitcnt lgkmcnt(4)
  v_mfma_f32_16x16x32_bf16 v[24:27], v[244:247], v[168:171], v[24:27]
  ds_read_b64_tr_b16 v[232:233], v243 offset:192
  ds_read_b64_tr_b16 v[234:235], v243 offset:704
  v_mfma_f32_16x16x32_bf16 v[28:31], v[244:247], v[176:179], v[28:31]
  v_pk_mul_f32 v[0:1], v[0:1], v[192:193]
  v_pk_mul_f32 v[2:3], v[2:3], v[192:193]
  v_pk_mul_f32 v[12:13], v[12:13], v[192:193]
  v_pk_mul_f32 v[14:15], v[14:15], v[192:193]
  v_cvt_pk_bf16_f32 v96, v0, v1
  v_cvt_pk_bf16_f32 v97, v2, v3
  v_cvt_pk_bf16_f32 v98, v12, v13
  v_cvt_pk_bf16_f32 v99, v14, v15
  s_mov_b32 s56, 0
  buffer_store_dwordx4 v[96:99], v238, s[28:31], s56 offen sc1
  v_pk_mul_f32 v[4:5], v[4:5], v[194:195]
  v_pk_mul_f32 v[6:7], v[6:7], v[194:195]
  v_pk_mul_f32 v[16:17], v[16:17], v[194:195]
  v_pk_mul_f32 v[18:19], v[18:19], v[194:195]
  v_cvt_pk_bf16_f32 v100, v4, v5
  v_cvt_pk_bf16_f32 v101, v6, v7
  v_cvt_pk_bf16_f32 v102, v16, v17
  v_cvt_pk_bf16_f32 v103, v18, v19
  s_mov_b32 s56, 1024
  buffer_store_dwordx4 v[100:103], v238, s[28:31], s56 offen sc1
  v_pk_mul_f32 v[8:9], v[8:9], v[196:197]
  v_pk_mul_f32 v[10:11], v[10:11], v[196:197]
  v_pk_mul_f32 v[20:21], v[20:21], v[196:197]
  v_pk_mul_f32 v[22:23], v[22:23], v[196:197]
  v_cvt_pk_bf16_f32 v104, v8, v9
  v_cvt_pk_bf16_f32 v105, v10, v11
  v_cvt_pk_bf16_f32 v106, v20, v21
  v_cvt_pk_bf16_f32 v107, v22, v23
  s_mov_b32 s56, 2048
  buffer_store_dwordx4 v[104:107], v238, s[28:31], s56 offen sc1
  v_mfma_f32_16x16x32_bf16 v[32:35], v[244:247], v[184:187], v[32:35]
  v_mfma_f32_16x16x32_bf16 v[36:39], v[220:223], v[168:171], v[36:39]
  v_mfma_f32_16x16x32_bf16 v[40:43], v[220:223], v[176:179], v[40:43]
  v_mfma_f32_16x16x32_bf16 v[44:47], v[220:223], v[184:187], v[44:47]
  s_waitcnt lgkmcnt(2)
  v_mfma_f32_16x16x32_bf16 v[48:51], v[224:227], v[168:171], v[48:51]
  v_mfma_f32_16x16x32_bf16 v[52:55], v[224:227], v[176:179], v[52:55]
  v_pk_mul_f32 v[24:25], v[24:25], v[192:193]
  v_pk_mul_f32 v[26:27], v[26:27], v[192:193]
  s_nop 0
  v_pk_mul_f32 v[36:37], v[36:37], v[192:193]
  v_pk_mul_f32 v[38:39], v[38:39], v[192:193]
  v_cvt_pk_bf16_f32 v108, v24, v25
  v_cvt_pk_bf16_f32 v109, v26, v27
  v_cvt_pk_bf16_f32 v110, v36, v37
  v_cvt_pk_bf16_f32 v111, v38, v39
  s_mov_b32 s56, 3072
  buffer_store_dwordx4 v[108:111], v238, s[28:31], s56 offen sc1
  v_pk_mul_f32 v[28:29], v[28:29], v[194:195]
  v_pk_mul_f32 v[30:31], v[30:31], v[194:195]
  v_pk_mul_f32 v[40:41], v[40:41], v[194:195]
  v_pk_mul_f32 v[42:43], v[42:43], v[194:195]
  v_cvt_pk_bf16_f32 v112, v28, v29
  v_cvt_pk_bf16_f32 v113, v30, v31
  v_cvt_pk_bf16_f32 v114, v40, v41
  v_cvt_pk_bf16_f32 v115, v42, v43
  s_mov_b32 s56, 4096
  buffer_store_dwordx4 v[112:115], v238, s[28:31], s56 offen sc1
  v_pk_mul_f32 v[32:33], v[32:33], v[196:197]
  v_pk_mul_f32 v[34:35], v[34:35], v[196:197]
  v_pk_mul_f32 v[44:45], v[44:45], v[196:197]
  v_pk_mul_f32 v[46:47], v[46:47], v[196:197]
  v_cvt_pk_bf16_f32 v116, v32, v33
  v_cvt_pk_bf16_f32 v117, v34, v35
  v_cvt_pk_bf16_f32 v118, v44, v45
  v_cvt_pk_bf16_f32 v119, v46, v47
  s_mov_b32 s56, 5120
  buffer_store_dwordx4 v[116:119], v238, s[28:31], s56 offen sc1
  v_mfma_f32_16x16x32_bf16 v[56:59], v[224:227], v[184:187], v[56:59]
  v_mfma_f32_16x16x32_bf16 v[60:63], v[228:231], v[168:171], v[60:63]
  v_mfma_f32_16x16x32_bf16 v[64:67], v[228:231], v[176:179], v[64:67]
  v_mfma_f32_16x16x32_bf16 v[68:71], v[228:231], v[184:187], v[68:71]
  s_waitcnt lgkmcnt(0)
  v_mfma_f32_16x16x32_bf16 v[72:75], v[232:235], v[168:171], v[72:75]
  v_mfma_f32_16x16x32_bf16 v[76:79], v[232:235], v[176:179], v[76:79]
  v_pk_mul_f32 v[48:49], v[48:49], v[192:193]
  v_pk_mul_f32 v[50:51], v[50:51], v[192:193]
  s_nop 0
  v_pk_mul_f32 v[60:61], v[60:61], v[192:193]
  v_pk_mul_f32 v[62:63], v[62:63], v[192:193]
  v_cvt_pk_bf16_f32 v120, v48, v49
  v_cvt_pk_bf16_f32 v121, v50, v51
  v_cvt_pk_bf16_f32 v122, v60, v61
  v_cvt_pk_bf16_f32 v123, v62, v63
  s_mov_b32 s56, 6144
  buffer_store_dwordx4 v[120:123], v238, s[28:31], s56 offen sc1
  v_pk_mul_f32 v[52:53], v[52:53], v[194:195]
  v_pk_mul_f32 v[54:55], v[54:55], v[194:195]
  v_pk_mul_f32 v[64:65], v[64:65], v[194:195]
  v_pk_mul_f32 v[66:67], v[66:67], v[194:195]
  v_cvt_pk_bf16_f32 v124, v52, v53
  v_cvt_pk_bf16_f32 v125, v54, v55
  v_cvt_pk_bf16_f32 v126, v64, v65
  v_cvt_pk_bf16_f32 v127, v66, v67
  s_mov_b32 s56, 7168
  buffer_store_dwordx4 v[124:127], v238, s[28:31], s56 offen sc1
  v_pk_mul_f32 v[56:57], v[56:57], v[196:197]
  v_pk_mul_f32 v[58:59], v[58:59], v[196:197]
  v_pk_mul_f32 v[68:69], v[68:69], v[196:197]
  v_pk_mul_f32 v[70:71], v[70:71], v[196:197]
  v_cvt_pk_bf16_f32 v128, v56, v57
  v_cvt_pk_bf16_f32 v129, v58, v59
  v_cvt_pk_bf16_f32 v130, v68, v69
  v_cvt_pk_bf16_f32 v131, v70, v71
  s_mov_b32 s56, 8192
  buffer_store_dwordx4 v[128:131], v238, s[28:31], s56 offen sc1
  v_mfma_f32_16x16x32_bf16 v[80:83], v[232:235], v[184:187], v[80:83]
  v_mfma_f32_16x16x32_bf16 v[84:87], v[248:251], v[168:171], v[84:87]
  v_mfma_f32_16x16x32_bf16 v[88:91], v[248:251], v[176:179], v[88:91]
  v_mfma_f32_16x16x32_bf16 v[92:95], v[248:251], v[184:187], v[92:95]
  v_pk_mul_f32 v[72:73], v[72:73], v[192:193]
  v_pk_mul_f32 v[74:75], v[74:75], v[192:193]
  s_nop 3
  v_pk_mul_f32 v[84:85], v[84:85], v[192:193]
  v_pk_mul_f32 v[86:87], v[86:87], v[192:193]
  v_cvt_pk_bf16_f32 v132, v72, v73
  v_cvt_pk_bf16_f32 v133, v74, v75
  v_cvt_pk_bf16_f32 v134, v84, v85
  v_cvt_pk_bf16_f32 v135, v86, v87
  s_mov_b32 s56, 9216
  buffer_store_dwordx4 v[132:135], v238, s[28:31], s56 offen sc1
  v_pk_mul_f32 v[76:77], v[76:77], v[194:195]
  v_pk_mul_f32 v[78:79], v[78:79], v[194:195]
  v_pk_mul_f32 v[88:89], v[88:89], v[194:195]
  v_pk_mul_f32 v[90:91], v[90:91], v[194:195]
  v_cvt_pk_bf16_f32 v136, v76, v77
  v_cvt_pk_bf16_f32 v137, v78, v79
  v_cvt_pk_bf16_f32 v138, v88, v89
  v_cvt_pk_bf16_f32 v139, v90, v91
  s_mov_b32 s56, 10240
  buffer_store_dwordx4 v[136:139], v238, s[28:31], s56 offen sc1
  v_pk_mul_f32 v[80:81], v[80:81], v[196:197]
  v_pk_mul_f32 v[82:83], v[82:83], v[196:197]
  v_pk_mul_f32 v[92:93], v[92:93], v[196:197]
  v_pk_mul_f32 v[94:95], v[94:95], v[196:197]
  v_cvt_pk_bf16_f32 v140, v80, v81
  v_cvt_pk_bf16_f32 v141, v82, v83
  v_cvt_pk_bf16_f32 v142, v92, v93
  v_cvt_pk_bf16_f32 v143, v94, v95
  s_mov_b32 s56, 11264
  buffer_store_dwordx4 v[140:143], v238, s[28:31], s56 offen sc1
  ds_add_u32 v252, v253
  s_waitcnt lgkmcnt(0)
  v_mov_b32 v254, 0
  v_lshlrev_b32 v251, 4, v255
  s_mul_i32 s64, s70, 393216
  s_mul_i32 s65, s54, 49152
  s_add_u32 s64, s64, s65
  v_add_u32 v248, s64, v251
  s_mul_i32 s64, s71, 589824
  s_mul_i32 s65, s54, 73728
  s_add_u32 s64, s64, s65
  v_add_u32 v249, s64, v251
  s_add_u32 s64, s47, 0
  s_and_b32 s64, s64, 7
  s_mul_i32 s36, s64, 6144
  s_mul_i32 s16, s64, 9216
  s_add_u32 s64, s47, 1
  s_and_b32 s64, s64, 7
  s_mul_i32 s37, s64, 6144
  s_mul_i32 s17, s64, 9216
  s_add_u32 s64, s47, 2
  s_and_b32 s64, s64, 7
  s_mul_i32 s38, s64, 6144
  s_mul_i32 s18, s64, 9216
  s_add_u32 s64, s47, 3
  s_and_b32 s64, s64, 7
  s_mul_i32 s39, s64, 6144
  s_mul_i32 s19, s64, 9216
  s_add_u32 s64, s47, 4
  s_and_b32 s64, s64, 7
  s_mul_i32 s40, s64, 6144
  s_mul_i32 s20, s64, 9216
  s_add_u32 s64, s47, 5
  s_and_b32 s64, s64, 7
  s_mul_i32 s41, s64, 6144
  s_mul_i32 s21, s64, 9216
  s_add_u32 s64, s47, 6
  s_and_b32 s64, s64, 7
  s_mul_i32 s42, s64, 6144
  s_mul_i32 s22, s64, 9216
  s_add_u32 s64, s47, 7
  s_and_b32 s64, s64, 7
  s_mul_i32 s43, s64, 6144
  s_mul_i32 s23, s64, 9216
  s_mov_b32 s66, 27648
  s_mov_b32 s67, 36864
  s_cmp_eq_u32 s54, 1
  s_cselect_b32 s66, 46080, s66
  s_cselect_b32 s67, 55296, s67
  s_cmp_eq_u32 s54, 2
  s_cselect_b32 s66, 86016, s66
  s_cselect_b32 s67, 95232, s67
  s_cmp_eq_u32 s54, 3
  s_cselect_b32 s66, 104448, s66
  s_cselect_b32 s67, 113664, s67
  s_cmp_eq_u32 s54, 4
  s_cselect_b32 s66, 9216, s66
  s_cselect_b32 s67, 67584, s67
  s_cmp_eq_u32 s54, 5
  s_cselect_b32 s66, 18432, s66
  s_cselect_b32 s67, 76800, s67
  s_cmp_eq_u32 s54, 6
  s_cselect_b32 s66, 135168, s66
  s_cselect_b32 s67, 144384, s67
  s_cmp_eq_u32 s54, 7
  s_cselect_b32 s66, 153600, s66
  s_cselect_b32 s67, 0, s67
  s_mov_b32 s88, s66
  s_mov_b32 s89, s67
  v_add_u32 v250, s66, v251
  global_load_dwordx2 v[252:253], v254, s[48:49] sc1
  s_waitcnt vmcnt(0)
  v_readfirstlane_b32 s92, v252
  v_readfirstlane_b32 s93, v253
  s_nop 0
  s_cmp_lg_u32 s92, 0
  s_cbranch_scc1 L_ctok_ok
  s_mov_b64 exec, 1
  v_mov_b32 v2, 0
  s_mov_b32 s65, 1048576
L_tokc:
  global_load_dwordx2 v[4:5], v2, s[48:49] sc1
  s_waitcnt vmcnt(0)
  v_readfirstlane_b32 s92, v4
  v_readfirstlane_b32 s93, v5
  s_nop 0
  s_cmp_lg_u32 s92, 0
  s_cbranch_scc1 L_tokc_ok
  s_sleep 2
  s_sub_u32 s65, s65, 1
  s_cmp_lg_u32 s65, 0
  s_cbranch_scc1 L_tokc
L_tokc_ok:
  s_mov_b64 exec, -1
L_ctok_ok:
  s_lshl_b32 s66, s52, 4
  s_add_u32 s66, s66, s53
  s_lshl_b32 s66, s66, 2
  s_add_u32 s66, s66, s54
  s_lshl_b32 s66, s66, 7
  s_add_u32 s66, s66, 12582912
  s_mov_b64 exec, 1
  v_mov_b32 v2, s66
  v_mov_b32 v4, s92
  v_mov_b32 v5, s93
  global_store_dwordx2 v2, v[4:5], s[50:51] sc1
  s_mov_b64 exec, -1
  v_mov_b32 v2, 163328
  s_mov_b32 s65, 16777216
L_pollwc:
  ds_read_b32 v3, v2
  s_waitcnt lgkmcnt(0)
  v_cmp_eq_u32 vcc, 0, v3
  s_nop 1
  s_cbranch_vccz L_pollwc_ok
  s_sleep 16
  s_sub_u32 s65, s65, 1
  s_cmp_lg_u32 s65, 0
  s_cbranch_scc1 L_pollwc
L_pollwc_ok:
  s_add_u32 s59, s16, 0
  buffer_load_dwordx4 v[72:75], v249, s[32:35], s59 offen sc1
  s_add_u32 s59, s16, 1024
  buffer_load_dwordx4 v[76:79], v249, s[32:35], s59 offen sc1
  s_add_u32 s59, s16, 2048
  buffer_load_dwordx4 v[80:83], v249, s[32:35], s59 offen sc1
  s_add_u32 s59, s16, 3072
  buffer_load_dwordx4 v[84:87], v249, s[32:35], s59 offen sc1
  s_add_u32 s59, s16, 4096
  buffer_load_dwordx4 v[88:91], v249, s[32:35], s59 offen sc1
  s_add_u32 s59, s16, 5120
  buffer_load_dwordx4 v[92:95], v249, s[32:35], s59 offen sc1
  s_add_u32 s59, s16, 6144
  buffer_load_dwordx4 v[96:99], v249, s[32:35], s59 offen sc1
  s_add_u32 s59, s16, 7168
  buffer_load_dwordx4 v[100:103], v249, s[32:35], s59 offen sc1
  s_add_u32 s59, s16, 8192
  buffer_load_dwordx4 v[104:107], v249, s[32:35], s59 offen sc1
  s_add_u32 s59, s17, 0
  buffer_load_dwordx4 v[108:111], v249, s[32:35], s59 offen sc1
  s_add_u32 s59, s17, 1024
  buffer_load_dwordx4 v[112:115], v249, s[32:35], s59 offen sc1
  s_add_u32 s59, s17, 2048
  buffer_load_dwordx4 v[116:119], v249, s[32:35], s59 offen sc1
  s_add_u32 s59, s17, 3072
  buffer_load_dwordx4 v[120:123], v249, s[32:35], s59 offen sc1
  s_add_u32 s59, s17, 4096
  buffer_load_dwordx4 v[124:127], v249, s[32:35], s59 offen sc1
  s_add_u32 s59, s17, 5120
  buffer_load_dwordx4 v[128:131], v249, s[32:35], s59 offen sc1
  s_add_u32 s59, s17, 6144
  buffer_load_dwordx4 v[132:135], v249, s[32:35], s59 offen sc1
  s_add_u32 s59, s17, 7168
  buffer_load_dwordx4 v[136:139], v249, s[32:35], s59 offen sc1
  s_add_u32 s59, s17, 8192
  buffer_load_dwordx4 v[140:143], v249, s[32:35], s59 offen sc1
  s_add_u32 s59, s18, 0
  buffer_load_dwordx4 v[144:147], v249, s[32:35], s59 offen sc1
  s_add_u32 s59, s18, 1024
  buffer_load_dwordx4 v[148:151], v249, s[32:35], s59 offen sc1
  s_add_u32 s59, s18, 2048
  buffer_load_dwordx4 v[152:155], v249, s[32:35], s59 offen sc1
  s_add_u32 s59, s18, 3072
  buffer_load_dwordx4 v[156:159], v249, s[32:35], s59 offen sc1
  s_add_u32 s59, s18, 4096
  buffer_load_dwordx4 v[160:163], v249, s[32:35], s59 offen sc1
  s_add_u32 s59, s18, 5120
  buffer_load_dwordx4 v[164:167], v249, s[32:35], s59 offen sc1
  s_add_u32 s59, s18, 6144
  buffer_load_dwordx4 v[168:171], v249, s[32:35], s59 offen sc1
  s_add_u32 s59, s18, 7168
  buffer_load_dwordx4 v[172:175], v249, s[32:35], s59 offen sc1
  s_add_u32 s59, s18, 8192
  buffer_load_dwordx4 v[176:179], v249, s[32:35], s59 offen sc1
  s_add_u32 s59, s19, 0
  buffer_load_dwordx4 v[180:183], v249, s[32:35], s59 offen sc1
  s_add_u32 s59, s19, 1024
  buffer_load_dwordx4 v[184:187], v249, s[32:35], s59 offen sc1
  s_add_u32 s59, s19, 2048
  buffer_load_dwordx4 v[188:191], v249, s[32:35], s59 offen sc1
  s_add_u32 s59, s19, 3072
  buffer_load_dwordx4 v[192:195], v249, s[32:35], s59 offen sc1
  s_add_u32 s59, s19, 4096
  buffer_load_dwordx4 v[196:199], v249, s[32:35], s59 offen sc1
  s_add_u32 s59, s19, 5120
  buffer_load_dwordx4 v[200:203], v249, s[32:35], s59 offen sc1
  s_add_u32 s59, s19, 6144
  buffer_load_dwordx4 v[204:207], v249, s[32:35], s59 offen sc1
  s_add_u32 s59, s19, 7168
  buffer_load_dwordx4 v[208:211], v249, s[32:35], s59 offen sc1
  s_add_u32 s59, s19, 8192
  buffer_load_dwordx4 v[212:215], v249, s[32:35], s59 offen sc1
  s_branch L_tail
L_stall1:
  s_mov_b32 s65, 16777216
L_stl1:
  s_sleep 1
  s_nop 0
  ds_read_b32 v241, v252 offset:256
  s_waitcnt lgkmcnt(0)
  v_cmp_ge_u32 vcc, s64, v241
  s_sub_u32 s65, s65, 1
  s_cmp_eq_u32 s65, 0
  s_cbranch_scc1 L_go1
  s_cbranch_vccnz L_stl1
  s_branch L_go1
L_stall2:
  s_mov_b32 s65, 16777216
L_stl2:
  s_sleep 1
  s_nop 0
  ds_read_b32 v241, v252 offset:256
  s_waitcnt lgkmcnt(0)
  v_cmp_ge_u32 vcc, s64, v241
  s_sub_u32 s65, s65, 1
  s_cmp_eq_u32 s65, 0
  s_cbranch_scc1 L_go2
  s_cbranch_vccnz L_stl2
  s_branch L_go2
L_stall3:
  s_mov_b32 s65, 16777216
L_stl3:
  s_sleep 1
  s_nop 0
  ds_read_b32 v241, v252 offset:256
  s_waitcnt lgkmcnt(0)
  v_cmp_ge_u32 vcc, s64, v241
  s_sub_u32 s65, s65, 1
  s_cmp_eq_u32 s65, 0
  s_cbranch_scc1 L_go3
  s_cbranch_vccnz L_stl3
  s_branch L_go3
L_stall4:
  s_mov_b32 s65, 16777216
L_stl4:
  s_sleep 1
  s_nop 0
  ds_read_b32 v241, v252 offset:256
  s_waitcnt lgkmcnt(0)
  v_cmp_ge_u32 vcc, s64, v241
  s_sub_u32 s65, s65, 1
  s_cmp_eq_u32 s65, 0
  s_cbranch_scc1 L_go4
  s_cbranch_vccnz L_stl4
  s_branch L_go4
L_rare1:
  s_call_b64 s[62:63], L_rare_sub1
  s_branch L_back1
L_resc1:
  s_call_b64 s[62:63], L_resc_sub
  s_branch L_rback1
L_rare2:
  s_call_b64 s[62:63], L_rare_sub0
  s_branch L_back2
L_resc2:
  s_call_b64 s[62:63], L_resc_sub
  s_branch L_rback2
L_rare3:
  s_call_b64 s[62:63], L_rare_sub1
  s_branch L_back3
L_resc3:
  s_call_b64 s[62:63], L_resc_sub
  s_branch L_rback3
L_rare4:
  s_call_b64 s[62:63], L_rare_sub0
  s_branch L_back4
L_resc4:
  s_call_b64 s[62:63], L_resc_sub
  s_branch L_rback4
L_rare5:
  s_call_b64 s[62:63], L_rare_sub1
  s_branch L_back5
L_resc5:
  s_call_b64 s[62:63], L_resc_sub
  s_branch L_rback5
L_rare_sub0:
  s_nop 7
  v_max3_f32 v238, v144, v145, v146
  v_max3_f32 v238, v238, v147, v148
  v_max3_f32 v238, v238, v149, v150
  v_max_f32 v238, v238, v151
  v_max3_f32 v239, v152, v153, v154
  v_max3_f32 v239, v239, v155, v156
  v_max3_f32 v239, v239, v157, v158
  v_max_f32 v239, v239, v159
  v_max3_f32 v240, v160, v161, v162
  v_max3_f32 v240, v240, v163, v164
  v_max3_f32 v240, v240, v165, v166
  v_max_f32 v240, v240, v167
  v_mov_b32 v241, v238
  s_nop 1
  v_permlane32_swap_b32 v238, v241
  v_max_f32 v238, v238, v241
  v_mov_b32 v241, v238
  s_nop 1
  v_permlane16_swap_b32 v238, v241
  v_max_f32 v238, v238, v241
  v_max_f32 v238, 0, v238
  v_sub_f32 v144, v144, v238
  v_sub_f32 v145, v145, v238
  v_sub_f32 v146, v146, v238
  v_sub_f32 v147, v147, v238
  v_sub_f32 v148, v148, v238
  v_sub_f32 v149, v149, v238
  v_sub_f32 v150, v150, v238
  v_sub_f32 v151, v151, v238
  v_sub_f32 v192, v192, v238
  v_sub_f32 v193, v193, v238
  v_sub_f32 v194, v194, v238
  v_sub_f32 v195, v195, v238
  v_exp_f32 v238, -v238
  v_mov_b32 v241, v239
  s_nop 1
  v_permlane32_swap_b32 v239, v241
  v_max_f32 v239, v239, v241
  v_mov_b32 v241, v239
  s_nop 1
  v_permlane16_swap_b32 v239, v241
  v_max_f32 v239, v239, v241
  v_max_f32 v239, 0, v239
  v_sub_f32 v152, v152, v239
  v_sub_f32 v153, v153, v239
  v_sub_f32 v154, v154, v239
  v_sub_f32 v155, v155, v239
  v_sub_f32 v156, v156, v239
  v_sub_f32 v157, v157, v239
  v_sub_f32 v158, v158, v239
  v_sub_f32 v159, v159, v239
  v_sub_f32 v196, v196, v239
  v_sub_f32 v197, v197, v239
  v_sub_f32 v198, v198, v239
  v_sub_f32 v199, v199, v239
  v_exp_f32 v239, -v239
  v_mov_b32 v241, v240
  s_nop 1
  v_permlane32_swap_b32 v240, v241
  v_max_f32 v240, v240, v241
  v_mov_b32 v241, v240
  s_nop 1
  v_permlane16_swap_b32 v240, v241
  v_max_f32 v240, v240, v241
  v_max_f32 v240, 0, v240
  v_sub_f32 v160, v160, v240
  v_sub_f32 v161, v161, v240
  v_sub_f32 v162, v162, v240
  v_sub_f32 v163, v163, v240
  v_sub_f32 v164, v164, v240
  v_sub_f32 v165, v165, v240
  v_sub_f32 v166, v166, v240
  v_sub_f32 v167, v167, v240
  v_sub_f32 v200, v200, v240
  v_sub_f32 v201, v201, v240
  v_sub_f32 v202, v202, v240
  v_sub_f32 v203, v203, v240
  v_exp_f32 v240, -v240
  s_mov_b32 s60, 1
  s_nop 1
  s_setpc_b64 s[62:63]
L_rare_sub1:
  s_nop 7
  v_max3_f32 v238, v168, v169, v170
  v_max3_f32 v238, v238, v171, v172
  v_max3_f32 v238, v238, v173, v174
  v_max_f32 v238, v238, v175
  v_max3_f32 v239, v176, v177, v178
  v_max3_f32 v239, v239, v179, v180
  v_max3_f32 v239, v239, v181, v182
  v_max_f32 v239, v239, v183
  v_max3_f32 v240, v184, v185, v186
  v_max3_f32 v240, v240, v187, v188
  v_max3_f32 v240, v240, v189, v190
  v_max_f32 v240, v240, v191
  v_mov_b32 v241, v238
  s_nop 1
  v_permlane32_swap_b32 v238, v241
  v_max_f32 v238, v238, v241
  v_mov_b32 v241, v238
  s_nop 1
  v_permlane16_swap_b32 v238, v241
  v_max_f32 v238, v238, v241
  v_max_f32 v238, 0, v238
  v_sub_f32 v168, v168, v238
  v_sub_f32 v169, v169, v238
  v_sub_f32 v170, v170, v238
  v_sub_f32 v171, v171, v238
  v_sub_f32 v172, v172, v238
  v_sub_f32 v173, v173, v238
  v_sub_f32 v174, v174, v238
  v_sub_f32 v175, v175, v238
  v_sub_f32 v192, v192, v238
  v_sub_f32 v193, v193, v238
  v_sub_f32 v194, v194, v238
  v_sub_f32 v195, v195, v238
  v_exp_f32 v238, -v238
  v_mov_b32 v241, v239
  s_nop 1
  v_permlane32_swap_b32 v239, v241
  v_max_f32 v239, v239, v241
  v_mov_b32 v241, v239
  s_nop 1
  v_permlane16_swap_b32 v239, v241
  v_max_f32 v239, v239, v241
  v_max_f32 v239, 0, v239
  v_sub_f32 v176, v176, v239
  v_sub_f32 v177, v177, v239
  v_sub_f32 v178, v178, v239
  v_sub_f32 v179, v179, v239
  v_sub_f32 v180, v180, v239
  v_sub_f32 v181, v181, v239
  v_sub_f32 v182, v182, v239
  v_sub_f32 v183, v183, v239
  v_sub_f32 v196, v196, v239
  v_sub_f32 v197, v197, v239
  v_sub_f32 v198, v198, v239
  v_sub_f32 v199, v199, v239
  v_exp_f32 v239, -v239
  v_mov_b32 v241, v240
  s_nop 1
  v_permlane32_swap_b32 v240, v241
  v_max_f32 v240, v240, v241
  v_mov_b32 v241, v240
  s_nop 1
  v_permlane16_swap_b32 v240, v241
  v_max_f32 v240, v240, v241
  v_max_f32 v240, 0, v240
  v_sub_f32 v184, v184, v240
  v_sub_f32 v185, v185, v240
  v_sub_f32 v186, v186, v240
  v_sub_f32 v187, v187, v240
  v_sub_f32 v188, v188, v240
  v_sub_f32 v189, v189, v240
  v_sub_f32 v190, v190, v240
  v_sub_f32 v191, v191, v240
  v_sub_f32 v200, v200, v240
  v_sub_f32 v201, v201, v240
  v_sub_f32 v202, v202, v240
  v_sub_f32 v203, v203, v240
  v_exp_f32 v240, -v240
  s_mov_b32 s60, 1
  s_nop 1
  s_setpc_b64 s[62:63]
L_resc_sub:
  s_nop 7
  s_nop 7
  v_mul_f32 v0, v0, v238
  v_mul_f32 v1, v1, v238
  v_mul_f32 v2, v2, v238
  v_mul_f32 v3, v3, v238
  v_mul_f32 v12, v12, v238
  v_mul_f32 v13, v13, v238
  v_mul_f32 v14, v14, v238
  v_mul_f32 v15, v15, v238
  v_mul_f32 v24, v24, v238
  v_mul_f32 v25, v25, v238
  v_mul_f32 v26, v26, v238
  v_mul_f32 v27, v27, v238
  v_mul_f32 v36, v36, v238
  v_mul_f32 v37, v37, v238
  v_mul_f32 v38, v38, v238
  v_mul_f32 v39, v39, v238
  v_mul_f32 v48, v48, v238
  v_mul_f32 v49, v49, v238
  v_mul_f32 v50, v50, v238
  v_mul_f32 v51, v51, v238
  v_mul_f32 v60, v60, v238
  v_mul_f32 v61, v61, v238
  v_mul_f32 v62, v62, v238
  v_mul_f32 v63, v63, v238
  v_mul_f32 v72, v72, v238
  v_mul_f32 v73, v73, v238
  v_mul_f32 v74, v74, v238
  v_mul_f32 v75, v75, v238
  v_mul_f32 v84, v84, v238
  v_mul_f32 v85, v85, v238
  v_mul_f32 v86, v86, v238
  v_mul_f32 v87, v87, v238
  v_mul_f32 v204, v204, v238
  v_mul_f32 v205, v205, v238
  v_mul_f32 v206, v206, v238
  v_mul_f32 v207, v207, v238
  v_mul_f32 v4, v4, v239
  v_mul_f32 v5, v5, v239
  v_mul_f32 v6, v6, v239
  v_mul_f32 v7, v7, v239
  v_mul_f32 v16, v16, v239
  v_mul_f32 v17, v17, v239
  v_mul_f32 v18, v18, v239
  v_mul_f32 v19, v19, v239
  v_mul_f32 v28, v28, v239
  v_mul_f32 v29, v29, v239
  v_mul_f32 v30, v30, v239
  v_mul_f32 v31, v31, v239
  v_mul_f32 v40, v40, v239
  v_mul_f32 v41, v41, v239
  v_mul_f32 v42, v42, v239
  v_mul_f32 v43, v43, v239
  v_mul_f32 v52, v52, v239
  v_mul_f32 v53, v53, v239
  v_mul_f32 v54, v54, v239
  v_mul_f32 v55, v55, v239
  v_mul_f32 v64, v64, v239
  v_mul_f32 v65, v65, v239
  v_mul_f32 v66, v66, v239
  v_mul_f32 v67, v67, v239
  v_mul_f32 v76, v76, v239
  v_mul_f32 v77, v77, v239
  v_mul_f32 v78, v78, v239
  v_mul_f32 v79, v79, v239
  v_mul_f32 v88, v88, v239
  v_mul_f32 v89, v89, v239
  v_mul_f32 v90, v90, v239
  v_mul_f32 v91, v91, v239
  v_mul_f32 v208, v208, v239
  v_mul_f32 v209, v209, v239
  v_mul_f32 v210, v210, v239
  v_mul_f32 v211, v211, v239
  v_mul_f32 v8, v8, v240
  v_mul_f32 v9, v9, v240
  v_mul_f32 v10, v10, v240
  v_mul_f32 v11, v11, v240
  v_mul_f32 v20, v20, v240
  v_mul_f32 v21, v21, v240
  v_mul_f32 v22, v22, v240
  v_mul_f32 v23, v23, v240
  v_mul_f32 v32, v32, v240
  v_mul_f32 v33, v33, v240
  v_mul_f32 v34, v34, v240
  v_mul_f32 v35, v35, v240
  v_mul_f32 v44, v44, v240
  v_mul_f32 v45, v45, v240
  v_mul_f32 v46, v46, v240
  v_mul_f32 v47, v47, v240
  v_mul_f32 v56, v56, v240
  v_mul_f32 v57, v57, v240
  v_mul_f32 v58, v58, v240
  v_mul_f32 v59, v59, v240
  v_mul_f32 v68, v68, v240
  v_mul_f32 v69, v69, v240
  v_mul_f32 v70, v70, v240
  v_mul_f32 v71, v71, v240
  v_mul_f32 v80, v80, v240
  v_mul_f32 v81, v81, v240
  v_mul_f32 v82, v82, v240
  v_mul_f32 v83, v83, v240
  v_mul_f32 v92, v92, v240
  v_mul_f32 v93, v93, v240
  v_mul_f32 v94, v94, v240
  v_mul_f32 v95, v95, v240
  v_mul_f32 v212, v212, v240
  v_mul_f32 v213, v213, v240
  v_mul_f32 v214, v214, v240
  v_mul_f32 v215, v215, v240
  s_mov_b32 s60, 0
  s_nop 1
  s_setpc_b64 s[62:63]
L_hk:
  v_lshlrev_b32 v10, 4, v0
  v_lshlrev_b32 v11, 4, v0
  v_lshlrev_b32 v12, 4, v0
  s_mul_i32 s55, s2, 8
  s_lshr_b32 s55, s55, 3
  v_lshlrev_b32 v6, 2, v0
  v_add_u32 v6, 163072, v6
  s_lshr_b32 s63, s2, 3
  s_and_b32 s63, s63, 7
  s_mul_i32 s63, s63, 0
  v_and_b32 v8, 3, v255
  v_lshlrev_b32 v8, 6, v8
  v_add_u32 v8, 162816, v8
  v_lshlrev_b32 v251, 4, v255
  s_mul_i32 s64, s70, 393216
  s_mul_i32 s65, s54, 49152
  s_add_u32 s64, s64, s65
  v_add_u32 v248, s64, v251
  s_mul_i32 s64, s71, 589824
  s_mul_i32 s65, s54, 73728
  s_add_u32 s64, s64, s65
  v_add_u32 v249, s64, v251
  s_add_u32 s64, s47, 0
  s_and_b32 s64, s64, 7
  s_mul_i32 s36, s64, 6144
  s_mul_i32 s16, s64, 9216
  s_add_u32 s64, s47, 1
  s_and_b32 s64, s64, 7
  s_mul_i32 s37, s64, 6144
  s_mul_i32 s17, s64, 9216
  s_add_u32 s64, s47, 2
  s_and_b32 s64, s64, 7
  s_mul_i32 s38, s64, 6144
  s_mul_i32 s18, s64, 9216
  s_add_u32 s64, s47, 3
  s_and_b32 s64, s64, 7
  s_mul_i32 s39, s64, 6144
  s_mul_i32 s19, s64, 9216
  s_add_u32 s64, s47, 4
  s_and_b32 s64, s64, 7
  s_mul_i32 s40, s64, 6144
  s_mul_i32 s20, s64, 9216
  s_add_u32 s64, s47, 5
  s_and_b32 s64, s64, 7
  s_mul_i32 s41, s64, 6144
  s_mul_i32 s21, s64, 9216
  s_add_u32 s64, s47, 6
  s_and_b32 s64, s64, 7
  s_mul_i32 s42, s64, 6144
  s_mul_i32 s22, s64, 9216
  s_add_u32 s64, s47, 7
  s_and_b32 s64, s64, 7
  s_mul_i32 s43, s64, 6144
  s_mul_i32 s23, s64, 9216
  s_mov_b32 s66, 27648
  s_mov_b32 s67, 36864
  s_cmp_eq_u32 s54, 1
  s_cselect_b32 s66, 46080, s66
  s_cselect_b32 s67, 55296, s67
  s_cmp_eq_u32 s54, 2
  s_cselect_b32 s66, 86016, s66
  s_cselect_b32 s67, 95232, s67
  s_cmp_eq_u32 s54, 3
  s_cselect_b32 s66, 104448, s66
  s_cselect_b32 s67, 113664, s67
  s_cmp_eq_u32 s54, 4
  s_cselect_b32 s66, 9216, s66
  s_cselect_b32 s67, 67584, s67
  s_cmp_eq_u32 s54, 5
  s_cselect_b32 s66, 18432, s66
  s_cselect_b32 s67, 76800, s67
  s_cmp_eq_u32 s54, 6
  s_cselect_b32 s66, 135168, s66
  s_cselect_b32 s67, 144384, s67
  s_cmp_eq_u32 s54, 7
  s_cselect_b32 s66, 153600, s66
  s_cselect_b32 s67, 0, s67
  s_mov_b32 s88, s66
  s_mov_b32 s89, s67
  v_add_u32 v250, s66, v251
  s_barrier
  s_barrier
  s_add_u32 s64, s55, 0
  s_and_b32 s64, s64, 31
  s_lshl_b32 s64, s64, 13
  s_mov_b32 m0, 0
  s_add_u32 s59, s64, 0
  buffer_load_dwordx4 v10, s[8:11], s59 offen nt lds
  s_mov_b32 m0, 1056
  s_add_u32 s59, s64, 1024
  buffer_load_dwordx4 v10, s[8:11], s59 offen nt lds
  s_mov_b32 m0, 2112
  s_add_u32 s59, s64, 2048
  buffer_load_dwordx4 v10, s[8:11], s59 offen nt lds
  s_mov_b32 m0, 3168
  s_add_u32 s59, s64, 3072
  buffer_load_dwordx4 v10, s[8:11], s59 offen nt lds
  s_mov_b32 m0, 4224
  s_add_u32 s59, s64, 4096
  buffer_load_dwordx4 v12, s[8:11], s59 offen nt lds
  s_mov_b32 m0, 5280
  s_add_u32 s59, s64, 5120
  buffer_load_dwordx4 v12, s[8:11], s59 offen nt lds
  s_mov_b32 m0, 6336
  s_add_u32 s59, s64, 6144
  buffer_load_dwordx4 v12, s[8:11], s59 offen nt lds
  s_mov_b32 m0, 7392
  s_add_u32 s59, s64, 7168
  buffer_load_dwordx4 v12, s[8:11], s59 offen nt lds
  s_barrier
  s_add_u32 s64, s55, 1
  s_and_b32 s64, s64, 31
  s_lshl_b32 s64, s64, 13
  s_mov_b32 m0, 8448
  s_add_u32 s59, s64, 0
  buffer_load_dwordx4 v10, s[8:11], s59 offen nt lds
  s_mov_b32 m0, 9504
  s_add_u32 s59, s64, 1024
  buffer_load_dwordx4 v10, s[8:11], s59 offen nt lds
  s_mov_b32 m0, 10560
  s_add_u32 s59, s64, 2048
  buffer_load_dwordx4 v10, s[8:11], s59 offen nt lds
  s_mov_b32 m0, 11616
  s_add_u32 s59, s64, 3072
  buffer_load_dwordx4 v10, s[8:11], s59 offen nt lds
  s_mov_b32 m0, 12672
  s_add_u32 s59, s64, 4096
  buffer_load_dwordx4 v12, s[8:11], s59 offen nt lds
  s_mov_b32 m0, 13728
  s_add_u32 s59, s64, 5120
  buffer_load_dwordx4 v12, s[8:11], s59 offen nt lds
  s_mov_b32 m0, 14784
  s_add_u32 s59, s64, 6144
  buffer_load_dwordx4 v12, s[8:11], s59 offen nt lds
  s_mov_b32 m0, 15840
  s_add_u32 s59, s64, 7168
  buffer_load_dwordx4 v12, s[8:11], s59 offen nt lds
  s_barrier
  s_barrier
  s_add_u32 s64, s55, 0
  s_and_b32 s64, s64, 31
  s_lshl_b32 s64, s64, 13
  s_mov_b32 m0, 67584
  s_add_u32 s59, s64, 0
  buffer_load_dwordx4 v11, s[12:15], s59 offen nt lds
  s_mov_b32 m0, 68640
  s_add_u32 s59, s64, 1024
  buffer_load_dwordx4 v11, s[12:15], s59 offen nt lds
  s_mov_b32 m0, 69696
  s_add_u32 s59, s64, 2048
  buffer_load_dwordx4 v11, s[12:15], s59 offen nt lds
  s_mov_b32 m0, 70752
  s_add_u32 s59, s64, 3072
  buffer_load_dwordx4 v11, s[12:15], s59 offen nt lds
  s_mov_b32 m0, 71808
  s_add_u32 s59, s64, 4096
  buffer_load_dwordx4 v11, s[12:15], s59 offen nt lds
  s_mov_b32 m0, 72864
  s_add_u32 s59, s64, 5120
  buffer_load_dwordx4 v11, s[12:15], s59 offen nt lds
  s_mov_b32 m0, 73920
  s_add_u32 s59, s64, 6144
  buffer_load_dwordx4 v11, s[12:15], s59 offen nt lds
  s_mov_b32 m0, 74976
  s_add_u32 s59, s64, 7168
  buffer_load_dwordx4 v11, s[12:15], s59 offen nt lds
  s_barrier
  s_barrier
  s_add_u32 s64, s55, 2
  s_and_b32 s64, s64, 31
  s_lshl_b32 s64, s64, 13
  s_mov_b32 m0, 16896
  s_add_u32 s59, s64, 0
  buffer_load_dwordx4 v10, s[8:11], s59 offen nt lds
  s_mov_b32 m0, 17952
  s_add_u32 s59, s64, 1024
  buffer_load_dwordx4 v10, s[8:11], s59 offen nt lds
  s_mov_b32 m0, 19008
  s_add_u32 s59, s64, 2048
  buffer_load_dwordx4 v10, s[8:11], s59 offen nt lds
  s_mov_b32 m0, 20064
  s_add_u32 s59, s64, 3072
  buffer_load_dwordx4 v10, s[8:11], s59 offen nt lds
  s_mov_b32 m0, 21120
  s_add_u32 s59, s64, 4096
  buffer_load_dwordx4 v12, s[8:11], s59 offen nt lds
  s_mov_b32 m0, 22176
  s_add_u32 s59, s64, 5120
  buffer_load_dwordx4 v12, s[8:11], s59 offen nt lds
  s_mov_b32 m0, 23232
  s_add_u32 s59, s64, 6144
  buffer_load_dwordx4 v12, s[8:11], s59 offen nt lds
  s_mov_b32 m0, 24288
  s_add_u32 s59, s64, 7168
  buffer_load_dwordx4 v12, s[8:11], s59 offen nt lds
  s_barrier
  s_add_u32 s64, s55, 1
  s_and_b32 s64, s64, 31
  s_lshl_b32 s64, s64, 13
  s_mov_b32 m0, 76032
  s_add_u32 s59, s64, 0
  buffer_load_dwordx4 v11, s[12:15], s59 offen nt lds
  s_mov_b32 m0, 77088
  s_add_u32 s59, s64, 1024
  buffer_load_dwordx4 v11, s[12:15], s59 offen nt lds
  s_mov_b32 m0, 78144
  s_add_u32 s59, s64, 2048
  buffer_load_dwordx4 v11, s[12:15], s59 offen nt lds
  s_mov_b32 m0, 79200
  s_add_u32 s59, s64, 3072
  buffer_load_dwordx4 v11, s[12:15], s59 offen nt lds
  s_mov_b32 m0, 80256
  s_add_u32 s59, s64, 4096
  buffer_load_dwordx4 v11, s[12:15], s59 offen nt lds
  s_mov_b32 m0, 81312
  s_add_u32 s59, s64, 5120
  buffer_load_dwordx4 v11, s[12:15], s59 offen nt lds
  s_mov_b32 m0, 82368
  s_add_u32 s59, s64, 6144
  buffer_load_dwordx4 v11, s[12:15], s59 offen nt lds
  s_mov_b32 m0, 83424
  s_add_u32 s59, s64, 7168
  buffer_load_dwordx4 v11, s[12:15], s59 offen nt lds
  s_barrier
  s_barrier
  s_add_u32 s64, s55, 3
  s_and_b32 s64, s64, 31
  s_lshl_b32 s64, s64, 13
  s_mov_b32 m0, 25344
  s_add_u32 s59, s64, 0
  buffer_load_dwordx4 v10, s[8:11], s59 offen nt lds
  s_mov_b32 m0, 26400
  s_add_u32 s59, s64, 1024
  buffer_load_dwordx4 v10, s[8:11], s59 offen nt lds
  s_mov_b32 m0, 27456
  s_add_u32 s59, s64, 2048
  buffer_load_dwordx4 v10, s[8:11], s59 offen nt lds
  s_mov_b32 m0, 28512
  s_add_u32 s59, s64, 3072
  buffer_load_dwordx4 v10, s[8:11], s59 offen nt lds
  s_mov_b32 m0, 29568
  s_add_u32 s59, s64, 4096
  buffer_load_dwordx4 v12, s[8:11], s59 offen nt lds
  s_mov_b32 m0, 30624
  s_add_u32 s59, s64, 5120
  buffer_load_dwordx4 v12, s[8:11], s59 offen nt lds
  s_mov_b32 m0, 31680
  s_add_u32 s59, s64, 6144
  buffer_load_dwordx4 v12, s[8:11], s59 offen nt lds
  s_mov_b32 m0, 32736
  s_add_u32 s59, s64, 7168
  buffer_load_dwordx4 v12, s[8:11], s59 offen nt lds
  s_barrier
  s_barrier
  s_add_u32 s64, s55, 2
  s_and_b32 s64, s64, 31
  s_lshl_b32 s64, s64, 13
  s_mov_b32 m0, 84480
  s_add_u32 s59, s64, 0
  buffer_load_dwordx4 v11, s[12:15], s59 offen nt lds
  s_mov_b32 m0, 85536
  s_add_u32 s59, s64, 1024
  buffer_load_dwordx4 v11, s[12:15], s59 offen nt lds
  s_mov_b32 m0, 86592
  s_add_u32 s59, s64, 2048
  buffer_load_dwordx4 v11, s[12:15], s59 offen nt lds
  s_mov_b32 m0, 87648
  s_add_u32 s59, s64, 3072
  buffer_load_dwordx4 v11, s[12:15], s59 offen nt lds
  s_mov_b32 m0, 88704
  s_add_u32 s59, s64, 4096
  buffer_load_dwordx4 v11, s[12:15], s59 offen nt lds
  s_mov_b32 m0, 89760
  s_add_u32 s59, s64, 5120
  buffer_load_dwordx4 v11, s[12:15], s59 offen nt lds
  s_mov_b32 m0, 90816
  s_add_u32 s59, s64, 6144
  buffer_load_dwordx4 v11, s[12:15], s59 offen nt lds
  s_mov_b32 m0, 91872
  s_add_u32 s59, s64, 7168
  buffer_load_dwordx4 v11, s[12:15], s59 offen nt lds
  s_barrier
  s_barrier
  s_barrier
  s_barrier
  s_barrier
  s_barrier
  s_waitcnt vmcnt(40)
  s_barrier
  s_waitcnt vmcnt(24)
  v_mov_b32 v7, 1
  ds_write_b32 v6, v7
  s_waitcnt vmcnt(8)
  v_mov_b32 v7, 2
  ds_write_b32 v6, v7
  s_add_u32 s64, s55, 6
  s_and_b32 s64, s64, 31
  s_lshl_b32 s64, s64, 13
  s_mov_b32 m0, 50688
  s_add_u32 s59, s64, 0
  buffer_load_dwordx4 v10, s[8:11], s59 offen nt lds
  s_mov_b32 m0, 51744
  s_add_u32 s59, s64, 1024
  buffer_load_dwordx4 v10, s[8:11], s59 offen nt lds
  s_mov_b32 m0, 52800
  s_add_u32 s59, s64, 2048
  buffer_load_dwordx4 v10, s[8:11], s59 offen nt lds
  s_mov_b32 m0, 53856
  s_add_u32 s59, s64, 3072
  buffer_load_dwordx4 v10, s[8:11], s59 offen nt lds
  s_mov_b32 m0, 54912
  s_add_u32 s59, s64, 4096
  buffer_load_dwordx4 v12, s[8:11], s59 offen nt lds
  s_mov_b32 m0, 55968
  s_add_u32 s59, s64, 5120
  buffer_load_dwordx4 v12, s[8:11], s59 offen nt lds
  s_mov_b32 m0, 57024
  s_add_u32 s59, s64, 6144
  buffer_load_dwordx4 v12, s[8:11], s59 offen nt lds
  s_mov_b32 m0, 58080
  s_add_u32 s59, s64, 7168
  buffer_load_dwordx4 v12, s[8:11], s59 offen nt lds
  ds_read_b32 v9, v8
  s_waitcnt vmcnt(8)
  v_mov_b32 v14, 163332
  s_mov_b32 s65, 16777216
L_w5c:
  ds_read_b32 v15, v14
  s_waitcnt lgkmcnt(0)
  v_cmp_gt_u32 vcc, 4, v15
  s_nop 1
  s_cbranch_vccz L_w5c_ok
  s_sleep 1
  s_sub_u32 s65, s65, 1
  s_cmp_lg_u32 s65, 0
  s_cbranch_scc1 L_w5c
L_w5c_ok:
  v_mov_b32 v7, 4
  ds_write_b32 v6, v7
  s_mov_b32 s65, 16777216
  s_waitcnt lgkmcnt(0)
  s_branch L_kv1_t
L_kv1:
  ds_read_b32 v9, v8
  s_waitcnt lgkmcnt(0)
L_kv1_t:
  v_cmp_gt_u32 vcc, 4, v9
  s_nop 1
  s_cbranch_vccz L_kv1_ok
  s_sleep 1
  s_sub_u32 s65, s65, 1
  s_cmp_lg_u32 s65, 0
  s_cbranch_scc1 L_kv1
L_kv1_ok:
  s_add_u32 s64, s55, 7
  s_and_b32 s64, s64, 31
  s_lshl_b32 s64, s64, 13
  s_mov_b32 m0, 59136
  s_add_u32 s59, s64, 0
  buffer_load_dwordx4 v10, s[8:11], s59 offen nt lds
  s_mov_b32 m0, 60192
  s_add_u32 s59, s64, 1024
  buffer_load_dwordx4 v10, s[8:11], s59 offen nt lds
  s_mov_b32 m0, 61248
  s_add_u32 s59, s64, 2048
  buffer_load_dwordx4 v10, s[8:11], s59 offen nt lds
  s_mov_b32 m0, 62304
  s_add_u32 s59, s64, 3072
  buffer_load_dwordx4 v10, s[8:11], s59 offen nt lds
  s_mov_b32 m0, 63360
  s_add_u32 s59, s64, 4096
  buffer_load_dwordx4 v12, s[8:11], s59 offen nt lds
  s_mov_b32 m0, 64416
  s_add_u32 s59, s64, 5120
  buffer_load_dwordx4 v12, s[8:11], s59 offen nt lds
  s_mov_b32 m0, 65472
  s_add_u32 s59, s64, 6144
  buffer_load_dwordx4 v12, s[8:11], s59 offen nt lds
  s_mov_b32 m0, 66528
  s_add_u32 s59, s64, 7168
  buffer_load_dwordx4 v12, s[8:11], s59 offen nt lds
  s_add_u32 s64, s55, 8
  s_and_b32 s64, s64, 31
  s_lshl_b32 s64, s64, 13
  s_mov_b32 m0, 0
  s_add_u32 s59, s64, 0
  buffer_load_dwordx4 v10, s[8:11], s59 offen nt lds
  s_mov_b32 m0, 1056
  s_add_u32 s59, s64, 1024
  buffer_load_dwordx4 v10, s[8:11], s59 offen nt lds
  s_mov_b32 m0, 2112
  s_add_u32 s59, s64, 2048
  buffer_load_dwordx4 v10, s[8:11], s59 offen nt lds
  s_mov_b32 m0, 3168
  s_add_u32 s59, s64, 3072
  buffer_load_dwordx4 v10, s[8:11], s59 offen nt lds
  s_mov_b32 m0, 4224
  s_add_u32 s59, s64, 4096
  buffer_load_dwordx4 v12, s[8:11], s59 offen nt lds
  s_mov_b32 m0, 5280
  s_add_u32 s59, s64, 5120
  buffer_load_dwordx4 v12, s[8:11], s59 offen nt lds
  s_mov_b32 m0, 6336
  s_add_u32 s59, s64, 6144
  buffer_load_dwordx4 v12, s[8:11], s59 offen nt lds
  s_mov_b32 m0, 7392
  s_add_u32 s59, s64, 7168
  buffer_load_dwordx4 v12, s[8:11], s59 offen nt lds
  s_add_u32 s64, s55, 5
  s_and_b32 s64, s64, 31
  s_lshl_b32 s64, s64, 13
  s_mov_b32 m0, 109824
  s_add_u32 s59, s64, 0
  buffer_load_dwordx4 v11, s[12:15], s59 offen nt lds
  s_mov_b32 m0, 110880
  s_add_u32 s59, s64, 1024
  buffer_load_dwordx4 v11, s[12:15], s59 offen nt lds
  s_mov_b32 m0, 111936
  s_add_u32 s59, s64, 2048
  buffer_load_dwordx4 v11, s[12:15], s59 offen nt lds
  s_mov_b32 m0, 112992
  s_add_u32 s59, s64, 3072
  buffer_load_dwordx4 v11, s[12:15], s59 offen nt lds
  s_mov_b32 m0, 114048
  s_add_u32 s59, s64, 4096
  buffer_load_dwordx4 v11, s[12:15], s59 offen nt lds
  s_mov_b32 m0, 115104
  s_add_u32 s59, s64, 5120
  buffer_load_dwordx4 v11, s[12:15], s59 offen nt lds
  s_mov_b32 m0, 116160
  s_add_u32 s59, s64, 6144
  buffer_load_dwordx4 v11, s[12:15], s59 offen nt lds
  s_mov_b32 m0, 117216
  s_add_u32 s59, s64, 7168
  buffer_load_dwordx4 v11, s[12:15], s59 offen nt lds
  s_add_u32 s64, s55, 6
  s_and_b32 s64, s64, 31
  s_lshl_b32 s64, s64, 13
  s_mov_b32 m0, 118272
  s_add_u32 s59, s64, 0
  buffer_load_dwordx4 v11, s[12:15], s59 offen nt lds
  s_mov_b32 m0, 119328
  s_add_u32 s59, s64, 1024
  buffer_load_dwordx4 v11, s[12:15], s59 offen nt lds
  s_mov_b32 m0, 120384
  s_add_u32 s59, s64, 2048
  buffer_load_dwordx4 v11, s[12:15], s59 offen nt lds
  s_mov_b32 m0, 121440
  s_add_u32 s59, s64, 3072
  buffer_load_dwordx4 v11, s[12:15], s59 offen nt lds
  s_mov_b32 m0, 122496
  s_add_u32 s59, s64, 4096
  buffer_load_dwordx4 v11, s[12:15], s59 offen nt lds
  s_mov_b32 m0, 123552
  s_add_u32 s59, s64, 5120
  buffer_load_dwordx4 v11, s[12:15], s59 offen nt lds
  s_mov_b32 m0, 124608
  s_add_u32 s59, s64, 6144
  buffer_load_dwordx4 v11, s[12:15], s59 offen nt lds
  s_mov_b32 m0, 125664
  s_add_u32 s59, s64, 7168
  buffer_load_dwordx4 v11, s[12:15], s59 offen nt lds
  ds_read_b32 v9, v8
  s_waitcnt vmcnt(8)
  v_mov_b32 v7, 6
  ds_write_b32 v6, v7
  s_mov_b32 s65, 16777216
  s_waitcnt lgkmcnt(0)
  s_branch L_kv2_t
L_kv2:
  ds_read_b32 v9, v8
  s_waitcnt lgkmcnt(0)
L_kv2_t:
  v_cmp_gt_u32 vcc, 12, v9
  s_nop 1
  s_cbranch_vccz L_kv2_ok
  s_sleep 1
  s_sub_u32 s65, s65, 1
  s_cmp_lg_u32 s65, 0
  s_cbranch_scc1 L_kv2
L_kv2_ok:
  s_add_u32 s64, s55, 9
  s_and_b32 s64, s64, 31
  s_lshl_b32 s64, s64, 13
  s_mov_b32 m0, 8448
  s_add_u32 s59, s64, 0
  buffer_load_dwordx4 v10, s[8:11], s59 offen nt lds
  s_mov_b32 m0, 9504
  s_add_u32 s59, s64, 1024
  buffer_load_dwordx4 v10, s[8:11], s59 offen nt lds
  s_mov_b32 m0, 10560
  s_add_u32 s59, s64, 2048
  buffer_load_dwordx4 v10, s[8:11], s59 offen nt lds
  s_mov_b32 m0, 11616
  s_add_u32 s59, s64, 3072
  buffer_load_dwordx4 v10, s[8:11], s59 offen nt lds
  s_mov_b32 m0, 12672
  s_add_u32 s59, s64, 4096
  buffer_load_dwordx4 v12, s[8:11], s59 offen nt lds
  s_mov_b32 m0, 13728
  s_add_u32 s59, s64, 5120
  buffer_load_dwordx4 v12, s[8:11], s59 offen nt lds
  s_mov_b32 m0, 14784
  s_add_u32 s59, s64, 6144
  buffer_load_dwordx4 v12, s[8:11], s59 offen nt lds
  s_mov_b32 m0, 15840
  s_add_u32 s59, s64, 7168
  buffer_load_dwordx4 v12, s[8:11], s59 offen nt lds
  s_add_u32 s64, s55, 10
  s_and_b32 s64, s64, 31
  s_lshl_b32 s64, s64, 13
  s_mov_b32 m0, 16896
  s_add_u32 s59, s64, 0
  buffer_load_dwordx4 v10, s[8:11], s59 offen nt lds
  s_mov_b32 m0, 17952
  s_add_u32 s59, s64, 1024
  buffer_load_dwordx4 v10, s[8:11], s59 offen nt lds
  s_mov_b32 m0, 19008
  s_add_u32 s59, s64, 2048
  buffer_load_dwordx4 v10, s[8:11], s59 offen nt lds
  s_mov_b32 m0, 20064
  s_add_u32 s59, s64, 3072
  buffer_load_dwordx4 v10, s[8:11], s59 offen nt lds
  s_mov_b32 m0, 21120
  s_add_u32 s59, s64, 4096
  buffer_load_dwordx4 v12, s[8:11], s59 offen nt lds
  s_mov_b32 m0, 22176
  s_add_u32 s59, s64, 5120
  buffer_load_dwordx4 v12, s[8:11], s59 offen nt lds
  s_mov_b32 m0, 23232
  s_add_u32 s59, s64, 6144
  buffer_load_dwordx4 v12, s[8:11], s59 offen nt lds
  s_mov_b32 m0, 24288
  s_add_u32 s59, s64, 7168
  buffer_load_dwordx4 v12, s[8:11], s59 offen nt lds
  s_add_u32 s64, s55, 7
  s_and_b32 s64, s64, 31
  s_lshl_b32 s64, s64, 13
  s_mov_b32 m0, 126720
  s_add_u32 s59, s64, 0
  buffer_load_dwordx4 v11, s[12:15], s59 offen nt lds
  s_mov_b32 m0, 127776
  s_add_u32 s59, s64, 1024
  buffer_load_dwordx4 v11, s[12:15], s59 offen nt lds
  s_mov_b32 m0, 128832
  s_add_u32 s59, s64, 2048
  buffer_load_dwordx4 v11, s[12:15], s59 offen nt lds
  s_mov_b32 m0, 129888
  s_add_u32 s59, s64, 3072
  buffer_load_dwordx4 v11, s[12:15], s59 offen nt lds
  s_mov_b32 m0, 130944
  s_add_u32 s59, s64, 4096
  buffer_load_dwordx4 v11, s[12:15], s59 offen nt lds
  s_mov_b32 m0, 132000
  s_add_u32 s59, s64, 5120
  buffer_load_dwordx4 v11, s[12:15], s59 offen nt lds
  s_mov_b32 m0, 133056
  s_add_u32 s59, s64, 6144
  buffer_load_dwordx4 v11, s[12:15], s59 offen nt lds
  s_mov_b32 m0, 134112
  s_add_u32 s59, s64, 7168
  buffer_load_dwordx4 v11, s[12:15], s59 offen nt lds
  s_add_u32 s64, s55, 8
  s_and_b32 s64, s64, 31
  s_lshl_b32 s64, s64, 13
  s_mov_b32 m0, 67584
  s_add_u32 s59, s64, 0
  buffer_load_dwordx4 v11, s[12:15], s59 offen nt lds
  s_mov_b32 m0, 68640
  s_add_u32 s59, s64, 1024
  buffer_load_dwordx4 v11, s[12:15], s59 offen nt lds
  s_mov_b32 m0, 69696
  s_add_u32 s59, s64, 2048
  buffer_load_dwordx4 v11, s[12:15], s59 offen nt lds
  s_mov_b32 m0, 70752
  s_add_u32 s59, s64, 3072
  buffer_load_dwordx4 v11, s[12:15], s59 offen nt lds
  s_mov_b32 m0, 71808
  s_add_u32 s59, s64, 4096
  buffer_load_dwordx4 v11, s[12:15], s59 offen nt lds
  s_mov_b32 m0, 72864
  s_add_u32 s59, s64, 5120
  buffer_load_dwordx4 v11, s[12:15], s59 offen nt lds
  s_mov_b32 m0, 73920
  s_add_u32 s59, s64, 6144
  buffer_load_dwordx4 v11, s[12:15], s59 offen nt lds
  s_mov_b32 m0, 74976
  s_add_u32 s59, s64, 7168
  buffer_load_dwordx4 v11, s[12:15], s59 offen nt lds
  ds_read_b32 v9, v8
  s_waitcnt vmcnt(8)
  v_mov_b32 v7, 8
  ds_write_b32 v6, v7
  s_mov_b32 s65, 16777216
  s_waitcnt lgkmcnt(0)
  s_branch L_kv3_t
L_kv3:
  ds_read_b32 v9, v8
  s_waitcnt lgkmcnt(0)
L_kv3_t:
  v_cmp_gt_u32 vcc, 20, v9
  s_nop 1
  s_cbranch_vccz L_kv3_ok
  s_sleep 1
  s_sub_u32 s65, s65, 1
  s_cmp_lg_u32 s65, 0
  s_cbranch_scc1 L_kv3
L_kv3_ok:
  s_add_u32 s64, s55, 11
  s_and_b32 s64, s64, 31
  s_lshl_b32 s64, s64, 13
  s_mov_b32 m0, 25344
  s_add_u32 s59, s64, 0
  buffer_load_dwordx4 v10, s[8:11], s59 offen nt lds
  s_mov_b32 m0, 26400
  s_add_u32 s59, s64, 1024
  buffer_load_dwordx4 v10, s[8:11], s59 offen nt lds
  s_mov_b32 m0, 27456
  s_add_u32 s59, s64, 2048
  buffer_load_dwordx4 v10, s[8:11], s59 offen nt lds
  s_mov_b32 m0, 28512
  s_add_u32 s59, s64, 3072
  buffer_load_dwordx4 v10, s[8:11], s59 offen nt lds
  s_mov_b32 m0, 29568
  s_add_u32 s59, s64, 4096
  buffer_load_dwordx4 v12, s[8:11], s59 offen nt lds
  s_mov_b32 m0, 30624
  s_add_u32 s59, s64, 5120
  buffer_load_dwordx4 v12, s[8:11], s59 offen nt lds
  s_mov_b32 m0, 31680
  s_add_u32 s59, s64, 6144
  buffer_load_dwordx4 v12, s[8:11], s59 offen nt lds
  s_mov_b32 m0, 32736
  s_add_u32 s59, s64, 7168
  buffer_load_dwordx4 v12, s[8:11], s59 offen nt lds
  s_add_u32 s64, s55, 12
  s_and_b32 s64, s64, 31
  s_lshl_b32 s64, s64, 13
  s_mov_b32 m0, 33792
  s_add_u32 s59, s64, 0
  buffer_load_dwordx4 v10, s[8:11], s59 offen nt lds
  s_mov_b32 m0, 34848
  s_add_u32 s59, s64, 1024
  buffer_load_dwordx4 v10, s[8:11], s59 offen nt lds
  s_mov_b32 m0, 35904
  s_add_u32 s59, s64, 2048
  buffer_load_dwordx4 v10, s[8:11], s59 offen nt lds
  s_mov_b32 m0, 36960
  s_add_u32 s59, s64, 3072
  buffer_load_dwordx4 v10, s[8:11], s59 offen nt lds
  s_mov_b32 m0, 38016
  s_add_u32 s59, s64, 4096
  buffer_load_dwordx4 v12, s[8:11], s59 offen nt lds
  s_mov_b32 m0, 39072
  s_add_u32 s59, s64, 5120
  buffer_load_dwordx4 v12, s[8:11], s59 offen nt lds
  s_mov_b32 m0, 40128
  s_add_u32 s59, s64, 6144
  buffer_load_dwordx4 v12, s[8:11], s59 offen nt lds
  s_mov_b32 m0, 41184
  s_add_u32 s59, s64, 7168
  buffer_load_dwordx4 v12, s[8:11], s59 offen nt lds
  s_add_u32 s64, s55, 9
  s_and_b32 s64, s64, 31
  s_lshl_b32 s64, s64, 13
  s_mov_b32 m0, 76032
  s_add_u32 s59, s64, 0
  buffer_load_dwordx4 v11, s[12:15], s59 offen nt lds
  s_mov_b32 m0, 77088
  s_add_u32 s59, s64, 1024
  buffer_load_dwordx4 v11, s[12:15], s59 offen nt lds
  s_mov_b32 m0, 78144
  s_add_u32 s59, s64, 2048
  buffer_load_dwordx4 v11, s[12:15], s59 offen nt lds
  s_mov_b32 m0, 79200
  s_add_u32 s59, s64, 3072
  buffer_load_dwordx4 v11, s[12:15], s59 offen nt lds
  s_mov_b32 m0, 80256
  s_add_u32 s59, s64, 4096
  buffer_load_dwordx4 v11, s[12:15], s59 offen nt lds
  s_mov_b32 m0, 81312
  s_add_u32 s59, s64, 5120
  buffer_load_dwordx4 v11, s[12:15], s59 offen nt lds
  s_mov_b32 m0, 82368
  s_add_u32 s59, s64, 6144
  buffer_load_dwordx4 v11, s[12:15], s59 offen nt lds
  s_mov_b32 m0, 83424
  s_add_u32 s59, s64, 7168
  buffer_load_dwordx4 v11, s[12:15], s59 offen nt lds
  s_add_u32 s64, s55, 10
  s_and_b32 s64, s64, 31
  s_lshl_b32 s64, s64, 13
  s_mov_b32 m0, 84480
  s_add_u32 s59, s64, 0
  buffer_load_dwordx4 v11, s[12:15], s59 offen nt lds
  s_mov_b32 m0, 85536
  s_add_u32 s59, s64, 1024
  buffer_load_dwordx4 v11, s[12:15], s59 offen nt lds
  s_mov_b32 m0, 86592
  s_add_u32 s59, s64, 2048
  buffer_load_dwordx4 v11, s[12:15], s59 offen nt lds
  s_mov_b32 m0, 87648
  s_add_u32 s59, s64, 3072
  buffer_load_dwordx4 v11, s[12:15], s59 offen nt lds
  s_mov_b32 m0, 88704
  s_add_u32 s59, s64, 4096
  buffer_load_dwordx4 v11, s[12:15], s59 offen nt lds
  s_mov_b32 m0, 89760
  s_add_u32 s59, s64, 5120
  buffer_load_dwordx4 v11, s[12:15], s59 offen nt lds
  s_mov_b32 m0, 90816
  s_add_u32 s59, s64, 6144
  buffer_load_dwordx4 v11, s[12:15], s59 offen nt lds
  s_mov_b32 m0, 91872
  s_add_u32 s59, s64, 7168
  buffer_load_dwordx4 v11, s[12:15], s59 offen nt lds
  ds_read_b32 v9, v8
  s_waitcnt vmcnt(8)
  v_mov_b32 v7, 10
  ds_write_b32 v6, v7
  s_mov_b32 s65, 16777216
  s_waitcnt lgkmcnt(0)
  s_branch L_kv4_t
L_kv4:
  ds_read_b32 v9, v8
  s_waitcnt lgkmcnt(0)
L_kv4_t:
  v_cmp_gt_u32 vcc, 28, v9
  s_nop 1
  s_cbranch_vccz L_kv4_ok
  s_sleep 1
  s_sub_u32 s65, s65, 1
  s_cmp_lg_u32 s65, 0
  s_cbranch_scc1 L_kv4
L_kv4_ok:
  s_add_u32 s64, s55, 13
  s_and_b32 s64, s64, 31
  s_lshl_b32 s64, s64, 13
  s_mov_b32 m0, 42240
  s_add_u32 s59, s64, 0
  buffer_load_dwordx4 v10, s[8:11], s59 offen nt lds
  s_mov_b32 m0, 43296
  s_add_u32 s59, s64, 1024
  buffer_load_dwordx4 v10, s[8:11], s59 offen nt lds
  s_mov_b32 m0, 44352
  s_add_u32 s59, s64, 2048
  buffer_load_dwordx4 v10, s[8:11], s59 offen nt lds
  s_mov_b32 m0, 45408
  s_add_u32 s59, s64, 3072
  buffer_load_dwordx4 v10, s[8:11], s59 offen nt lds
  s_mov_b32 m0, 46464
  s_add_u32 s59, s64, 4096
  buffer_load_dwordx4 v12, s[8:11], s59 offen nt lds
  s_mov_b32 m0, 47520
  s_add_u32 s59, s64, 5120
  buffer_load_dwordx4 v12, s[8:11], s59 offen nt lds
  s_mov_b32 m0, 48576
  s_add_u32 s59, s64, 6144
  buffer_load_dwordx4 v12, s[8:11], s59 offen nt lds
  s_mov_b32 m0, 49632
  s_add_u32 s59, s64, 7168
  buffer_load_dwordx4 v12, s[8:11], s59 offen nt lds
  s_add_u32 s64, s55, 14
  s_and_b32 s64, s64, 31
  s_lshl_b32 s64, s64, 13
  s_mov_b32 m0, 50688
  s_add_u32 s59, s64, 0
  buffer_load_dwordx4 v10, s[8:11], s59 offen nt lds
  s_mov_b32 m0, 51744
  s_add_u32 s59, s64, 1024
  buffer_load_dwordx4 v10, s[8:11], s59 offen nt lds
  s_mov_b32 m0, 52800
  s_add_u32 s59, s64, 2048
  buffer_load_dwordx4 v10, s[8:11], s59 offen nt lds
  s_mov_b32 m0, 53856
  s_add_u32 s59, s64, 3072
  buffer_load_dwordx4 v10, s[8:11], s59 offen nt lds
  s_mov_b32 m0, 54912
  s_add_u32 s59, s64, 4096
  buffer_load_dwordx4 v12, s[8:11], s59 offen nt lds
  s_mov_b32 m0, 55968
  s_add_u32 s59, s64, 5120
  buffer_load_dwordx4 v12, s[8:11], s59 offen nt lds
  s_mov_b32 m0, 57024
  s_add_u32 s59, s64, 6144
  buffer_load_dwordx4 v12, s[8:11], s59 offen nt lds
  s_mov_b32 m0, 58080
  s_add_u32 s59, s64, 7168
  buffer_load_dwordx4 v12, s[8:11], s59 offen nt lds
  s_add_u32 s64, s55, 11
  s_and_b32 s64, s64, 31
  s_lshl_b32 s64, s64, 13
  s_mov_b32 m0, 92928
  s_add_u32 s59, s64, 0
  buffer_load_dwordx4 v11, s[12:15], s59 offen nt lds
  s_mov_b32 m0, 93984
  s_add_u32 s59, s64, 1024
  buffer_load_dwordx4 v11, s[12:15], s59 offen nt lds
  s_mov_b32 m0, 95040
  s_add_u32 s59, s64, 2048
  buffer_load_dwordx4 v11, s[12:15], s59 offen nt lds
  s_mov_b32 m0, 96096
  s_add_u32 s59, s64, 3072
  buffer_load_dwordx4 v11, s[12:15], s59 offen nt lds
  s_mov_b32 m0, 97152
  s_add_u32 s59, s64, 4096
  buffer_load_dwordx4 v11, s[12:15], s59 offen nt lds
  s_mov_b32 m0, 98208
  s_add_u32 s59, s64, 5120
  buffer_load_dwordx4 v11, s[12:15], s59 offen nt lds
  s_mov_b32 m0, 99264
  s_add_u32 s59, s64, 6144
  buffer_load_dwordx4 v11, s[12:15], s59 offen nt lds
  s_mov_b32 m0, 100320
  s_add_u32 s59, s64, 7168
  buffer_load_dwordx4 v11, s[12:15], s59 offen nt lds
  s_add_u32 s64, s55, 12
  s_and_b32 s64, s64, 31
  s_lshl_b32 s64, s64, 13
  s_mov_b32 m0, 101376
  s_add_u32 s59, s64, 0
  buffer_load_dwordx4 v11, s[12:15], s59 offen nt lds
  s_mov_b32 m0, 102432
  s_add_u32 s59, s64, 1024
  buffer_load_dwordx4 v11, s[12:15], s59 offen nt lds
  s_mov_b32 m0, 103488
  s_add_u32 s59, s64, 2048
  buffer_load_dwordx4 v11, s[12:15], s59 offen nt lds
  s_mov_b32 m0, 104544
  s_add_u32 s59, s64, 3072
  buffer_load_dwordx4 v11, s[12:15], s59 offen nt lds
  s_mov_b32 m0, 105600
  s_add_u32 s59, s64, 4096
  buffer_load_dwordx4 v11, s[12:15], s59 offen nt lds
  s_mov_b32 m0, 106656
  s_add_u32 s59, s64, 5120
  buffer_load_dwordx4 v11, s[12:15], s59 offen nt lds
  s_mov_b32 m0, 107712
  s_add_u32 s59, s64, 6144
  buffer_load_dwordx4 v11, s[12:15], s59 offen nt lds
  s_mov_b32 m0, 108768
  s_add_u32 s59, s64, 7168
  buffer_load_dwordx4 v11, s[12:15], s59 offen nt lds
  ds_read_b32 v9, v8
  s_waitcnt vmcnt(8)
  v_mov_b32 v7, 12
  ds_write_b32 v6, v7
  s_mov_b32 s65, 16777216
  s_waitcnt lgkmcnt(0)
  s_branch L_kv5_t
L_kv5:
  ds_read_b32 v9, v8
  s_waitcnt lgkmcnt(0)
L_kv5_t:
  v_cmp_gt_u32 vcc, 36, v9
  s_nop 1
  s_cbranch_vccz L_kv5_ok
  s_sleep 1
  s_sub_u32 s65, s65, 1
  s_cmp_lg_u32 s65, 0
  s_cbranch_scc1 L_kv5
L_kv5_ok:
  s_add_u32 s64, s55, 15
  s_and_b32 s64, s64, 31
  s_lshl_b32 s64, s64, 13
  s_mov_b32 m0, 59136
  s_add_u32 s59, s64, 0
  buffer_load_dwordx4 v10, s[8:11], s59 offen nt lds
  s_mov_b32 m0, 60192
  s_add_u32 s59, s64, 1024
  buffer_load_dwordx4 v10, s[8:11], s59 offen nt lds
  s_mov_b32 m0, 61248
  s_add_u32 s59, s64, 2048
  buffer_load_dwordx4 v10, s[8:11], s59 offen nt lds
  s_mov_b32 m0, 62304
  s_add_u32 s59, s64, 3072
  buffer_load_dwordx4 v10, s[8:11], s59 offen nt lds
  s_mov_b32 m0, 63360
  s_add_u32 s59, s64, 4096
  buffer_load_dwordx4 v12, s[8:11], s59 offen nt lds
  s_mov_b32 m0, 64416
  s_add_u32 s59, s64, 5120
  buffer_load_dwordx4 v12, s[8:11], s59 offen nt lds
  s_mov_b32 m0, 65472
  s_add_u32 s59, s64, 6144
  buffer_load_dwordx4 v12, s[8:11], s59 offen nt lds
  s_mov_b32 m0, 66528
  s_add_u32 s59, s64, 7168
  buffer_load_dwordx4 v12, s[8:11], s59 offen nt lds
  s_add_u32 s64, s55, 16
  s_and_b32 s64, s64, 31
  s_lshl_b32 s64, s64, 13
  s_mov_b32 m0, 0
  s_add_u32 s59, s64, 0
  buffer_load_dwordx4 v10, s[8:11], s59 offen nt lds
  s_mov_b32 m0, 1056
  s_add_u32 s59, s64, 1024
  buffer_load_dwordx4 v10, s[8:11], s59 offen nt lds
  s_mov_b32 m0, 2112
  s_add_u32 s59, s64, 2048
  buffer_load_dwordx4 v10, s[8:11], s59 offen nt lds
  s_mov_b32 m0, 3168
  s_add_u32 s59, s64, 3072
  buffer_load_dwordx4 v10, s[8:11], s59 offen nt lds
  s_mov_b32 m0, 4224
  s_add_u32 s59, s64, 4096
  buffer_load_dwordx4 v12, s[8:11], s59 offen nt lds
  s_mov_b32 m0, 5280
  s_add_u32 s59, s64, 5120
  buffer_load_dwordx4 v12, s[8:11], s59 offen nt lds
  s_mov_b32 m0, 6336
  s_add_u32 s59, s64, 6144
  buffer_load_dwordx4 v12, s[8:11], s59 offen nt lds
  s_mov_b32 m0, 7392
  s_add_u32 s59, s64, 7168
  buffer_load_dwordx4 v12, s[8:11], s59 offen nt lds
  s_add_u32 s64, s55, 13
  s_and_b32 s64, s64, 31
  s_lshl_b32 s64, s64, 13
  s_mov_b32 m0, 109824
  s_add_u32 s59, s64, 0
  buffer_load_dwordx4 v11, s[12:15], s59 offen nt lds
  s_mov_b32 m0, 110880
  s_add_u32 s59, s64, 1024
  buffer_load_dwordx4 v11, s[12:15], s59 offen nt lds
  s_mov_b32 m0, 111936
  s_add_u32 s59, s64, 2048
  buffer_load_dwordx4 v11, s[12:15], s59 offen nt lds
  s_mov_b32 m0, 112992
  s_add_u32 s59, s64, 3072
  buffer_load_dwordx4 v11, s[12:15], s59 offen nt lds
  s_mov_b32 m0, 114048
  s_add_u32 s59, s64, 4096
  buffer_load_dwordx4 v11, s[12:15], s59 offen nt lds
  s_mov_b32 m0, 115104
  s_add_u32 s59, s64, 5120
  buffer_load_dwordx4 v11, s[12:15], s59 offen nt lds
  s_mov_b32 m0, 116160
  s_add_u32 s59, s64, 6144
  buffer_load_dwordx4 v11, s[12:15], s59 offen nt lds
  s_mov_b32 m0, 117216
  s_add_u32 s59, s64, 7168
  buffer_load_dwordx4 v11, s[12:15], s59 offen nt lds
  s_add_u32 s64, s55, 14
  s_and_b32 s64, s64, 31
  s_lshl_b32 s64, s64, 13
  s_mov_b32 m0, 118272
  s_add_u32 s59, s64, 0
  buffer_load_dwordx4 v11, s[12:15], s59 offen nt lds
  s_mov_b32 m0, 119328
  s_add_u32 s59, s64, 1024
  buffer_load_dwordx4 v11, s[12:15], s59 offen nt lds
  s_mov_b32 m0, 120384
  s_add_u32 s59, s64, 2048
  buffer_load_dwordx4 v11, s[12:15], s59 offen nt lds
  s_mov_b32 m0, 121440
  s_add_u32 s59, s64, 3072
  buffer_load_dwordx4 v11, s[12:15], s59 offen nt lds
  s_mov_b32 m0, 122496
  s_add_u32 s59, s64, 4096
  buffer_load_dwordx4 v11, s[12:15], s59 offen nt lds
  s_mov_b32 m0, 123552
  s_add_u32 s59, s64, 5120
  buffer_load_dwordx4 v11, s[12:15], s59 offen nt lds
  s_mov_b32 m0, 124608
  s_add_u32 s59, s64, 6144
  buffer_load_dwordx4 v11, s[12:15], s59 offen nt lds
  s_mov_b32 m0, 125664
  s_add_u32 s59, s64, 7168
  buffer_load_dwordx4 v11, s[12:15], s59 offen nt lds
  ds_read_b32 v9, v8
  s_waitcnt vmcnt(8)
  v_mov_b32 v7, 14
  ds_write_b32 v6, v7
  s_mov_b32 s65, 16777216
  s_waitcnt lgkmcnt(0)
  s_branch L_kv6_t
L_kv6:
  ds_read_b32 v9, v8
  s_waitcnt lgkmcnt(0)
L_kv6_t:
  v_cmp_gt_u32 vcc, 44, v9
  s_nop 1
  s_cbranch_vccz L_kv6_ok
  s_sleep 1
  s_sub_u32 s65, s65, 1
  s_cmp_lg_u32 s65, 0
  s_cbranch_scc1 L_kv6
L_kv6_ok:
  s_add_u32 s64, s55, 17
  s_and_b32 s64, s64, 31
  s_lshl_b32 s64, s64, 13
  s_mov_b32 m0, 8448
  s_add_u32 s59, s64, 0
  buffer_load_dwordx4 v10, s[8:11], s59 offen nt lds
  s_mov_b32 m0, 9504
  s_add_u32 s59, s64, 1024
  buffer_load_dwordx4 v10, s[8:11], s59 offen nt lds
  s_mov_b32 m0, 10560
  s_add_u32 s59, s64, 2048
  buffer_load_dwordx4 v10, s[8:11], s59 offen nt lds
  s_mov_b32 m0, 11616
  s_add_u32 s59, s64, 3072
  buffer_load_dwordx4 v10, s[8:11], s59 offen nt lds
  s_mov_b32 m0, 12672
  s_add_u32 s59, s64, 4096
  buffer_load_dwordx4 v12, s[8:11], s59 offen nt lds
  s_mov_b32 m0, 13728
  s_add_u32 s59, s64, 5120
  buffer_load_dwordx4 v12, s[8:11], s59 offen nt lds
  s_mov_b32 m0, 14784
  s_add_u32 s59, s64, 6144
  buffer_load_dwordx4 v12, s[8:11], s59 offen nt lds
  s_mov_b32 m0, 15840
  s_add_u32 s59, s64, 7168
  buffer_load_dwordx4 v12, s[8:11], s59 offen nt lds
  s_add_u32 s64, s55, 18
  s_and_b32 s64, s64, 31
  s_lshl_b32 s64, s64, 13
  s_mov_b32 m0, 16896
  s_add_u32 s59, s64, 0
  buffer_load_dwordx4 v10, s[8:11], s59 offen nt lds
  s_mov_b32 m0, 17952
  s_add_u32 s59, s64, 1024
  buffer_load_dwordx4 v10, s[8:11], s59 offen nt lds
  s_mov_b32 m0, 19008
  s_add_u32 s59, s64, 2048
  buffer_load_dwordx4 v10, s[8:11], s59 offen nt lds
  s_mov_b32 m0, 20064
  s_add_u32 s59, s64, 3072
  buffer_load_dwordx4 v10, s[8:11], s59 offen nt lds
  s_mov_b32 m0, 21120
  s_add_u32 s59, s64, 4096
  buffer_load_dwordx4 v12, s[8:11], s59 offen nt lds
  s_mov_b32 m0, 22176
  s_add_u32 s59, s64, 5120
  buffer_load_dwordx4 v12, s[8:11], s59 offen nt lds
  s_mov_b32 m0, 23232
  s_add_u32 s59, s64, 6144
  buffer_load_dwordx4 v12, s[8:11], s59 offen nt lds
  s_mov_b32 m0, 24288
  s_add_u32 s59, s64, 7168
  buffer_load_dwordx4 v12, s[8:11], s59 offen nt lds
  s_add_u32 s64, s55, 15
  s_and_b32 s64, s64, 31
  s_lshl_b32 s64, s64, 13
  s_mov_b32 m0, 126720
  s_add_u32 s59, s64, 0
  buffer_load_dwordx4 v11, s[12:15], s59 offen nt lds
  s_mov_b32 m0, 127776
  s_add_u32 s59, s64, 1024
  buffer_load_dwordx4 v11, s[12:15], s59 offen nt lds
  s_mov_b32 m0, 128832
  s_add_u32 s59, s64, 2048
  buffer_load_dwordx4 v11, s[12:15], s59 offen nt lds
  s_mov_b32 m0, 129888
  s_add_u32 s59, s64, 3072
  buffer_load_dwordx4 v11, s[12:15], s59 offen nt lds
  s_mov_b32 m0, 130944
  s_add_u32 s59, s64, 4096
  buffer_load_dwordx4 v11, s[12:15], s59 offen nt lds
  s_mov_b32 m0, 132000
  s_add_u32 s59, s64, 5120
  buffer_load_dwordx4 v11, s[12:15], s59 offen nt lds
  s_mov_b32 m0, 133056
  s_add_u32 s59, s64, 6144
  buffer_load_dwordx4 v11, s[12:15], s59 offen nt lds
  s_mov_b32 m0, 134112
  s_add_u32 s59, s64, 7168
  buffer_load_dwordx4 v11, s[12:15], s59 offen nt lds
  s_add_u32 s64, s55, 16
  s_and_b32 s64, s64, 31
  s_lshl_b32 s64, s64, 13
  s_mov_b32 m0, 67584
  s_add_u32 s59, s64, 0
  buffer_load_dwordx4 v11, s[12:15], s59 offen nt lds
  s_mov_b32 m0, 68640
  s_add_u32 s59, s64, 1024
  buffer_load_dwordx4 v11, s[12:15], s59 offen nt lds
  s_mov_b32 m0, 69696
  s_add_u32 s59, s64, 2048
  buffer_load_dwordx4 v11, s[12:15], s59 offen nt lds
  s_mov_b32 m0, 70752
  s_add_u32 s59, s64, 3072
  buffer_load_dwordx4 v11, s[12:15], s59 offen nt lds
  s_mov_b32 m0, 71808
  s_add_u32 s59, s64, 4096
  buffer_load_dwordx4 v11, s[12:15], s59 offen nt lds
  s_mov_b32 m0, 72864
  s_add_u32 s59, s64, 5120
  buffer_load_dwordx4 v11, s[12:15], s59 offen nt lds
  s_mov_b32 m0, 73920
  s_add_u32 s59, s64, 6144
  buffer_load_dwordx4 v11, s[12:15], s59 offen nt lds
  s_mov_b32 m0, 74976
  s_add_u32 s59, s64, 7168
  buffer_load_dwordx4 v11, s[12:15], s59 offen nt lds
  ds_read_b32 v9, v8
  s_waitcnt vmcnt(8)
  v_mov_b32 v7, 16
  ds_write_b32 v6, v7
  s_mov_b32 s65, 16777216
  s_waitcnt lgkmcnt(0)
  s_branch L_kv7_t
L_kv7:
  ds_read_b32 v9, v8
  s_waitcnt lgkmcnt(0)
L_kv7_t:
  v_cmp_gt_u32 vcc, 52, v9
  s_nop 1
  s_cbranch_vccz L_kv7_ok
  s_sleep 1
  s_sub_u32 s65, s65, 1
  s_cmp_lg_u32 s65, 0
  s_cbranch_scc1 L_kv7
L_kv7_ok:
  s_add_u32 s64, s55, 19
  s_and_b32 s64, s64, 31
  s_lshl_b32 s64, s64, 13
  s_mov_b32 m0, 25344
  s_add_u32 s59, s64, 0
  buffer_load_dwordx4 v10, s[8:11], s59 offen nt lds
  s_mov_b32 m0, 26400
  s_add_u32 s59, s64, 1024
  buffer_load_dwordx4 v10, s[8:11], s59 offen nt lds
  s_mov_b32 m0, 27456
  s_add_u32 s59, s64, 2048
  buffer_load_dwordx4 v10, s[8:11], s59 offen nt lds
  s_mov_b32 m0, 28512
  s_add_u32 s59, s64, 3072
  buffer_load_dwordx4 v10, s[8:11], s59 offen nt lds
  s_mov_b32 m0, 29568
  s_add_u32 s59, s64, 4096
  buffer_load_dwordx4 v12, s[8:11], s59 offen nt lds
  s_mov_b32 m0, 30624
  s_add_u32 s59, s64, 5120
  buffer_load_dwordx4 v12, s[8:11], s59 offen nt lds
  s_mov_b32 m0, 31680
  s_add_u32 s59, s64, 6144
  buffer_load_dwordx4 v12, s[8:11], s59 offen nt lds
  s_mov_b32 m0, 32736
  s_add_u32 s59, s64, 7168
  buffer_load_dwordx4 v12, s[8:11], s59 offen nt lds
  s_add_u32 s64, s55, 20
  s_and_b32 s64, s64, 31
  s_lshl_b32 s64, s64, 13
  s_mov_b32 m0, 33792
  s_add_u32 s59, s64, 0
  buffer_load_dwordx4 v10, s[8:11], s59 offen nt lds
  s_mov_b32 m0, 34848
  s_add_u32 s59, s64, 1024
  buffer_load_dwordx4 v10, s[8:11], s59 offen nt lds
  s_mov_b32 m0, 35904
  s_add_u32 s59, s64, 2048
  buffer_load_dwordx4 v10, s[8:11], s59 offen nt lds
  s_mov_b32 m0, 36960
  s_add_u32 s59, s64, 3072
  buffer_load_dwordx4 v10, s[8:11], s59 offen nt lds
  s_mov_b32 m0, 38016
  s_add_u32 s59, s64, 4096
  buffer_load_dwordx4 v12, s[8:11], s59 offen nt lds
  s_mov_b32 m0, 39072
  s_add_u32 s59, s64, 5120
  buffer_load_dwordx4 v12, s[8:11], s59 offen nt lds
  s_mov_b32 m0, 40128
  s_add_u32 s59, s64, 6144
  buffer_load_dwordx4 v12, s[8:11], s59 offen nt lds
  s_mov_b32 m0, 41184
  s_add_u32 s59, s64, 7168
  buffer_load_dwordx4 v12, s[8:11], s59 offen nt lds
  s_add_u32 s64, s55, 17
  s_and_b32 s64, s64, 31
  s_lshl_b32 s64, s64, 13
  s_mov_b32 m0, 76032
  s_add_u32 s59, s64, 0
  buffer_load_dwordx4 v11, s[12:15], s59 offen nt lds
  s_mov_b32 m0, 77088
  s_add_u32 s59, s64, 1024
  buffer_load_dwordx4 v11, s[12:15], s59 offen nt lds
  s_mov_b32 m0, 78144
  s_add_u32 s59, s64, 2048
  buffer_load_dwordx4 v11, s[12:15], s59 offen nt lds
  s_mov_b32 m0, 79200
  s_add_u32 s59, s64, 3072
  buffer_load_dwordx4 v11, s[12:15], s59 offen nt lds
  s_mov_b32 m0, 80256
  s_add_u32 s59, s64, 4096
  buffer_load_dwordx4 v11, s[12:15], s59 offen nt lds
  s_mov_b32 m0, 81312
  s_add_u32 s59, s64, 5120
  buffer_load_dwordx4 v11, s[12:15], s59 offen nt lds
  s_mov_b32 m0, 82368
  s_add_u32 s59, s64, 6144
  buffer_load_dwordx4 v11, s[12:15], s59 offen nt lds
  s_mov_b32 m0, 83424
  s_add_u32 s59, s64, 7168
  buffer_load_dwordx4 v11, s[12:15], s59 offen nt lds
  s_add_u32 s64, s55, 18
  s_and_b32 s64, s64, 31
  s_lshl_b32 s64, s64, 13
  s_mov_b32 m0, 84480
  s_add_u32 s59, s64, 0
  buffer_load_dwordx4 v11, s[12:15], s59 offen nt lds
  s_mov_b32 m0, 85536
  s_add_u32 s59, s64, 1024
  buffer_load_dwordx4 v11, s[12:15], s59 offen nt lds
  s_mov_b32 m0, 86592
  s_add_u32 s59, s64, 2048
  buffer_load_dwordx4 v11, s[12:15], s59 offen nt lds
  s_mov_b32 m0, 87648
  s_add_u32 s59, s64, 3072
  buffer_load_dwordx4 v11, s[12:15], s59 offen nt lds
  s_mov_b32 m0, 88704
  s_add_u32 s59, s64, 4096
  buffer_load_dwordx4 v11, s[12:15], s59 offen nt lds
  s_mov_b32 m0, 89760
  s_add_u32 s59, s64, 5120
  buffer_load_dwordx4 v11, s[12:15], s59 offen nt lds
  s_mov_b32 m0, 90816
  s_add_u32 s59, s64, 6144
  buffer_load_dwordx4 v11, s[12:15], s59 offen nt lds
  s_mov_b32 m0, 91872
  s_add_u32 s59, s64, 7168
  buffer_load_dwordx4 v11, s[12:15], s59 offen nt lds
  ds_read_b32 v9, v8
  s_waitcnt vmcnt(8)
  v_mov_b32 v7, 18
  ds_write_b32 v6, v7
  s_mov_b32 s65, 16777216
  s_waitcnt lgkmcnt(0)
  s_branch L_kv8_t
L_kv8:
  ds_read_b32 v9, v8
  s_waitcnt lgkmcnt(0)
L_kv8_t:
  v_cmp_gt_u32 vcc, 60, v9
  s_nop 1
  s_cbranch_vccz L_kv8_ok
  s_sleep 1
  s_sub_u32 s65, s65, 1
  s_cmp_lg_u32 s65, 0
  s_cbranch_scc1 L_kv8
L_kv8_ok:
  s_add_u32 s64, s55, 21
  s_and_b32 s64, s64, 31
  s_lshl_b32 s64, s64, 13
  s_mov_b32 m0, 42240
  s_add_u32 s59, s64, 0
  buffer_load_dwordx4 v10, s[8:11], s59 offen nt lds
  s_mov_b32 m0, 43296
  s_add_u32 s59, s64, 1024
  buffer_load_dwordx4 v10, s[8:11], s59 offen nt lds
  s_mov_b32 m0, 44352
  s_add_u32 s59, s64, 2048
  buffer_load_dwordx4 v10, s[8:11], s59 offen nt lds
  s_mov_b32 m0, 45408
  s_add_u32 s59, s64, 3072
  buffer_load_dwordx4 v10, s[8:11], s59 offen nt lds
  s_mov_b32 m0, 46464
  s_add_u32 s59, s64, 4096
  buffer_load_dwordx4 v12, s[8:11], s59 offen nt lds
  s_mov_b32 m0, 47520
  s_add_u32 s59, s64, 5120
  buffer_load_dwordx4 v12, s[8:11], s59 offen nt lds
  s_mov_b32 m0, 48576
  s_add_u32 s59, s64, 6144
  buffer_load_dwordx4 v12, s[8:11], s59 offen nt lds
  s_mov_b32 m0, 49632
  s_add_u32 s59, s64, 7168
  buffer_load_dwordx4 v12, s[8:11], s59 offen nt lds
  s_add_u32 s64, s55, 22
  s_and_b32 s64, s64, 31
  s_lshl_b32 s64, s64, 13
  s_mov_b32 m0, 50688
  s_add_u32 s59, s64, 0
  buffer_load_dwordx4 v10, s[8:11], s59 offen nt lds
  s_mov_b32 m0, 51744
  s_add_u32 s59, s64, 1024
  buffer_load_dwordx4 v10, s[8:11], s59 offen nt lds
  s_mov_b32 m0, 52800
  s_add_u32 s59, s64, 2048
  buffer_load_dwordx4 v10, s[8:11], s59 offen nt lds
  s_mov_b32 m0, 53856
  s_add_u32 s59, s64, 3072
  buffer_load_dwordx4 v10, s[8:11], s59 offen nt lds
  s_mov_b32 m0, 54912
  s_add_u32 s59, s64, 4096
  buffer_load_dwordx4 v12, s[8:11], s59 offen nt lds
  s_mov_b32 m0, 55968
  s_add_u32 s59, s64, 5120
  buffer_load_dwordx4 v12, s[8:11], s59 offen nt lds
  s_mov_b32 m0, 57024
  s_add_u32 s59, s64, 6144
  buffer_load_dwordx4 v12, s[8:11], s59 offen nt lds
  s_mov_b32 m0, 58080
  s_add_u32 s59, s64, 7168
  buffer_load_dwordx4 v12, s[8:11], s59 offen nt lds
  s_add_u32 s64, s55, 19
  s_and_b32 s64, s64, 31
  s_lshl_b32 s64, s64, 13
  s_mov_b32 m0, 92928
  s_add_u32 s59, s64, 0
  buffer_load_dwordx4 v11, s[12:15], s59 offen nt lds
  s_mov_b32 m0, 93984
  s_add_u32 s59, s64, 1024
  buffer_load_dwordx4 v11, s[12:15], s59 offen nt lds
  s_mov_b32 m0, 95040
  s_add_u32 s59, s64, 2048
  buffer_load_dwordx4 v11, s[12:15], s59 offen nt lds
  s_mov_b32 m0, 96096
  s_add_u32 s59, s64, 3072
  buffer_load_dwordx4 v11, s[12:15], s59 offen nt lds
  s_mov_b32 m0, 97152
  s_add_u32 s59, s64, 4096
  buffer_load_dwordx4 v11, s[12:15], s59 offen nt lds
  s_mov_b32 m0, 98208
  s_add_u32 s59, s64, 5120
  buffer_load_dwordx4 v11, s[12:15], s59 offen nt lds
  s_mov_b32 m0, 99264
  s_add_u32 s59, s64, 6144
  buffer_load_dwordx4 v11, s[12:15], s59 offen nt lds
  s_mov_b32 m0, 100320
  s_add_u32 s59, s64, 7168
  buffer_load_dwordx4 v11, s[12:15], s59 offen nt lds
  s_add_u32 s64, s55, 20
  s_and_b32 s64, s64, 31
  s_lshl_b32 s64, s64, 13
  s_mov_b32 m0, 101376
  s_add_u32 s59, s64, 0
  buffer_load_dwordx4 v11, s[12:15], s59 offen nt lds
  s_mov_b32 m0, 102432
  s_add_u32 s59, s64, 1024
  buffer_load_dwordx4 v11, s[12:15], s59 offen nt lds
  s_mov_b32 m0, 103488
  s_add_u32 s59, s64, 2048
  buffer_load_dwordx4 v11, s[12:15], s59 offen nt lds
  s_mov_b32 m0, 104544
  s_add_u32 s59, s64, 3072
  buffer_load_dwordx4 v11, s[12:15], s59 offen nt lds
  s_mov_b32 m0, 105600
  s_add_u32 s59, s64, 4096
  buffer_load_dwordx4 v11, s[12:15], s59 offen nt lds
  s_mov_b32 m0, 106656
  s_add_u32 s59, s64, 5120
  buffer_load_dwordx4 v11, s[12:15], s59 offen nt lds
  s_mov_b32 m0, 107712
  s_add_u32 s59, s64, 6144
  buffer_load_dwordx4 v11, s[12:15], s59 offen nt lds
  s_mov_b32 m0, 108768
  s_add_u32 s59, s64, 7168
  buffer_load_dwordx4 v11, s[12:15], s59 offen nt lds
  ds_read_b32 v9, v8
  s_waitcnt vmcnt(8)
  v_mov_b32 v7, 20
  ds_write_b32 v6, v7
  s_mov_b32 s65, 16777216
  s_waitcnt lgkmcnt(0)
  s_branch L_kv9_t
L_kv9:
  ds_read_b32 v9, v8
  s_waitcnt lgkmcnt(0)
L_kv9_t:
  v_cmp_gt_u32 vcc, 68, v9
  s_nop 1
  s_cbranch_vccz L_kv9_ok
  s_sleep 1
  s_sub_u32 s65, s65, 1
  s_cmp_lg_u32 s65, 0
  s_cbranch_scc1 L_kv9
L_kv9_ok:
  s_add_u32 s64, s55, 23
  s_and_b32 s64, s64, 31
  s_lshl_b32 s64, s64, 13
  s_mov_b32 m0, 59136
  s_add_u32 s59, s64, 0
  buffer_load_dwordx4 v10, s[8:11], s59 offen nt lds
  s_mov_b32 m0, 60192
  s_add_u32 s59, s64, 1024
  buffer_load_dwordx4 v10, s[8:11], s59 offen nt lds
  s_mov_b32 m0, 61248
  s_add_u32 s59, s64, 2048
  buffer_load_dwordx4 v10, s[8:11], s59 offen nt lds
  s_mov_b32 m0, 62304
  s_add_u32 s59, s64, 3072
  buffer_load_dwordx4 v10, s[8:11], s59 offen nt lds
  s_mov_b32 m0, 63360
  s_add_u32 s59, s64, 4096
  buffer_load_dwordx4 v12, s[8:11], s59 offen nt lds
  s_mov_b32 m0, 64416
  s_add_u32 s59, s64, 5120
  buffer_load_dwordx4 v12, s[8:11], s59 offen nt lds
  s_mov_b32 m0, 65472
  s_add_u32 s59, s64, 6144
  buffer_load_dwordx4 v12, s[8:11], s59 offen nt lds
  s_mov_b32 m0, 66528
  s_add_u32 s59, s64, 7168
  buffer_load_dwordx4 v12, s[8:11], s59 offen nt lds
  s_add_u32 s64, s55, 24
  s_and_b32 s64, s64, 31
  s_lshl_b32 s64, s64, 13
  s_mov_b32 m0, 0
  s_add_u32 s59, s64, 0
  buffer_load_dwordx4 v10, s[8:11], s59 offen nt lds
  s_mov_b32 m0, 1056
  s_add_u32 s59, s64, 1024
  buffer_load_dwordx4 v10, s[8:11], s59 offen nt lds
  s_mov_b32 m0, 2112
  s_add_u32 s59, s64, 2048
  buffer_load_dwordx4 v10, s[8:11], s59 offen nt lds
  s_mov_b32 m0, 3168
  s_add_u32 s59, s64, 3072
  buffer_load_dwordx4 v10, s[8:11], s59 offen nt lds
  s_mov_b32 m0, 4224
  s_add_u32 s59, s64, 4096
  buffer_load_dwordx4 v12, s[8:11], s59 offen nt lds
  s_mov_b32 m0, 5280
  s_add_u32 s59, s64, 5120
  buffer_load_dwordx4 v12, s[8:11], s59 offen nt lds
  s_mov_b32 m0, 6336
  s_add_u32 s59, s64, 6144
  buffer_load_dwordx4 v12, s[8:11], s59 offen nt lds
  s_mov_b32 m0, 7392
  s_add_u32 s59, s64, 7168
  buffer_load_dwordx4 v12, s[8:11], s59 offen nt lds
  s_add_u32 s64, s55, 21
  s_and_b32 s64, s64, 31
  s_lshl_b32 s64, s64, 13
  s_mov_b32 m0, 109824
  s_add_u32 s59, s64, 0
  buffer_load_dwordx4 v11, s[12:15], s59 offen nt lds
  s_mov_b32 m0, 110880
  s_add_u32 s59, s64, 1024
  buffer_load_dwordx4 v11, s[12:15], s59 offen nt lds
  s_mov_b32 m0, 111936
  s_add_u32 s59, s64, 2048
  buffer_load_dwordx4 v11, s[12:15], s59 offen nt lds
  s_mov_b32 m0, 112992
  s_add_u32 s59, s64, 3072
  buffer_load_dwordx4 v11, s[12:15], s59 offen nt lds
  s_mov_b32 m0, 114048
  s_add_u32 s59, s64, 4096
  buffer_load_dwordx4 v11, s[12:15], s59 offen nt lds
  s_mov_b32 m0, 115104
  s_add_u32 s59, s64, 5120
  buffer_load_dwordx4 v11, s[12:15], s59 offen nt lds
  s_mov_b32 m0, 116160
  s_add_u32 s59, s64, 6144
  buffer_load_dwordx4 v11, s[12:15], s59 offen nt lds
  s_mov_b32 m0, 117216
  s_add_u32 s59, s64, 7168
  buffer_load_dwordx4 v11, s[12:15], s59 offen nt lds
  s_add_u32 s64, s55, 22
  s_and_b32 s64, s64, 31
  s_lshl_b32 s64, s64, 13
  s_mov_b32 m0, 118272
  s_add_u32 s59, s64, 0
  buffer_load_dwordx4 v11, s[12:15], s59 offen nt lds
  s_mov_b32 m0, 119328
  s_add_u32 s59, s64, 1024
  buffer_load_dwordx4 v11, s[12:15], s59 offen nt lds
  s_mov_b32 m0, 120384
  s_add_u32 s59, s64, 2048
  buffer_load_dwordx4 v11, s[12:15], s59 offen nt lds
  s_mov_b32 m0, 121440
  s_add_u32 s59, s64, 3072
  buffer_load_dwordx4 v11, s[12:15], s59 offen nt lds
  s_mov_b32 m0, 122496
  s_add_u32 s59, s64, 4096
  buffer_load_dwordx4 v11, s[12:15], s59 offen nt lds
  s_mov_b32 m0, 123552
  s_add_u32 s59, s64, 5120
  buffer_load_dwordx4 v11, s[12:15], s59 offen nt lds
  s_mov_b32 m0, 124608
  s_add_u32 s59, s64, 6144
  buffer_load_dwordx4 v11, s[12:15], s59 offen nt lds
  s_mov_b32 m0, 125664
  s_add_u32 s59, s64, 7168
  buffer_load_dwordx4 v11, s[12:15], s59 offen nt lds
  ds_read_b32 v9, v8
  s_waitcnt vmcnt(8)
  v_mov_b32 v7, 22
  ds_write_b32 v6, v7
  s_mov_b32 s65, 16777216
  s_waitcnt lgkmcnt(0)
  s_branch L_kv10_t
L_kv10:
  ds_read_b32 v9, v8
  s_waitcnt lgkmcnt(0)
L_kv10_t:
  v_cmp_gt_u32 vcc, 76, v9
  s_nop 1
  s_cbranch_vccz L_kv10_ok
  s_sleep 1
  s_sub_u32 s65, s65, 1
  s_cmp_lg_u32 s65, 0
  s_cbranch_scc1 L_kv10
L_kv10_ok:
  s_add_u32 s64, s55, 25
  s_and_b32 s64, s64, 31
  s_lshl_b32 s64, s64, 13
  s_mov_b32 m0, 8448
  s_add_u32 s59, s64, 0
  buffer_load_dwordx4 v10, s[8:11], s59 offen nt lds
  s_mov_b32 m0, 9504
  s_add_u32 s59, s64, 1024
  buffer_load_dwordx4 v10, s[8:11], s59 offen nt lds
  s_mov_b32 m0, 10560
  s_add_u32 s59, s64, 2048
  buffer_load_dwordx4 v10, s[8:11], s59 offen nt lds
  s_mov_b32 m0, 11616
  s_add_u32 s59, s64, 3072
  buffer_load_dwordx4 v10, s[8:11], s59 offen nt lds
  s_mov_b32 m0, 12672
  s_add_u32 s59, s64, 4096
  buffer_load_dwordx4 v12, s[8:11], s59 offen nt lds
  s_mov_b32 m0, 13728
  s_add_u32 s59, s64, 5120
  buffer_load_dwordx4 v12, s[8:11], s59 offen nt lds
  s_mov_b32 m0, 14784
  s_add_u32 s59, s64, 6144
  buffer_load_dwordx4 v12, s[8:11], s59 offen nt lds
  s_mov_b32 m0, 15840
  s_add_u32 s59, s64, 7168
  buffer_load_dwordx4 v12, s[8:11], s59 offen nt lds
  s_add_u32 s64, s55, 26
  s_and_b32 s64, s64, 31
  s_lshl_b32 s64, s64, 13
  s_mov_b32 m0, 16896
  s_add_u32 s59, s64, 0
  buffer_load_dwordx4 v10, s[8:11], s59 offen nt lds
  s_mov_b32 m0, 17952
  s_add_u32 s59, s64, 1024
  buffer_load_dwordx4 v10, s[8:11], s59 offen nt lds
  s_mov_b32 m0, 19008
  s_add_u32 s59, s64, 2048
  buffer_load_dwordx4 v10, s[8:11], s59 offen nt lds
  s_mov_b32 m0, 20064
  s_add_u32 s59, s64, 3072
  buffer_load_dwordx4 v10, s[8:11], s59 offen nt lds
  s_mov_b32 m0, 21120
  s_add_u32 s59, s64, 4096
  buffer_load_dwordx4 v12, s[8:11], s59 offen nt lds
  s_mov_b32 m0, 22176
  s_add_u32 s59, s64, 5120
  buffer_load_dwordx4 v12, s[8:11], s59 offen nt lds
  s_mov_b32 m0, 23232
  s_add_u32 s59, s64, 6144
  buffer_load_dwordx4 v12, s[8:11], s59 offen nt lds
  s_mov_b32 m0, 24288
  s_add_u32 s59, s64, 7168
  buffer_load_dwordx4 v12, s[8:11], s59 offen nt lds
  s_add_u32 s64, s55, 23
  s_and_b32 s64, s64, 31
  s_lshl_b32 s64, s64, 13
  s_mov_b32 m0, 126720
  s_add_u32 s59, s64, 0
  buffer_load_dwordx4 v11, s[12:15], s59 offen nt lds
  s_mov_b32 m0, 127776
  s_add_u32 s59, s64, 1024
  buffer_load_dwordx4 v11, s[12:15], s59 offen nt lds
  s_mov_b32 m0, 128832
  s_add_u32 s59, s64, 2048
  buffer_load_dwordx4 v11, s[12:15], s59 offen nt lds
  s_mov_b32 m0, 129888
  s_add_u32 s59, s64, 3072
  buffer_load_dwordx4 v11, s[12:15], s59 offen nt lds
  s_mov_b32 m0, 130944
  s_add_u32 s59, s64, 4096
  buffer_load_dwordx4 v11, s[12:15], s59 offen nt lds
  s_mov_b32 m0, 132000
  s_add_u32 s59, s64, 5120
  buffer_load_dwordx4 v11, s[12:15], s59 offen nt lds
  s_mov_b32 m0, 133056
  s_add_u32 s59, s64, 6144
  buffer_load_dwordx4 v11, s[12:15], s59 offen nt lds
  s_mov_b32 m0, 134112
  s_add_u32 s59, s64, 7168
  buffer_load_dwordx4 v11, s[12:15], s59 offen nt lds
  s_add_u32 s64, s55, 24
  s_and_b32 s64, s64, 31
  s_lshl_b32 s64, s64, 13
  s_mov_b32 m0, 67584
  s_add_u32 s59, s64, 0
  buffer_load_dwordx4 v11, s[12:15], s59 offen nt lds
  s_mov_b32 m0, 68640
  s_add_u32 s59, s64, 1024
  buffer_load_dwordx4 v11, s[12:15], s59 offen nt lds
  s_mov_b32 m0, 69696
  s_add_u32 s59, s64, 2048
  buffer_load_dwordx4 v11, s[12:15], s59 offen nt lds
  s_mov_b32 m0, 70752
  s_add_u32 s59, s64, 3072
  buffer_load_dwordx4 v11, s[12:15], s59 offen nt lds
  s_mov_b32 m0, 71808
  s_add_u32 s59, s64, 4096
  buffer_load_dwordx4 v11, s[12:15], s59 offen nt lds
  s_mov_b32 m0, 72864
  s_add_u32 s59, s64, 5120
  buffer_load_dwordx4 v11, s[12:15], s59 offen nt lds
  s_mov_b32 m0, 73920
  s_add_u32 s59, s64, 6144
  buffer_load_dwordx4 v11, s[12:15], s59 offen nt lds
  s_mov_b32 m0, 74976
  s_add_u32 s59, s64, 7168
  buffer_load_dwordx4 v11, s[12:15], s59 offen nt lds
  ds_read_b32 v9, v8
  s_waitcnt vmcnt(8)
  v_mov_b32 v7, 24
  ds_write_b32 v6, v7
  s_mov_b32 s65, 16777216
  s_waitcnt lgkmcnt(0)
  s_branch L_kv11_t
L_kv11:
  ds_read_b32 v9, v8
  s_waitcnt lgkmcnt(0)
L_kv11_t:
  v_cmp_gt_u32 vcc, 84, v9
  s_nop 1
  s_cbranch_vccz L_kv11_ok
  s_sleep 1
  s_sub_u32 s65, s65, 1
  s_cmp_lg_u32 s65, 0
  s_cbranch_scc1 L_kv11
L_kv11_ok:
  s_add_u32 s64, s55, 27
  s_and_b32 s64, s64, 31
  s_lshl_b32 s64, s64, 13
  s_mov_b32 m0, 25344
  s_add_u32 s59, s64, 0
  buffer_load_dwordx4 v10, s[8:11], s59 offen nt lds
  s_mov_b32 m0, 26400
  s_add_u32 s59, s64, 1024
  buffer_load_dwordx4 v10, s[8:11], s59 offen nt lds
  s_mov_b32 m0, 27456
  s_add_u32 s59, s64, 2048
  buffer_load_dwordx4 v10, s[8:11], s59 offen nt lds
  s_mov_b32 m0, 28512
  s_add_u32 s59, s64, 3072
  buffer_load_dwordx4 v10, s[8:11], s59 offen nt lds
  s_mov_b32 m0, 29568
  s_add_u32 s59, s64, 4096
  buffer_load_dwordx4 v12, s[8:11], s59 offen nt lds
  s_mov_b32 m0, 30624
  s_add_u32 s59, s64, 5120
  buffer_load_dwordx4 v12, s[8:11], s59 offen nt lds
  s_mov_b32 m0, 31680
  s_add_u32 s59, s64, 6144
  buffer_load_dwordx4 v12, s[8:11], s59 offen nt lds
  s_mov_b32 m0, 32736
  s_add_u32 s59, s64, 7168
  buffer_load_dwordx4 v12, s[8:11], s59 offen nt lds
  s_add_u32 s64, s55, 28
  s_and_b32 s64, s64, 31
  s_lshl_b32 s64, s64, 13
  s_mov_b32 m0, 33792
  s_add_u32 s59, s64, 0
  buffer_load_dwordx4 v10, s[8:11], s59 offen nt lds
  s_mov_b32 m0, 34848
  s_add_u32 s59, s64, 1024
  buffer_load_dwordx4 v10, s[8:11], s59 offen nt lds
  s_mov_b32 m0, 35904
  s_add_u32 s59, s64, 2048
  buffer_load_dwordx4 v10, s[8:11], s59 offen nt lds
  s_mov_b32 m0, 36960
  s_add_u32 s59, s64, 3072
  buffer_load_dwordx4 v10, s[8:11], s59 offen nt lds
  s_mov_b32 m0, 38016
  s_add_u32 s59, s64, 4096
  buffer_load_dwordx4 v12, s[8:11], s59 offen nt lds
  s_mov_b32 m0, 39072
  s_add_u32 s59, s64, 5120
  buffer_load_dwordx4 v12, s[8:11], s59 offen nt lds
  s_mov_b32 m0, 40128
  s_add_u32 s59, s64, 6144
  buffer_load_dwordx4 v12, s[8:11], s59 offen nt lds
  s_mov_b32 m0, 41184
  s_add_u32 s59, s64, 7168
  buffer_load_dwordx4 v12, s[8:11], s59 offen nt lds
  s_add_u32 s64, s55, 25
  s_and_b32 s64, s64, 31
  s_lshl_b32 s64, s64, 13
  s_mov_b32 m0, 76032
  s_add_u32 s59, s64, 0
  buffer_load_dwordx4 v11, s[12:15], s59 offen nt lds
  s_mov_b32 m0, 77088
  s_add_u32 s59, s64, 1024
  buffer_load_dwordx4 v11, s[12:15], s59 offen nt lds
  s_mov_b32 m0, 78144
  s_add_u32 s59, s64, 2048
  buffer_load_dwordx4 v11, s[12:15], s59 offen nt lds
  s_mov_b32 m0, 79200
  s_add_u32 s59, s64, 3072
  buffer_load_dwordx4 v11, s[12:15], s59 offen nt lds
  s_mov_b32 m0, 80256
  s_add_u32 s59, s64, 4096
  buffer_load_dwordx4 v11, s[12:15], s59 offen nt lds
  s_mov_b32 m0, 81312
  s_add_u32 s59, s64, 5120
  buffer_load_dwordx4 v11, s[12:15], s59 offen nt lds
  s_mov_b32 m0, 82368
  s_add_u32 s59, s64, 6144
  buffer_load_dwordx4 v11, s[12:15], s59 offen nt lds
  s_mov_b32 m0, 83424
  s_add_u32 s59, s64, 7168
  buffer_load_dwordx4 v11, s[12:15], s59 offen nt lds
  s_add_u32 s64, s55, 26
  s_and_b32 s64, s64, 31
  s_lshl_b32 s64, s64, 13
  s_mov_b32 m0, 84480
  s_add_u32 s59, s64, 0
  buffer_load_dwordx4 v11, s[12:15], s59 offen nt lds
  s_mov_b32 m0, 85536
  s_add_u32 s59, s64, 1024
  buffer_load_dwordx4 v11, s[12:15], s59 offen nt lds
  s_mov_b32 m0, 86592
  s_add_u32 s59, s64, 2048
  buffer_load_dwordx4 v11, s[12:15], s59 offen nt lds
  s_mov_b32 m0, 87648
  s_add_u32 s59, s64, 3072
  buffer_load_dwordx4 v11, s[12:15], s59 offen nt lds
  s_mov_b32 m0, 88704
  s_add_u32 s59, s64, 4096
  buffer_load_dwordx4 v11, s[12:15], s59 offen nt lds
  s_mov_b32 m0, 89760
  s_add_u32 s59, s64, 5120
  buffer_load_dwordx4 v11, s[12:15], s59 offen nt lds
  s_mov_b32 m0, 90816
  s_add_u32 s59, s64, 6144
  buffer_load_dwordx4 v11, s[12:15], s59 offen nt lds
  s_mov_b32 m0, 91872
  s_add_u32 s59, s64, 7168
  buffer_load_dwordx4 v11, s[12:15], s59 offen nt lds
  ds_read_b32 v9, v8
  s_waitcnt vmcnt(8)
  v_mov_b32 v7, 26
  ds_write_b32 v6, v7
  s_mov_b32 s65, 16777216
  s_waitcnt lgkmcnt(0)
  s_branch L_kv12_t
L_kv12:
  ds_read_b32 v9, v8
  s_waitcnt lgkmcnt(0)
L_kv12_t:
  v_cmp_gt_u32 vcc, 92, v9
  s_nop 1
  s_cbranch_vccz L_kv12_ok
  s_sleep 1
  s_sub_u32 s65, s65, 1
  s_cmp_lg_u32 s65, 0
  s_cbranch_scc1 L_kv12
L_kv12_ok:
  s_add_u32 s64, s55, 29
  s_and_b32 s64, s64, 31
  s_lshl_b32 s64, s64, 13
  s_mov_b32 m0, 42240
  s_add_u32 s59, s64, 0
  buffer_load_dwordx4 v10, s[8:11], s59 offen nt lds
  s_mov_b32 m0, 43296
  s_add_u32 s59, s64, 1024
  buffer_load_dwordx4 v10, s[8:11], s59 offen nt lds
  s_mov_b32 m0, 44352
  s_add_u32 s59, s64, 2048
  buffer_load_dwordx4 v10, s[8:11], s59 offen nt lds
  s_mov_b32 m0, 45408
  s_add_u32 s59, s64, 3072
  buffer_load_dwordx4 v10, s[8:11], s59 offen nt lds
  s_mov_b32 m0, 46464
  s_add_u32 s59, s64, 4096
  buffer_load_dwordx4 v12, s[8:11], s59 offen nt lds
  s_mov_b32 m0, 47520
  s_add_u32 s59, s64, 5120
  buffer_load_dwordx4 v12, s[8:11], s59 offen nt lds
  s_mov_b32 m0, 48576
  s_add_u32 s59, s64, 6144
  buffer_load_dwordx4 v12, s[8:11], s59 offen nt lds
  s_mov_b32 m0, 49632
  s_add_u32 s59, s64, 7168
  buffer_load_dwordx4 v12, s[8:11], s59 offen nt lds
  s_add_u32 s64, s55, 30
  s_and_b32 s64, s64, 31
  s_lshl_b32 s64, s64, 13
  s_mov_b32 m0, 50688
  s_add_u32 s59, s64, 0
  buffer_load_dwordx4 v10, s[8:11], s59 offen nt lds
  s_mov_b32 m0, 51744
  s_add_u32 s59, s64, 1024
  buffer_load_dwordx4 v10, s[8:11], s59 offen nt lds
  s_mov_b32 m0, 52800
  s_add_u32 s59, s64, 2048
  buffer_load_dwordx4 v10, s[8:11], s59 offen nt lds
  s_mov_b32 m0, 53856
  s_add_u32 s59, s64, 3072
  buffer_load_dwordx4 v10, s[8:11], s59 offen nt lds
  s_mov_b32 m0, 54912
  s_add_u32 s59, s64, 4096
  buffer_load_dwordx4 v12, s[8:11], s59 offen nt lds
  s_mov_b32 m0, 55968
  s_add_u32 s59, s64, 5120
  buffer_load_dwordx4 v12, s[8:11], s59 offen nt lds
  s_mov_b32 m0, 57024
  s_add_u32 s59, s64, 6144
  buffer_load_dwordx4 v12, s[8:11], s59 offen nt lds
  s_mov_b32 m0, 58080
  s_add_u32 s59, s64, 7168
  buffer_load_dwordx4 v12, s[8:11], s59 offen nt lds
  s_add_u32 s64, s55, 27
  s_and_b32 s64, s64, 31
  s_lshl_b32 s64, s64, 13
  s_mov_b32 m0, 92928
  s_add_u32 s59, s64, 0
  buffer_load_dwordx4 v11, s[12:15], s59 offen nt lds
  s_mov_b32 m0, 93984
  s_add_u32 s59, s64, 1024
  buffer_load_dwordx4 v11, s[12:15], s59 offen nt lds
  s_mov_b32 m0, 95040
  s_add_u32 s59, s64, 2048
  buffer_load_dwordx4 v11, s[12:15], s59 offen nt lds
  s_mov_b32 m0, 96096
  s_add_u32 s59, s64, 3072
  buffer_load_dwordx4 v11, s[12:15], s59 offen nt lds
  s_mov_b32 m0, 97152
  s_add_u32 s59, s64, 4096
  buffer_load_dwordx4 v11, s[12:15], s59 offen nt lds
  s_mov_b32 m0, 98208
  s_add_u32 s59, s64, 5120
  buffer_load_dwordx4 v11, s[12:15], s59 offen nt lds
  s_mov_b32 m0, 99264
  s_add_u32 s59, s64, 6144
  buffer_load_dwordx4 v11, s[12:15], s59 offen nt lds
  s_mov_b32 m0, 100320
  s_add_u32 s59, s64, 7168
  buffer_load_dwordx4 v11, s[12:15], s59 offen nt lds
  s_add_u32 s64, s55, 28
  s_and_b32 s64, s64, 31
  s_lshl_b32 s64, s64, 13
  s_mov_b32 m0, 101376
  s_add_u32 s59, s64, 0
  buffer_load_dwordx4 v11, s[12:15], s59 offen nt lds
  s_mov_b32 m0, 102432
  s_add_u32 s59, s64, 1024
  buffer_load_dwordx4 v11, s[12:15], s59 offen nt lds
  s_mov_b32 m0, 103488
  s_add_u32 s59, s64, 2048
  buffer_load_dwordx4 v11, s[12:15], s59 offen nt lds
  s_mov_b32 m0, 104544
  s_add_u32 s59, s64, 3072
  buffer_load_dwordx4 v11, s[12:15], s59 offen nt lds
  s_mov_b32 m0, 105600
  s_add_u32 s59, s64, 4096
  buffer_load_dwordx4 v11, s[12:15], s59 offen nt lds
  s_mov_b32 m0, 106656
  s_add_u32 s59, s64, 5120
  buffer_load_dwordx4 v11, s[12:15], s59 offen nt lds
  s_mov_b32 m0, 107712
  s_add_u32 s59, s64, 6144
  buffer_load_dwordx4 v11, s[12:15], s59 offen nt lds
  s_mov_b32 m0, 108768
  s_add_u32 s59, s64, 7168
  buffer_load_dwordx4 v11, s[12:15], s59 offen nt lds
  ds_read_b32 v9, v8
  s_waitcnt vmcnt(16)
  v_mov_b32 v7, 27
  ds_write_b32 v6, v7
  s_mov_b32 s65, 16777216
  s_waitcnt lgkmcnt(0)
  s_branch L_kv13_t
L_kv13:
  ds_read_b32 v9, v8
  s_waitcnt lgkmcnt(0)
L_kv13_t:
  v_cmp_gt_u32 vcc, 96, v9
  s_nop 1
  s_cbranch_vccz L_kv13_ok
  s_sleep 1
  s_sub_u32 s65, s65, 1
  s_cmp_lg_u32 s65, 0
  s_cbranch_scc1 L_kv13
L_kv13_ok:
  s_add_u32 s64, s55, 31
  s_and_b32 s64, s64, 31
  s_lshl_b32 s64, s64, 13
  s_mov_b32 m0, 59136
  s_add_u32 s59, s64, 0
  buffer_load_dwordx4 v10, s[8:11], s59 offen nt lds
  s_mov_b32 m0, 60192
  s_add_u32 s59, s64, 1024
  buffer_load_dwordx4 v10, s[8:11], s59 offen nt lds
  s_mov_b32 m0, 61248
  s_add_u32 s59, s64, 2048
  buffer_load_dwordx4 v10, s[8:11], s59 offen nt lds
  s_mov_b32 m0, 62304
  s_add_u32 s59, s64, 3072
  buffer_load_dwordx4 v10, s[8:11], s59 offen nt lds
  s_mov_b32 m0, 63360
  s_add_u32 s59, s64, 4096
  buffer_load_dwordx4 v12, s[8:11], s59 offen nt lds
  s_mov_b32 m0, 64416
  s_add_u32 s59, s64, 5120
  buffer_load_dwordx4 v12, s[8:11], s59 offen nt lds
  s_mov_b32 m0, 65472
  s_add_u32 s59, s64, 6144
  buffer_load_dwordx4 v12, s[8:11], s59 offen nt lds
  s_mov_b32 m0, 66528
  s_add_u32 s59, s64, 7168
  buffer_load_dwordx4 v12, s[8:11], s59 offen nt lds
  s_add_u32 s64, s55, 29
  s_and_b32 s64, s64, 31
  s_lshl_b32 s64, s64, 13
  s_mov_b32 m0, 109824
  s_add_u32 s59, s64, 0
  buffer_load_dwordx4 v11, s[12:15], s59 offen nt lds
  s_mov_b32 m0, 110880
  s_add_u32 s59, s64, 1024
  buffer_load_dwordx4 v11, s[12:15], s59 offen nt lds
  s_mov_b32 m0, 111936
  s_add_u32 s59, s64, 2048
  buffer_load_dwordx4 v11, s[12:15], s59 offen nt lds
  s_mov_b32 m0, 112992
  s_add_u32 s59, s64, 3072
  buffer_load_dwordx4 v11, s[12:15], s59 offen nt lds
  s_mov_b32 m0, 114048
  s_add_u32 s59, s64, 4096
  buffer_load_dwordx4 v11, s[12:15], s59 offen nt lds
  s_mov_b32 m0, 115104
  s_add_u32 s59, s64, 5120
  buffer_load_dwordx4 v11, s[12:15], s59 offen nt lds
  s_mov_b32 m0, 116160
  s_add_u32 s59, s64, 6144
  buffer_load_dwordx4 v11, s[12:15], s59 offen nt lds
  s_mov_b32 m0, 117216
  s_add_u32 s59, s64, 7168
  buffer_load_dwordx4 v11, s[12:15], s59 offen nt lds
  s_add_u32 s64, s55, 30
  s_and_b32 s64, s64, 31
  s_lshl_b32 s64, s64, 13
  s_mov_b32 m0, 118272
  s_add_u32 s59, s64, 0
  buffer_load_dwordx4 v11, s[12:15], s59 offen nt lds
  s_mov_b32 m0, 119328
  s_add_u32 s59, s64, 1024
  buffer_load_dwordx4 v11, s[12:15], s59 offen nt lds
  s_mov_b32 m0, 120384
  s_add_u32 s59, s64, 2048
  buffer_load_dwordx4 v11, s[12:15], s59 offen nt lds
  s_mov_b32 m0, 121440
  s_add_u32 s59, s64, 3072
  buffer_load_dwordx4 v11, s[12:15], s59 offen nt lds
  s_mov_b32 m0, 122496
  s_add_u32 s59, s64, 4096
  buffer_load_dwordx4 v11, s[12:15], s59 offen nt lds
  s_mov_b32 m0, 123552
  s_add_u32 s59, s64, 5120
  buffer_load_dwordx4 v11, s[12:15], s59 offen nt lds
  s_mov_b32 m0, 124608
  s_add_u32 s59, s64, 6144
  buffer_load_dwordx4 v11, s[12:15], s59 offen nt lds
  s_mov_b32 m0, 125664
  s_add_u32 s59, s64, 7168
  buffer_load_dwordx4 v11, s[12:15], s59 offen nt lds
  ds_read_b32 v9, v8
  s_waitcnt vmcnt(32)
  v_mov_b32 v7, 28
  ds_write_b32 v6, v7
  s_mov_b32 s65, 16777216
  s_waitcnt lgkmcnt(0)
  s_branch L_kv14_t
L_kv14:
  ds_read_b32 v9, v8
  s_waitcnt lgkmcnt(0)
L_kv14_t:
  v_cmp_gt_u32 vcc, 100, v9
  s_nop 1
  s_cbranch_vccz L_kv14_ok
  s_sleep 1
  s_sub_u32 s65, s65, 1
  s_cmp_lg_u32 s65, 0
  s_cbranch_scc1 L_kv14
L_kv14_ok:
  s_add_u32 s64, s55, 31
  s_and_b32 s64, s64, 31
  s_lshl_b32 s64, s64, 13
  s_mov_b32 m0, 126720
  s_add_u32 s59, s64, 0
  buffer_load_dwordx4 v11, s[12:15], s59 offen nt lds
  s_mov_b32 m0, 127776
  s_add_u32 s59, s64, 1024
  buffer_load_dwordx4 v11, s[12:15], s59 offen nt lds
  s_mov_b32 m0, 128832
  s_add_u32 s59, s64, 2048
  buffer_load_dwordx4 v11, s[12:15], s59 offen nt lds
  s_mov_b32 m0, 129888
  s_add_u32 s59, s64, 3072
  buffer_load_dwordx4 v11, s[12:15], s59 offen nt lds
  s_mov_b32 m0, 130944
  s_add_u32 s59, s64, 4096
  buffer_load_dwordx4 v11, s[12:15], s59 offen nt lds
  s_mov_b32 m0, 132000
  s_add_u32 s59, s64, 5120
  buffer_load_dwordx4 v11, s[12:15], s59 offen nt lds
  s_mov_b32 m0, 133056
  s_add_u32 s59, s64, 6144
  buffer_load_dwordx4 v11, s[12:15], s59 offen nt lds
  s_mov_b32 m0, 134112
  s_add_u32 s59, s64, 7168
  buffer_load_dwordx4 v11, s[12:15], s59 offen nt lds
  s_waitcnt vmcnt(32)
  v_mov_b32 v7, 29
  ds_write_b32 v6, v7
  s_waitcnt vmcnt(16)
  v_mov_b32 v7, 30
  ds_write_b32 v6, v7
  s_waitcnt vmcnt(8)
  v_mov_b32 v7, 31
  ds_write_b32 v6, v7
  s_waitcnt vmcnt(0)
  v_mov_b32 v7, 32
  ds_write_b32 v6, v7
  s_mov_b64 exec, 1
  v_mov_b32 v2, 0
  s_mov_b32 s65, 1048576
L_tokk:
  global_load_dwordx2 v[4:5], v2, s[48:49] sc1
  s_waitcnt vmcnt(0)
  v_readfirstlane_b32 s92, v4
  v_readfirstlane_b32 s93, v5
  s_nop 0
  s_cmp_lg_u32 s92, 0
  s_cbranch_scc1 L_tokk_ok
  s_sleep 2
  s_sub_u32 s65, s65, 1
  s_cmp_lg_u32 s65, 0
  s_cbranch_scc1 L_tokk
L_tokk_ok:
  s_mov_b64 exec, -1
  v_mov_b32 v2, 163328
  s_mov_b32 s65, 16777216
L_pollw4:
  ds_read_b32 v3, v2
  s_waitcnt lgkmcnt(0)
  v_cmp_eq_u32 vcc, 0, v3
  s_nop 1
  s_cbranch_vccz L_pollw4_ok
  s_sleep 16
  s_sub_u32 s65, s65, 1
  s_cmp_lg_u32 s65, 0
  s_cbranch_scc1 L_pollw4
L_pollw4_ok:
  s_add_u32 s59, s16, 0
  buffer_load_dwordx4 v[72:75], v249, s[32:35], s59 offen sc1
  s_add_u32 s59, s16, 1024
  buffer_load_dwordx4 v[76:79], v249, s[32:35], s59 offen sc1
  s_add_u32 s59, s16, 2048
  buffer_load_dwordx4 v[80:83], v249, s[32:35], s59 offen sc1
  s_add_u32 s59, s16, 3072
  buffer_load_dwordx4 v[84:87], v249, s[32:35], s59 offen sc1
  s_add_u32 s59, s16, 4096
  buffer_load_dwordx4 v[88:91], v249, s[32:35], s59 offen sc1
  s_add_u32 s59, s16, 5120
  buffer_load_dwordx4 v[92:95], v249, s[32:35], s59 offen sc1
  s_add_u32 s59, s16, 6144
  buffer_load_dwordx4 v[96:99], v249, s[32:35], s59 offen sc1
  s_add_u32 s59, s16, 7168
  buffer_load_dwordx4 v[100:103], v249, s[32:35], s59 offen sc1
  s_add_u32 s59, s16, 8192
  buffer_load_dwordx4 v[104:107], v249, s[32:35], s59 offen sc1
  s_add_u32 s59, s17, 0
  buffer_load_dwordx4 v[108:111], v249, s[32:35], s59 offen sc1
  s_add_u32 s59, s17, 1024
  buffer_load_dwordx4 v[112:115], v249, s[32:35], s59 offen sc1
  s_add_u32 s59, s17, 2048
  buffer_load_dwordx4 v[116:119], v249, s[32:35], s59 offen sc1
  s_add_u32 s59, s17, 3072
  buffer_load_dwordx4 v[120:123], v249, s[32:35], s59 offen sc1
  s_add_u32 s59, s17, 4096
  buffer_load_dwordx4 v[124:127], v249, s[32:35], s59 offen sc1
  s_add_u32 s59, s17, 5120
  buffer_load_dwordx4 v[128:131], v249, s[32:35], s59 offen sc1
  s_add_u32 s59, s17, 6144
  buffer_load_dwordx4 v[132:135], v249, s[32:35], s59 offen sc1
  s_add_u32 s59, s17, 7168
  buffer_load_dwordx4 v[136:139], v249, s[32:35], s59 offen sc1
  s_add_u32 s59, s17, 8192
  buffer_load_dwordx4 v[140:143], v249, s[32:35], s59 offen sc1
  s_add_u32 s59, s18, 0
  buffer_load_dwordx4 v[144:147], v249, s[32:35], s59 offen sc1
  s_add_u32 s59, s18, 1024
  buffer_load_dwordx4 v[148:151], v249, s[32:35], s59 offen sc1
  s_add_u32 s59, s18, 2048
  buffer_load_dwordx4 v[152:155], v249, s[32:35], s59 offen sc1
  s_add_u32 s59, s18, 3072
  buffer_load_dwordx4 v[156:159], v249, s[32:35], s59 offen sc1
  s_add_u32 s59, s18, 4096
  buffer_load_dwordx4 v[160:163], v249, s[32:35], s59 offen sc1
  s_add_u32 s59, s18, 5120
  buffer_load_dwordx4 v[164:167], v249, s[32:35], s59 offen sc1
  s_add_u32 s59, s18, 6144
  buffer_load_dwordx4 v[168:171], v249, s[32:35], s59 offen sc1
  s_add_u32 s59, s18, 7168
  buffer_load_dwordx4 v[172:175], v249, s[32:35], s59 offen sc1
  s_add_u32 s59, s18, 8192
  buffer_load_dwordx4 v[176:179], v249, s[32:35], s59 offen sc1
  s_add_u32 s59, s19, 0
  buffer_load_dwordx4 v[180:183], v249, s[32:35], s59 offen sc1
  s_add_u32 s59, s19, 1024
  buffer_load_dwordx4 v[184:187], v249, s[32:35], s59 offen sc1
  s_add_u32 s59, s19, 2048
  buffer_load_dwordx4 v[188:191], v249, s[32:35], s59 offen sc1
  s_add_u32 s59, s19, 3072
  buffer_load_dwordx4 v[192:195], v249, s[32:35], s59 offen sc1
  s_add_u32 s59, s19, 4096
  buffer_load_dwordx4 v[196:199], v249, s[32:35], s59 offen sc1
  s_add_u32 s59, s19, 5120
  buffer_load_dwordx4 v[200:203], v249, s[32:35], s59 offen sc1
  s_add_u32 s59, s19, 6144
  buffer_load_dwordx4 v[204:207], v249, s[32:35], s59 offen sc1
  s_add_u32 s59, s19, 7168
  buffer_load_dwordx4 v[208:211], v249, s[32:35], s59 offen sc1
  s_add_u32 s59, s19, 8192
  buffer_load_dwordx4 v[212:215], v249, s[32:35], s59 offen sc1
  s_mov_b32 s65, 16777216
L_prk26_0:
  ds_read_b32 v9, v8
  s_waitcnt lgkmcnt(0)
L_prk26_0_t:
  v_cmp_gt_u32 vcc, 108, v9
  s_nop 1
  s_cbranch_vccz L_prk26_0_ok
  s_sleep 4
  s_sub_u32 s65, s65, 1
  s_cmp_lg_u32 s65, 0
  s_cbranch_scc1 L_prk26_0
L_prk26_0_ok:
  s_add_u32 m0, s88, 0
  s_add_u32 s59, s20, 0
  buffer_load_dwordx4 v249, s[32:35], s59 offen sc1 lds
  s_add_u32 m0, s88, 1024
  s_add_u32 s59, s20, 1024
  buffer_load_dwordx4 v249, s[32:35], s59 offen sc1 lds
  s_add_u32 m0, s88, 2048
  s_add_u32 s59, s20, 2048
  buffer_load_dwordx4 v249, s[32:35], s59 offen sc1 lds
  s_add_u32 m0, s88, 3072
  s_add_u32 s59, s20, 3072
  buffer_load_dwordx4 v249, s[32:35], s59 offen sc1 lds
  s_add_u32 m0, s88, 4096
  s_add_u32 s59, s20, 4096
  buffer_load_dwordx4 v249, s[32:35], s59 offen sc1 lds
  s_add_u32 m0, s88, 5120
  s_add_u32 s59, s20, 5120
  buffer_load_dwordx4 v249, s[32:35], s59 offen sc1 lds
  s_add_u32 m0, s88, 6144
  s_add_u32 s59, s20, 6144
  buffer_load_dwordx4 v249, s[32:35], s59 offen sc1 lds
  s_add_u32 m0, s88, 7168
  s_add_u32 s59, s20, 7168
  buffer_load_dwordx4 v249, s[32:35], s59 offen sc1 lds
  s_add_u32 m0, s88, 8192
  s_add_u32 s59, s20, 8192
  buffer_load_dwordx4 v249, s[32:35], s59 offen sc1 lds
  s_add_u32 m0, s89, 0
  s_add_u32 s59, s21, 0
  buffer_load_dwordx4 v249, s[32:35], s59 offen sc1 lds
  s_add_u32 m0, s89, 1024
  s_add_u32 s59, s21, 1024
  buffer_load_dwordx4 v249, s[32:35], s59 offen sc1 lds
  s_add_u32 m0, s89, 2048
  s_add_u32 s59, s21, 2048
  buffer_load_dwordx4 v249, s[32:35], s59 offen sc1 lds
  s_add_u32 m0, s89, 3072
  s_add_u32 s59, s21, 3072
  buffer_load_dwordx4 v249, s[32:35], s59 offen sc1 lds
  s_add_u32 m0, s89, 4096
  s_add_u32 s59, s21, 4096
  buffer_load_dwordx4 v249, s[32:35], s59 offen sc1 lds
  s_add_u32 m0, s89, 5120
  s_add_u32 s59, s21, 5120
  buffer_load_dwordx4 v249, s[32:35], s59 offen sc1 lds
  s_add_u32 m0, s89, 6144
  s_add_u32 s59, s21, 6144
  buffer_load_dwordx4 v249, s[32:35], s59 offen sc1 lds
  s_add_u32 m0, s89, 7168
  s_add_u32 s59, s21, 7168
  buffer_load_dwordx4 v249, s[32:35], s59 offen sc1 lds
  s_add_u32 m0, s89, 8192
  s_add_u32 s59, s21, 8192
  buffer_load_dwordx4 v249, s[32:35], s59 offen sc1 lds
  s_branch L_tail
L_h5:
  v_lshlrev_b32 v6, 3, v0
  v_add_u32 v6, 162816, v6
  v_mov_b32 v2, 0
  v_mov_b32 v3, 0
  ds_write_b64 v6, v[2:3]
  v_mov_b32 v6, 163328
  ds_write_b32 v6, v2
  s_waitcnt lgkmcnt(0)
  v_mov_b32 v6, 163332
  ds_write_b32 v6, v2
  v_mov_b32 v6, 163336
  ds_write_b32 v6, v2
  s_waitcnt lgkmcnt(0)
  v_lshlrev_b32 v10, 4, v0
  v_lshlrev_b32 v11, 4, v0
  v_lshlrev_b32 v12, 4, v0
  s_mul_i32 s55, s2, 8
  s_lshr_b32 s55, s55, 3
  v_lshlrev_b32 v13, 4, v0
  v_add_u32 v14, 67584, v13
  s_lshr_b32 s63, s2, 3
  s_and_b32 s63, s63, 7
  s_mul_i32 s63, s63, 0
  v_and_b32 v8, 3, v255
  v_lshlrev_b32 v8, 6, v8
  v_add_u32 v8, 162816, v8
  v_lshlrev_b32 v251, 4, v255
  s_mul_i32 s64, s70, 393216
  s_mul_i32 s65, s54, 49152
  s_add_u32 s64, s64, s65
  v_add_u32 v248, s64, v251
  s_mul_i32 s64, s71, 589824
  s_mul_i32 s65, s54, 73728
  s_add_u32 s64, s64, s65
  v_add_u32 v249, s64, v251
  s_add_u32 s64, s47, 0
  s_and_b32 s64, s64, 7
  s_mul_i32 s36, s64, 6144
  s_mul_i32 s16, s64, 9216
  s_add_u32 s64, s47, 1
  s_and_b32 s64, s64, 7
  s_mul_i32 s37, s64, 6144
  s_mul_i32 s17, s64, 9216
  s_add_u32 s64, s47, 2
  s_and_b32 s64, s64, 7
  s_mul_i32 s38, s64, 6144
  s_mul_i32 s18, s64, 9216
  s_add_u32 s64, s47, 3
  s_and_b32 s64, s64, 7
  s_mul_i32 s39, s64, 6144
  s_mul_i32 s19, s64, 9216
  s_add_u32 s64, s47, 4
  s_and_b32 s64, s64, 7
  s_mul_i32 s40, s64, 6144
  s_mul_i32 s20, s64, 9216
  s_add_u32 s64, s47, 5
  s_and_b32 s64, s64, 7
  s_mul_i32 s41, s64, 6144
  s_mul_i32 s21, s64, 9216
  s_add_u32 s64, s47, 6
  s_and_b32 s64, s64, 7
  s_mul_i32 s42, s64, 6144
  s_mul_i32 s22, s64, 9216
  s_add_u32 s64, s47, 7
  s_and_b32 s64, s64, 7
  s_mul_i32 s43, s64, 6144
  s_mul_i32 s23, s64, 9216
  s_mov_b32 s66, 27648
  s_mov_b32 s67, 36864
  s_cmp_eq_u32 s54, 1
  s_cselect_b32 s66, 46080, s66
  s_cselect_b32 s67, 55296, s67
  s_cmp_eq_u32 s54, 2
  s_cselect_b32 s66, 86016, s66
  s_cselect_b32 s67, 95232, s67
  s_cmp_eq_u32 s54, 3
  s_cselect_b32 s66, 104448, s66
  s_cselect_b32 s67, 113664, s67
  s_cmp_eq_u32 s54, 4
  s_cselect_b32 s66, 9216, s66
  s_cselect_b32 s67, 67584, s67
  s_cmp_eq_u32 s54, 5
  s_cselect_b32 s66, 18432, s66
  s_cselect_b32 s67, 76800, s67
  s_cmp_eq_u32 s54, 6
  s_cselect_b32 s66, 135168, s66
  s_cselect_b32 s67, 144384, s67
  s_cmp_eq_u32 s54, 7
  s_cselect_b32 s66, 153600, s66
  s_cselect_b32 s67, 0, s67
  s_mov_b32 s88, s66
  s_mov_b32 s89, s67
  v_add_u32 v250, s66, v251
  s_barrier
  s_barrier
  s_barrier
  s_barrier
  s_barrier
  s_barrier
  s_add_u32 s64, s55, 4
  s_and_b32 s64, s64, 31
  s_lshl_b32 s64, s64, 13
  s_add_u32 s59, s64, 0
  buffer_load_dwordx4 v[16:19], v10, s[8:11], s59 offen nt
  s_add_u32 s59, s64, 1024
  buffer_load_dwordx4 v[20:23], v10, s[8:11], s59 offen nt
  s_add_u32 s59, s64, 2048
  buffer_load_dwordx4 v[24:27], v10, s[8:11], s59 offen nt
  s_add_u32 s59, s64, 3072
  buffer_load_dwordx4 v[28:31], v10, s[8:11], s59 offen nt
  s_add_u32 s59, s64, 4096
  buffer_load_dwordx4 v[32:35], v12, s[8:11], s59 offen nt
  s_add_u32 s59, s64, 5120
  buffer_load_dwordx4 v[36:39], v12, s[8:11], s59 offen nt
  s_add_u32 s59, s64, 6144
  buffer_load_dwordx4 v[40:43], v12, s[8:11], s59 offen nt
  s_add_u32 s59, s64, 7168
  buffer_load_dwordx4 v[44:47], v12, s[8:11], s59 offen nt
  s_barrier
  s_barrier
  s_barrier
  s_add_u32 s64, s55, 3
  s_and_b32 s64, s64, 31
  s_lshl_b32 s64, s64, 13
  s_add_u32 s59, s64, 0
  buffer_load_dwordx4 v[48:51], v11, s[12:15], s59 offen nt
  s_add_u32 s59, s64, 1024
  buffer_load_dwordx4 v[52:55], v11, s[12:15], s59 offen nt
  s_add_u32 s59, s64, 2048
  buffer_load_dwordx4 v[56:59], v11, s[12:15], s59 offen nt
  s_add_u32 s59, s64, 3072
  buffer_load_dwordx4 v[60:63], v11, s[12:15], s59 offen nt
  s_add_u32 s59, s64, 4096
  buffer_load_dwordx4 v[64:67], v11, s[12:15], s59 offen nt
  s_add_u32 s59, s64, 5120
  buffer_load_dwordx4 v[68:71], v11, s[12:15], s59 offen nt
  s_add_u32 s59, s64, 6144
  buffer_load_dwordx4 v[72:75], v11, s[12:15], s59 offen nt
  s_add_u32 s59, s64, 7168
  buffer_load_dwordx4 v[76:79], v11, s[12:15], s59 offen nt
  s_barrier
  s_barrier
  s_barrier
  s_add_u32 s64, s55, 5
  s_and_b32 s64, s64, 31
  s_lshl_b32 s64, s64, 13
  s_add_u32 s59, s64, 0
  buffer_load_dwordx4 v[80:83], v10, s[8:11], s59 offen nt
  s_add_u32 s59, s64, 1024
  buffer_load_dwordx4 v[84:87], v10, s[8:11], s59 offen nt
  s_add_u32 s59, s64, 2048
  buffer_load_dwordx4 v[88:91], v10, s[8:11], s59 offen nt
  s_add_u32 s59, s64, 3072
  buffer_load_dwordx4 v[92:95], v10, s[8:11], s59 offen nt
  s_add_u32 s59, s64, 4096
  buffer_load_dwordx4 v[96:99], v12, s[8:11], s59 offen nt
  s_add_u32 s59, s64, 5120
  buffer_load_dwordx4 v[100:103], v12, s[8:11], s59 offen nt
  s_add_u32 s59, s64, 6144
  buffer_load_dwordx4 v[104:107], v12, s[8:11], s59 offen nt
  s_add_u32 s59, s64, 7168
  buffer_load_dwordx4 v[108:111], v12, s[8:11], s59 offen nt
  s_barrier
  s_barrier
  s_barrier
  s_add_u32 s64, s55, 4
  s_and_b32 s64, s64, 31
  s_lshl_b32 s64, s64, 13
  s_add_u32 s59, s64, 0
  buffer_load_dwordx4 v[112:115], v11, s[12:15], s59 offen nt
  s_add_u32 s59, s64, 1024
  buffer_load_dwordx4 v[116:119], v11, s[12:15], s59 offen nt
  s_add_u32 s59, s64, 2048
  buffer_load_dwordx4 v[120:123], v11, s[12:15], s59 offen nt
  s_add_u32 s59, s64, 3072
  buffer_load_dwordx4 v[124:127], v11, s[12:15], s59 offen nt
  s_add_u32 s59, s64, 4096
  buffer_load_dwordx4 v[128:131], v11, s[12:15], s59 offen nt
  s_add_u32 s59, s64, 5120
  buffer_load_dwordx4 v[132:135], v11, s[12:15], s59 offen nt
  s_add_u32 s59, s64, 6144
  buffer_load_dwordx4 v[136:139], v11, s[12:15], s59 offen nt
  s_add_u32 s59, s64, 7168
  buffer_load_dwordx4 v[140:143], v11, s[12:15], s59 offen nt
  s_barrier
  s_barrier
  s_barrier
  s_barrier
  s_waitcnt vmcnt(24)
  ds_write_b128 v13, v[16:19] offset:33792
  ds_write_b128 v13, v[20:23] offset:34848
  ds_write_b128 v13, v[24:27] offset:35904
  ds_write_b128 v13, v[28:31] offset:36960
  ds_write_b128 v13, v[32:35] offset:38016
  ds_write_b128 v13, v[36:39] offset:39072
  ds_write_b128 v13, v[40:43] offset:40128
  ds_write_b128 v13, v[44:47] offset:41184
  s_waitcnt vmcnt(16)
  ds_write_b128 v14, v[48:51] offset:25344
  ds_write_b128 v14, v[52:55] offset:26400
  ds_write_b128 v14, v[56:59] offset:27456
  ds_write_b128 v14, v[60:63] offset:28512
  ds_write_b128 v14, v[64:67] offset:29568
  ds_write_b128 v14, v[68:71] offset:30624
  ds_write_b128 v14, v[72:75] offset:31680
  ds_write_b128 v14, v[76:79] offset:32736
  s_waitcnt vmcnt(8)
  ds_write_b128 v13, v[80:83] offset:42240
  ds_write_b128 v13, v[84:87] offset:43296
  ds_write_b128 v13, v[88:91] offset:44352
  ds_write_b128 v13, v[92:95] offset:45408
  ds_write_b128 v13, v[96:99] offset:46464
  ds_write_b128 v13, v[100:103] offset:47520
  ds_write_b128 v13, v[104:107] offset:48576
  ds_write_b128 v13, v[108:111] offset:49632
  s_waitcnt vmcnt(0)
  ds_write_b128 v14, v[112:115] offset:33792
  ds_write_b128 v14, v[116:119] offset:34848
  ds_write_b128 v14, v[120:123] offset:35904
  ds_write_b128 v14, v[124:127] offset:36960
  ds_write_b128 v14, v[128:131] offset:38016
  ds_write_b128 v14, v[132:135] offset:39072
  ds_write_b128 v14, v[136:139] offset:40128
  ds_write_b128 v14, v[140:143] offset:41184
  s_waitcnt lgkmcnt(0)
  v_mov_b32 v6, 163332
  v_mov_b32 v7, 4
  ds_write_b32 v6, v7
  s_waitcnt lgkmcnt(0)
  s_mov_b64 exec, 1
  v_mov_b32 v2, 0
  s_mov_b32 s65, 1048576
L_tok5:
  global_load_dwordx2 v[4:5], v2, s[48:49] sc1
  s_waitcnt vmcnt(0)
  v_readfirstlane_b32 s92, v4
  v_readfirstlane_b32 s93, v5
  s_nop 0
  s_cmp_lg_u32 s92, 0
  s_cbranch_scc1 L_tok5_ok
  s_sleep 2
  s_sub_u32 s65, s65, 1
  s_cmp_lg_u32 s65, 0
  s_cbranch_scc1 L_tok5
L_tok5_ok:
  s_mov_b64 exec, -1
  v_mov_b32 v2, 163328
  s_mov_b32 s65, 16777216
L_pollw5:
  ds_read_b32 v3, v2
  s_waitcnt lgkmcnt(0)
  v_cmp_eq_u32 vcc, 0, v3
  s_nop 1
  s_cbranch_vccz L_pollw5_ok
  s_sleep 16
  s_sub_u32 s65, s65, 1
  s_cmp_lg_u32 s65, 0
  s_cbranch_scc1 L_pollw5
L_pollw5_ok:
  s_mov_b32 s65, 16777216
L_pcf0:
  ds_read_b32 v9, v8
  s_waitcnt lgkmcnt(0)
L_pcf0_t:
  v_cmp_gt_u32 vcc, 96, v9
  s_nop 1
  s_cbranch_vccz L_pcf0_ok
  s_sleep 4
  s_sub_u32 s65, s65, 1
  s_cmp_lg_u32 s65, 0
  s_cbranch_scc1 L_pcf0
L_pcf0_ok:
  s_add_u32 s59, s16, 0
  buffer_load_dwordx4 v[72:75], v249, s[32:35], s59 offen sc1
  s_add_u32 s59, s16, 1024
  buffer_load_dwordx4 v[76:79], v249, s[32:35], s59 offen sc1
  s_add_u32 s59, s16, 2048
  buffer_load_dwordx4 v[80:83], v249, s[32:35], s59 offen sc1
  s_add_u32 s59, s16, 3072
  buffer_load_dwordx4 v[84:87], v249, s[32:35], s59 offen sc1
  s_add_u32 s59, s16, 4096
  buffer_load_dwordx4 v[88:91], v249, s[32:35], s59 offen sc1
  s_add_u32 s59, s16, 5120
  buffer_load_dwordx4 v[92:95], v249, s[32:35], s59 offen sc1
  s_add_u32 s59, s16, 6144
  buffer_load_dwordx4 v[96:99], v249, s[32:35], s59 offen sc1
  s_add_u32 s59, s16, 7168
  buffer_load_dwordx4 v[100:103], v249, s[32:35], s59 offen sc1
  s_add_u32 s59, s16, 8192
  buffer_load_dwordx4 v[104:107], v249, s[32:35], s59 offen sc1
  s_mov_b32 s65, 16777216
L_pcf9:
  ds_read_b32 v9, v8
  s_waitcnt lgkmcnt(0)
L_pcf9_t:
  v_cmp_gt_u32 vcc, 100, v9
  s_nop 1
  s_cbranch_vccz L_pcf9_ok
  s_sleep 4
  s_sub_u32 s65, s65, 1
  s_cmp_lg_u32 s65, 0
  s_cbranch_scc1 L_pcf9
L_pcf9_ok:
  s_add_u32 s59, s17, 0
  buffer_load_dwordx4 v[108:111], v249, s[32:35], s59 offen sc1
  s_add_u32 s59, s17, 1024
  buffer_load_dwordx4 v[112:115], v249, s[32:35], s59 offen sc1
  s_add_u32 s59, s17, 2048
  buffer_load_dwordx4 v[116:119], v249, s[32:35], s59 offen sc1
  s_add_u32 s59, s17, 3072
  buffer_load_dwordx4 v[120:123], v249, s[32:35], s59 offen sc1
  s_add_u32 s59, s17, 4096
  buffer_load_dwordx4 v[124:127], v249, s[32:35], s59 offen sc1
  s_add_u32 s59, s17, 5120
  buffer_load_dwordx4 v[128:131], v249, s[32:35], s59 offen sc1
  s_add_u32 s59, s17, 6144
  buffer_load_dwordx4 v[132:135], v249, s[32:35], s59 offen sc1
  s_add_u32 s59, s17, 7168
  buffer_load_dwordx4 v[136:139], v249, s[32:35], s59 offen sc1
  s_add_u32 s59, s17, 8192
  buffer_load_dwordx4 v[140:143], v249, s[32:35], s59 offen sc1
  s_mov_b32 s65, 16777216
L_pcf18:
  ds_read_b32 v9, v8
  s_waitcnt lgkmcnt(0)
L_pcf18_t:
  v_cmp_gt_u32 vcc, 104, v9
  s_nop 1
  s_cbranch_vccz L_pcf18_ok
  s_sleep 4
  s_sub_u32 s65, s65, 1
  s_cmp_lg_u32 s65, 0
  s_cbranch_scc1 L_pcf18
L_pcf18_ok:
  s_add_u32 s59, s18, 0
  buffer_load_dwordx4 v[144:147], v249, s[32:35], s59 offen sc1
  s_add_u32 s59, s18, 1024
  buffer_load_dwordx4 v[148:151], v249, s[32:35], s59 offen sc1
  s_add_u32 s59, s18, 2048
  buffer_load_dwordx4 v[152:155], v249, s[32:35], s59 offen sc1
  s_add_u32 s59, s18, 3072
  buffer_load_dwordx4 v[156:159], v249, s[32:35], s59 offen sc1
  s_add_u32 s59, s18, 4096
  buffer_load_dwordx4 v[160:163], v249, s[32:35], s59 offen sc1
  s_add_u32 s59, s18, 5120
  buffer_load_dwordx4 v[164:167], v249, s[32:35], s59 offen sc1
  s_add_u32 s59, s18, 6144
  buffer_load_dwordx4 v[168:171], v249, s[32:35], s59 offen sc1
  s_add_u32 s59, s18, 7168
  buffer_load_dwordx4 v[172:175], v249, s[32:35], s59 offen sc1
  s_add_u32 s59, s18, 8192
  buffer_load_dwordx4 v[176:179], v249, s[32:35], s59 offen sc1
  s_mov_b32 s65, 16777216
L_pcf27:
  ds_read_b32 v9, v8
  s_waitcnt lgkmcnt(0)
L_pcf27_t:
  v_cmp_gt_u32 vcc, 108, v9
  s_nop 1
  s_cbranch_vccz L_pcf27_ok
  s_sleep 4
  s_sub_u32 s65, s65, 1
  s_cmp_lg_u32 s65, 0
  s_cbranch_scc1 L_pcf27
L_pcf27_ok:
  s_add_u32 s59, s19, 0
  buffer_load_dwordx4 v[180:183], v249, s[32:35], s59 offen sc1
  s_add_u32 s59, s19, 1024
  buffer_load_dwordx4 v[184:187], v249, s[32:35], s59 offen sc1
  s_add_u32 s59, s19, 2048
  buffer_load_dwordx4 v[188:191], v249, s[32:35], s59 offen sc1
  s_add_u32 s59, s19, 3072
  buffer_load_dwordx4 v[192:195], v249, s[32:35], s59 offen sc1
  s_add_u32 s59, s19, 4096
  buffer_load_dwordx4 v[196:199], v249, s[32:35], s59 offen sc1
  s_add_u32 s59, s19, 5120
  buffer_load_dwordx4 v[200:203], v249, s[32:35], s59 offen sc1
  s_add_u32 s59, s19, 6144
  buffer_load_dwordx4 v[204:207], v249, s[32:35], s59 offen sc1
  s_add_u32 s59, s19, 7168
  buffer_load_dwordx4 v[208:211], v249, s[32:35], s59 offen sc1
  s_add_u32 s59, s19, 8192
  buffer_load_dwordx4 v[212:215], v249, s[32:35], s59 offen sc1
  s_mov_b32 s65, 16777216
L_prf27_27:
  ds_read_b32 v9, v8
  s_waitcnt lgkmcnt(0)
L_prf27_27_t:
  v_cmp_gt_u32 vcc, 112, v9
  s_nop 1
  s_cbranch_vccz L_prf27_27_ok
  s_sleep 4
  s_sub_u32 s65, s65, 1
  s_cmp_lg_u32 s65, 0
  s_cbranch_scc1 L_prf27_27
L_prf27_27_ok:
  s_add_u32 m0, s88, 0
  s_add_u32 s59, s20, 0
  buffer_load_dwordx4 v249, s[32:35], s59 offen sc1 lds
  s_add_u32 m0, s88, 1024
  s_add_u32 s59, s20, 1024
  buffer_load_dwordx4 v249, s[32:35], s59 offen sc1 lds
  s_add_u32 m0, s88, 2048
  s_add_u32 s59, s20, 2048
  buffer_load_dwordx4 v249, s[32:35], s59 offen sc1 lds
  s_add_u32 m0, s88, 3072
  s_add_u32 s59, s20, 3072
  buffer_load_dwordx4 v249, s[32:35], s59 offen sc1 lds
  s_add_u32 m0, s88, 4096
  s_add_u32 s59, s20, 4096
  buffer_load_dwordx4 v249, s[32:35], s59 offen sc1 lds
  s_add_u32 m0, s88, 5120
  s_add_u32 s59, s20, 5120
  buffer_load_dwordx4 v249, s[32:35], s59 offen sc1 lds
  s_add_u32 m0, s88, 6144
  s_add_u32 s59, s20, 6144
  buffer_load_dwordx4 v249, s[32:35], s59 offen sc1 lds
  s_add_u32 m0, s88, 7168
  s_add_u32 s59, s20, 7168
  buffer_load_dwordx4 v249, s[32:35], s59 offen sc1 lds
  s_add_u32 m0, s88, 8192
  s_add_u32 s59, s20, 8192
  buffer_load_dwordx4 v249, s[32:35], s59 offen sc1 lds
  s_add_u32 m0, s89, 0
  s_add_u32 s59, s21, 0
  buffer_load_dwordx4 v249, s[32:35], s59 offen sc1 lds
  s_add_u32 m0, s89, 1024
  s_add_u32 s59, s21, 1024
  buffer_load_dwordx4 v249, s[32:35], s59 offen sc1 lds
  s_add_u32 m0, s89, 2048
  s_add_u32 s59, s21, 2048
  buffer_load_dwordx4 v249, s[32:35], s59 offen sc1 lds
  s_add_u32 m0, s89, 3072
  s_add_u32 s59, s21, 3072
  buffer_load_dwordx4 v249, s[32:35], s59 offen sc1 lds
  s_add_u32 m0, s89, 4096
  s_add_u32 s59, s21, 4096
  buffer_load_dwordx4 v249, s[32:35], s59 offen sc1 lds
  s_add_u32 m0, s89, 5120
  s_add_u32 s59, s21, 5120
  buffer_load_dwordx4 v249, s[32:35], s59 offen sc1 lds
  s_add_u32 m0, s89, 6144
  s_add_u32 s59, s21, 6144
  buffer_load_dwordx4 v249, s[32:35], s59 offen sc1 lds
  s_add_u32 m0, s89, 7168
  s_add_u32 s59, s21, 7168
  buffer_load_dwordx4 v249, s[32:35], s59 offen sc1 lds
  s_add_u32 m0, s89, 8192
  s_add_u32 s59, s21, 8192
  buffer_load_dwordx4 v249, s[32:35], s59 offen sc1 lds
  v_lshlrev_b32 v14, 4, v255
  s_mul_i32 s66, s71, 589824
  v_add_u32 v14, s66, v14
  s_mov_b32 s65, 16777216
L_clf00:
  ds_read_b32 v9, v8
  s_waitcnt lgkmcnt(0)
L_clf00_t:
  v_cmp_gt_u32 vcc, 116, v9
  s_nop 1
  s_cbranch_vccz L_clf00_ok
  s_sleep 4
  s_sub_u32 s65, s65, 1
  s_cmp_lg_u32 s65, 0
  s_cbranch_scc1 L_clf00
L_clf00_ok:
  s_mov_b32 m0, 27648
  s_mov_b32 s59, 36864
  buffer_load_dwordx4 v14, s[32:35], s59 offen sc1 lds
  s_mov_b32 m0, 28672
  s_mov_b32 s59, 37888
  buffer_load_dwordx4 v14, s[32:35], s59 offen sc1 lds
  s_mov_b32 m0, 29696
  s_mov_b32 s59, 38912
  buffer_load_dwordx4 v14, s[32:35], s59 offen sc1 lds
  s_mov_b32 m0, 30720
  s_mov_b32 s59, 39936
  buffer_load_dwordx4 v14, s[32:35], s59 offen sc1 lds
  s_mov_b32 m0, 31744
  s_mov_b32 s59, 40960
  buffer_load_dwordx4 v14, s[32:35], s59 offen sc1 lds
  s_mov_b32 m0, 32768
  s_mov_b32 s59, 41984
  buffer_load_dwordx4 v14, s[32:35], s59 offen sc1 lds
  s_mov_b32 m0, 33792
  s_mov_b32 s59, 43008
  s_waitcnt vmcnt(40)
  buffer_load_dwordx4 v14, s[32:35], s59 offen sc1 lds
  s_mov_b32 m0, 34816
  s_mov_b32 s59, 44032
  buffer_load_dwordx4 v14, s[32:35], s59 offen sc1 lds
  s_mov_b32 m0, 35840
  s_mov_b32 s59, 45056
  buffer_load_dwordx4 v14, s[32:35], s59 offen sc1 lds
  s_mov_b32 s65, 16777216
L_clf01:
  ds_read_b32 v9, v8
  s_waitcnt lgkmcnt(0)
L_clf01_t:
  v_cmp_gt_u32 vcc, 120, v9
  s_nop 1
  s_cbranch_vccz L_clf01_ok
  s_sleep 4
  s_sub_u32 s65, s65, 1
  s_cmp_lg_u32 s65, 0
  s_cbranch_scc1 L_clf01
L_clf01_ok:
  s_mov_b32 m0, 36864
  s_mov_b32 s59, 46080
  buffer_load_dwordx4 v14, s[32:35], s59 offen sc1 lds
  s_mov_b32 m0, 37888
  s_mov_b32 s59, 47104
  buffer_load_dwordx4 v14, s[32:35], s59 offen sc1 lds
  s_mov_b32 m0, 38912
  s_mov_b32 s59, 48128
  buffer_load_dwordx4 v14, s[32:35], s59 offen sc1 lds
  s_mov_b32 m0, 39936
  s_mov_b32 s59, 49152
  buffer_load_dwordx4 v14, s[32:35], s59 offen sc1 lds
  s_mov_b32 m0, 40960
  s_mov_b32 s59, 50176
  buffer_load_dwordx4 v14, s[32:35], s59 offen sc1 lds
  s_mov_b32 m0, 41984
  s_mov_b32 s59, 51200
  buffer_load_dwordx4 v14, s[32:35], s59 offen sc1 lds
  s_mov_b32 m0, 43008
  s_mov_b32 s59, 52224
  buffer_load_dwordx4 v14, s[32:35], s59 offen sc1 lds
  s_mov_b32 m0, 44032
  s_mov_b32 s59, 53248
  buffer_load_dwordx4 v14, s[32:35], s59 offen sc1 lds
  s_mov_b32 m0, 45056
  s_mov_b32 s59, 54272
  buffer_load_dwordx4 v14, s[32:35], s59 offen sc1 lds
  s_mov_b32 s65, 16777216
L_clf10:
  ds_read_b32 v9, v8
  s_waitcnt lgkmcnt(0)
L_clf10_t:
  v_cmp_gt_u32 vcc, 124, v9
  s_nop 1
  s_cbranch_vccz L_clf10_ok
  s_sleep 4
  s_sub_u32 s65, s65, 1
  s_cmp_lg_u32 s65, 0
  s_cbranch_scc1 L_clf10
L_clf10_ok:
  s_mov_b32 m0, 46080
  s_mov_b32 s59, 110592
  buffer_load_dwordx4 v14, s[32:35], s59 offen sc1 lds
  s_mov_b32 m0, 47104
  s_mov_b32 s59, 111616
  buffer_load_dwordx4 v14, s[32:35], s59 offen sc1 lds
  s_mov_b32 m0, 48128
  s_mov_b32 s59, 112640
  buffer_load_dwordx4 v14, s[32:35], s59 offen sc1 lds
  s_mov_b32 m0, 49152
  s_mov_b32 s59, 113664
  buffer_load_dwordx4 v14, s[32:35], s59 offen sc1 lds
  s_mov_b32 m0, 50176
  s_mov_b32 s59, 114688
  buffer_load_dwordx4 v14, s[32:35], s59 offen sc1 lds
  s_mov_b32 m0, 51200
  s_mov_b32 s59, 115712
  buffer_load_dwordx4 v14, s[32:35], s59 offen sc1 lds
  s_mov_b32 m0, 52224
  s_mov_b32 s59, 116736
  buffer_load_dwordx4 v14, s[32:35], s59 offen sc1 lds
  s_mov_b32 m0, 53248
  s_mov_b32 s59, 117760
  buffer_load_dwordx4 v14, s[32:35], s59 offen sc1 lds
  s_mov_b32 m0, 54272
  s_mov_b32 s59, 118784
  s_waitcnt vmcnt(40)
  buffer_load_dwordx4 v14, s[32:35], s59 offen sc1 lds
  s_waitcnt vmcnt(0)
  v_mov_b32 v2, 163336
  v_mov_b32 v3, 1
  s_mov_b64 exec, 1
  ds_add_u32 v2, v3
  s_mov_b64 exec, -1
  s_waitcnt lgkmcnt(0)
L_tail:
  s_lshr_b32 s66, s70, 1
  s_lshl_b32 s66, s66, 4
  s_lshl_b32 s67, s54, 1
  s_add_u32 s66, s66, s67
  s_lshl_b32 s66, s66, 2
  s_and_b32 s67, s70, 1
  s_add_u32 s66, s66, s67
  s_lshl_b32 s66, s66, 7
  s_add_u32 s66, s66, 12582912
  s_mov_b64 exec, 0xf
  v_lshlrev_b32 v254, 8, v255
  v_add_u32 v254, s66, v254
  s_mov_b32 s65, 1048576
  global_load_dwordx2 v[252:253], v254, s[50:51] sc1
L_pp:
  global_load_dwordx2 v[246:247], v254, s[50:51] sc1
  s_waitcnt vmcnt(1)
  v_cmp_ne_u32 vcc, s92, v252
  v_cmp_ne_u32 s[90:91], s93, v253
  s_nop 1
  s_or_b64 s[90:91], vcc, s[90:91]
  s_cbranch_scc0 L_pp_ok
  global_load_dwordx2 v[252:253], v254, s[50:51] sc1
  s_waitcnt vmcnt(1)
  v_cmp_ne_u32 vcc, s92, v246
  v_cmp_ne_u32 s[90:91], s93, v247
  s_nop 1
  s_or_b64 s[90:91], vcc, s[90:91]
  s_cbranch_scc0 L_pp_ok
  s_sub_u32 s65, s65, 1
  s_cmp_lg_u32 s65, 0
  s_cbranch_scc1 L_pp
L_pp_ok:
  s_mov_b64 exec, -1
  v_add_u32 v254, s89, v251
  s_add_u32 s59, s36, 0
  buffer_load_dwordx4 v[216:219], v248, s[28:31], s59 offen sc1
  s_add_u32 s59, s36, 1024
  buffer_load_dwordx4 v[220:223], v248, s[28:31], s59 offen sc1
  s_add_u32 s59, s36, 2048
  buffer_load_dwordx4 v[224:227], v248, s[28:31], s59 offen sc1
  s_add_u32 s59, s36, 3072
  buffer_load_dwordx4 v[228:231], v248, s[28:31], s59 offen sc1
  s_add_u32 s59, s36, 4096
  buffer_load_dwordx4 v[232:235], v248, s[28:31], s59 offen sc1
  s_add_u32 s59, s36, 5120
  buffer_load_dwordx4 v[236:239], v248, s[28:31], s59 offen sc1
  s_add_u32 s59, s37, 0
  buffer_load_dwordx4 v[240:243], v248, s[28:31], s59 offen sc1
  s_add_u32 s59, s37, 1024
  buffer_load_dwordx4 v[244:247], v248, s[28:31], s59 offen sc1
  s_waitcnt vmcnt(7)
  v_mfma_f32_16x16x32_bf16 v[0:3], v[72:75], v[216:219], 0
  s_waitcnt vmcnt(6)
  v_mfma_f32_16x16x32_bf16 v[4:7], v[72:75], v[220:223], 0
  s_waitcnt vmcnt(5)
  v_mfma_f32_16x16x32_bf16 v[8:11], v[72:75], v[224:227], 0
  s_add_u32 s59, s37, 2048
  buffer_load_dwordx4 v[72:75], v248, s[28:31], s59 offen sc1
  v_mfma_f32_16x16x32_bf16 v[12:15], v[76:79], v[216:219], 0
  v_mfma_f32_16x16x32_bf16 v[16:19], v[76:79], v[220:223], 0
  v_mfma_f32_16x16x32_bf16 v[20:23], v[76:79], v[224:227], 0
  s_add_u32 s59, s37, 3072
  buffer_load_dwordx4 v[76:79], v248, s[28:31], s59 offen sc1
  v_mfma_f32_16x16x32_bf16 v[24:27], v[80:83], v[216:219], 0
  v_mfma_f32_16x16x32_bf16 v[28:31], v[80:83], v[220:223], 0
  v_mfma_f32_16x16x32_bf16 v[32:35], v[80:83], v[224:227], 0
  s_add_u32 s59, s37, 4096
  buffer_load_dwordx4 v[80:83], v248, s[28:31], s59 offen sc1
  v_mfma_f32_16x16x32_bf16 v[36:39], v[84:87], v[216:219], 0
  v_mfma_f32_16x16x32_bf16 v[40:43], v[84:87], v[220:223], 0
  v_mfma_f32_16x16x32_bf16 v[44:47], v[84:87], v[224:227], 0
  v_mfma_f32_16x16x32_bf16 v[48:51], v[104:107], v[216:219], 0
  v_mfma_f32_16x16x32_bf16 v[52:55], v[104:107], v[220:223], 0
  v_mfma_f32_16x16x32_bf16 v[56:59], v[104:107], v[224:227], 0
  s_waitcnt vmcnt(7)
  v_mfma_f32_16x16x32_bf16 v[0:3], v[88:91], v[228:231], v[0:3]
  s_waitcnt vmcnt(6)
  v_mfma_f32_16x16x32_bf16 v[4:7], v[88:91], v[232:235], v[4:7]
  s_waitcnt vmcnt(5)
  v_mfma_f32_16x16x32_bf16 v[8:11], v[88:91], v[236:239], v[8:11]
  s_add_u32 s59, s37, 5120
  buffer_load_dwordx4 v[84:87], v248, s[28:31], s59 offen sc1
  s_add_u32 s59, s38, 0
  buffer_load_dwordx4 v[216:219], v248, s[28:31], s59 offen sc1
  s_add_u32 s59, s38, 1024
  buffer_load_dwordx4 v[220:223], v248, s[28:31], s59 offen sc1
  v_mfma_f32_16x16x32_bf16 v[12:15], v[92:95], v[228:231], v[12:15]
  v_mfma_f32_16x16x32_bf16 v[16:19], v[92:95], v[232:235], v[16:19]
  v_mfma_f32_16x16x32_bf16 v[20:23], v[92:95], v[236:239], v[20:23]
  v_mfma_f32_16x16x32_bf16 v[24:27], v[96:99], v[228:231], v[24:27]
  v_mfma_f32_16x16x32_bf16 v[28:31], v[96:99], v[232:235], v[28:31]
  v_mfma_f32_16x16x32_bf16 v[32:35], v[96:99], v[236:239], v[32:35]
  v_mfma_f32_16x16x32_bf16 v[36:39], v[100:103], v[228:231], v[36:39]
  v_mfma_f32_16x16x32_bf16 v[40:43], v[100:103], v[232:235], v[40:43]
  v_mfma_f32_16x16x32_bf16 v[44:47], v[100:103], v[236:239], v[44:47]
  v_mfma_f32_16x16x32_bf16 v[60:63], v[104:107], v[228:231], 0
  v_mfma_f32_16x16x32_bf16 v[64:67], v[104:107], v[232:235], 0
  v_mfma_f32_16x16x32_bf16 v[68:71], v[104:107], v[236:239], 0
  s_waitcnt vmcnt(7)
  v_mfma_f32_16x16x32_bf16 v[0:3], v[108:111], v[240:243], v[0:3]
  s_waitcnt vmcnt(6)
  v_mfma_f32_16x16x32_bf16 v[4:7], v[108:111], v[244:247], v[4:7]
  s_waitcnt vmcnt(5)
  v_mfma_f32_16x16x32_bf16 v[8:11], v[108:111], v[72:75], v[8:11]
  s_add_u32 s59, s38, 2048
  buffer_load_dwordx4 v[224:227], v248, s[28:31], s59 offen sc1
  s_add_u32 s59, s38, 3072
  buffer_load_dwordx4 v[88:91], v248, s[28:31], s59 offen sc1
  s_add_u32 s59, s38, 4096
  buffer_load_dwordx4 v[92:95], v248, s[28:31], s59 offen sc1
  v_mfma_f32_16x16x32_bf16 v[12:15], v[112:115], v[240:243], v[12:15]
  v_mfma_f32_16x16x32_bf16 v[16:19], v[112:115], v[244:247], v[16:19]
  v_mfma_f32_16x16x32_bf16 v[20:23], v[112:115], v[72:75], v[20:23]
  v_mfma_f32_16x16x32_bf16 v[24:27], v[116:119], v[240:243], v[24:27]
  v_mfma_f32_16x16x32_bf16 v[28:31], v[116:119], v[244:247], v[28:31]
  v_mfma_f32_16x16x32_bf16 v[32:35], v[116:119], v[72:75], v[32:35]
  v_mfma_f32_16x16x32_bf16 v[36:39], v[120:123], v[240:243], v[36:39]
  v_mfma_f32_16x16x32_bf16 v[40:43], v[120:123], v[244:247], v[40:43]
  v_mfma_f32_16x16x32_bf16 v[44:47], v[120:123], v[72:75], v[44:47]
  v_mfma_f32_16x16x32_bf16 v[48:51], v[140:143], v[240:243], v[48:51]
  v_mfma_f32_16x16x32_bf16 v[52:55], v[140:143], v[244:247], v[52:55]
  v_mfma_f32_16x16x32_bf16 v[56:59], v[140:143], v[72:75], v[56:59]
  s_waitcnt vmcnt(7)
  v_mfma_f32_16x16x32_bf16 v[0:3], v[124:127], v[76:79], v[0:3]
  s_waitcnt vmcnt(6)
  v_mfma_f32_16x16x32_bf16 v[4:7], v[124:127], v[80:83], v[4:7]
  s_waitcnt vmcnt(5)
  v_mfma_f32_16x16x32_bf16 v[8:11], v[124:127], v[84:87], v[8:11]
  s_add_u32 s59, s38, 5120
  buffer_load_dwordx4 v[96:99], v248, s[28:31], s59 offen sc1
  s_add_u32 s59, s39, 0
  buffer_load_dwordx4 v[100:103], v248, s[28:31], s59 offen sc1
  s_add_u32 s59, s39, 1024
  buffer_load_dwordx4 v[104:107], v248, s[28:31], s59 offen sc1
  v_mfma_f32_16x16x32_bf16 v[12:15], v[128:131], v[76:79], v[12:15]
  v_mfma_f32_16x16x32_bf16 v[16:19], v[128:131], v[80:83], v[16:19]
  v_mfma_f32_16x16x32_bf16 v[20:23], v[128:131], v[84:87], v[20:23]
  v_mfma_f32_16x16x32_bf16 v[24:27], v[132:135], v[76:79], v[24:27]
  v_mfma_f32_16x16x32_bf16 v[28:31], v[132:135], v[80:83], v[28:31]
  v_mfma_f32_16x16x32_bf16 v[32:35], v[132:135], v[84:87], v[32:35]
  v_mfma_f32_16x16x32_bf16 v[36:39], v[136:139], v[76:79], v[36:39]
  v_mfma_f32_16x16x32_bf16 v[40:43], v[136:139], v[80:83], v[40:43]
  v_mfma_f32_16x16x32_bf16 v[44:47], v[136:139], v[84:87], v[44:47]
  v_mfma_f32_16x16x32_bf16 v[60:63], v[140:143], v[76:79], v[60:63]
  v_mfma_f32_16x16x32_bf16 v[64:67], v[140:143], v[80:83], v[64:67]
  v_mfma_f32_16x16x32_bf16 v[68:71], v[140:143], v[84:87], v[68:71]
  s_waitcnt vmcnt(7)
  v_mfma_f32_16x16x32_bf16 v[0:3], v[144:147], v[216:219], v[0:3]
  s_waitcnt vmcnt(6)
  v_mfma_f32_16x16x32_bf16 v[4:7], v[144:147], v[220:223], v[4:7]
  s_waitcnt vmcnt(5)
  v_mfma_f32_16x16x32_bf16 v[8:11], v[144:147], v[224:227], v[8:11]
  s_add_u32 s59, s39, 2048
  buffer_load_dwordx4 v[228:231], v248, s[28:31], s59 offen sc1
  s_add_u32 s59, s39, 3072
  buffer_load_dwordx4 v[232:235], v248, s[28:31], s59 offen sc1
  s_add_u32 s59, s39, 4096
  buffer_load_dwordx4 v[236:239], v248, s[28:31], s59 offen sc1
  v_mfma_f32_16x16x32_bf16 v[12:15], v[148:151], v[216:219], v[12:15]
  v_mfma_f32_16x16x32_bf16 v[16:19], v[148:151], v[220:223], v[16:19]
  v_mfma_f32_16x16x32_bf16 v[20:23], v[148:151], v[224:227], v[20:23]
  v_mfma_f32_16x16x32_bf16 v[24:27], v[152:155], v[216:219], v[24:27]
  v_mfma_f32_16x16x32_bf16 v[28:31], v[152:155], v[220:223], v[28:31]
  v_mfma_f32_16x16x32_bf16 v[32:35], v[152:155], v[224:227], v[32:35]
  v_mfma_f32_16x16x32_bf16 v[36:39], v[156:159], v[216:219], v[36:39]
  v_mfma_f32_16x16x32_bf16 v[40:43], v[156:159], v[220:223], v[40:43]
  v_mfma_f32_16x16x32_bf16 v[44:47], v[156:159], v[224:227], v[44:47]
  v_mfma_f32_16x16x32_bf16 v[48:51], v[176:179], v[216:219], v[48:51]
  v_mfma_f32_16x16x32_bf16 v[52:55], v[176:179], v[220:223], v[52:55]
  v_mfma_f32_16x16x32_bf16 v[56:59], v[176:179], v[224:227], v[56:59]
  s_waitcnt vmcnt(7)
  v_mfma_f32_16x16x32_bf16 v[0:3], v[160:163], v[88:91], v[0:3]
  s_waitcnt vmcnt(6)
  v_mfma_f32_16x16x32_bf16 v[4:7], v[160:163], v[92:95], v[4:7]
  s_waitcnt vmcnt(5)
  v_mfma_f32_16x16x32_bf16 v[8:11], v[160:163], v[96:99], v[8:11]
  s_add_u32 s59, s39, 5120
  buffer_load_dwordx4 v[108:111], v248, s[28:31], s59 offen sc1
  s_add_u32 s59, s40, 0
  buffer_load_dwordx4 v[112:115], v248, s[28:31], s59 offen sc1
  s_add_u32 s59, s40, 1024
  buffer_load_dwordx4 v[116:119], v248, s[28:31], s59 offen sc1
  v_mfma_f32_16x16x32_bf16 v[12:15], v[164:167], v[88:91], v[12:15]
  v_mfma_f32_16x16x32_bf16 v[16:19], v[164:167], v[92:95], v[16:19]
  v_mfma_f32_16x16x32_bf16 v[20:23], v[164:167], v[96:99], v[20:23]
  v_mfma_f32_16x16x32_bf16 v[24:27], v[168:171], v[88:91], v[24:27]
  v_mfma_f32_16x16x32_bf16 v[28:31], v[168:171], v[92:95], v[28:31]
  v_mfma_f32_16x16x32_bf16 v[32:35], v[168:171], v[96:99], v[32:35]
  v_mfma_f32_16x16x32_bf16 v[36:39], v[172:175], v[88:91], v[36:39]
  v_mfma_f32_16x16x32_bf16 v[40:43], v[172:175], v[92:95], v[40:43]
  v_mfma_f32_16x16x32_bf16 v[44:47], v[172:175], v[96:99], v[44:47]
  v_mfma_f32_16x16x32_bf16 v[60:63], v[176:179], v[88:91], v[60:63]
  v_mfma_f32_16x16x32_bf16 v[64:67], v[176:179], v[92:95], v[64:67]
  v_mfma_f32_16x16x32_bf16 v[68:71], v[176:179], v[96:99], v[68:71]
  s_waitcnt vmcnt(7)
  v_mfma_f32_16x16x32_bf16 v[0:3], v[180:183], v[100:103], v[0:3]
  s_waitcnt vmcnt(6)
  v_mfma_f32_16x16x32_bf16 v[4:7], v[180:183], v[104:107], v[4:7]
  s_waitcnt vmcnt(5)
  v_mfma_f32_16x16x32_bf16 v[8:11], v[180:183], v[228:231], v[8:11]
  s_add_u32 s59, s40, 2048
  buffer_load_dwordx4 v[120:123], v248, s[28:31], s59 offen sc1
  s_add_u32 s59, s40, 3072
  buffer_load_dwordx4 v[240:243], v248, s[28:31], s59 offen sc1
  s_add_u32 s59, s40, 4096
  buffer_load_dwordx4 v[244:247], v248, s[28:31], s59 offen sc1
  v_mfma_f32_16x16x32_bf16 v[12:15], v[184:187], v[100:103], v[12:15]
  v_mfma_f32_16x16x32_bf16 v[16:19], v[184:187], v[104:107], v[16:19]
  v_mfma_f32_16x16x32_bf16 v[20:23], v[184:187], v[228:231], v[20:23]
  v_mfma_f32_16x16x32_bf16 v[24:27], v[188:191], v[100:103], v[24:27]
  v_mfma_f32_16x16x32_bf16 v[28:31], v[188:191], v[104:107], v[28:31]
  v_mfma_f32_16x16x32_bf16 v[32:35], v[188:191], v[228:231], v[32:35]
  v_mfma_f32_16x16x32_bf16 v[36:39], v[192:195], v[100:103], v[36:39]
  v_mfma_f32_16x16x32_bf16 v[40:43], v[192:195], v[104:107], v[40:43]
  v_mfma_f32_16x16x32_bf16 v[44:47], v[192:195], v[228:231], v[44:47]
  v_mfma_f32_16x16x32_bf16 v[48:51], v[212:215], v[100:103], v[48:51]
  v_mfma_f32_16x16x32_bf16 v[52:55], v[212:215], v[104:107], v[52:55]
  v_mfma_f32_16x16x32_bf16 v[56:59], v[212:215], v[228:231], v[56:59]
  s_waitcnt vmcnt(7)
  v_mfma_f32_16x16x32_bf16 v[0:3], v[196:199], v[232:235], v[0:3]
  s_waitcnt vmcnt(6)
  v_mfma_f32_16x16x32_bf16 v[4:7], v[196:199], v[236:239], v[4:7]
  s_waitcnt vmcnt(5)
  v_mfma_f32_16x16x32_bf16 v[8:11], v[196:199], v[108:111], v[8:11]
  s_add_u32 s59, s40, 5120
  buffer_load_dwordx4 v[72:75], v248, s[28:31], s59 offen sc1
  s_add_u32 s59, s41, 0
  buffer_load_dwordx4 v[124:127], v248, s[28:31], s59 offen sc1
  s_add_u32 s59, s41, 1024
  buffer_load_dwordx4 v[128:131], v248, s[28:31], s59 offen sc1
  v_mfma_f32_16x16x32_bf16 v[12:15], v[200:203], v[232:235], v[12:15]
  v_mfma_f32_16x16x32_bf16 v[16:19], v[200:203], v[236:239], v[16:19]
  v_mfma_f32_16x16x32_bf16 v[20:23], v[200:203], v[108:111], v[20:23]
  v_mov_b32 v252, 163336
  s_mov_b32 s65, 16777216
L_ldn:
  ds_read_b32 v253, v252
  s_waitcnt lgkmcnt(0)
  v_cmp_gt_u32 vcc, 3, v253
  s_nop 1
  s_cbranch_vccz L_ldn_ok
  s_sleep 1
  s_sub_u32 s65, s65, 1
  s_cmp_lg_u32 s65, 0
  s_cbranch_scc1 L_ldn
L_ldn_ok:
  ds_read_b128 v[132:135], v250 offset:0
  v_mfma_f32_16x16x32_bf16 v[24:27], v[204:207], v[232:235], v[24:27]
  v_mfma_f32_16x16x32_bf16 v[28:31], v[204:207], v[236:239], v[28:31]
  v_mfma_f32_16x16x32_bf16 v[32:35], v[204:207], v[108:111], v[32:35]
  ds_read_b128 v[136:139], v250 offset:1024
  v_mfma_f32_16x16x32_bf16 v[36:39], v[208:211], v[232:235], v[36:39]
  v_mfma_f32_16x16x32_bf16 v[40:43], v[208:211], v[236:239], v[40:43]
  v_mfma_f32_16x16x32_bf16 v[44:47], v[208:211], v[108:111], v[44:47]
  ds_read_b128 v[140:143], v250 offset:2048
  v_mfma_f32_16x16x32_bf16 v[60:63], v[212:215], v[232:235], v[60:63]
  v_mfma_f32_16x16x32_bf16 v[64:67], v[212:215], v[236:239], v[64:67]
  v_mfma_f32_16x16x32_bf16 v[68:71], v[212:215], v[108:111], v[68:71]
  ds_read_b128 v[76:79], v250 offset:3072
  s_waitcnt vmcnt(7) lgkmcnt(3)
  v_mfma_f32_16x16x32_bf16 v[0:3], v[132:135], v[112:115], v[0:3]
  s_waitcnt vmcnt(6)
  v_mfma_f32_16x16x32_bf16 v[4:7], v[132:135], v[116:119], v[4:7]
  s_waitcnt vmcnt(5)
  v_mfma_f32_16x16x32_bf16 v[8:11], v[132:135], v[120:123], v[8:11]
  ds_read_b128 v[80:83], v250 offset:8192
  s_add_u32 s59, s41, 2048
  buffer_load_dwordx4 v[84:87], v248, s[28:31], s59 offen sc1
  s_add_u32 s59, s41, 3072
  buffer_load_dwordx4 v[144:147], v248, s[28:31], s59 offen sc1
  s_add_u32 s59, s41, 4096
  buffer_load_dwordx4 v[148:151], v248, s[28:31], s59 offen sc1
  s_waitcnt lgkmcnt(3)
  v_mfma_f32_16x16x32_bf16 v[12:15], v[136:139], v[112:115], v[12:15]
  v_mfma_f32_16x16x32_bf16 v[16:19], v[136:139], v[116:119], v[16:19]
  v_mfma_f32_16x16x32_bf16 v[20:23], v[136:139], v[120:123], v[20:23]
  ds_read_b128 v[152:155], v250 offset:4096
  s_waitcnt lgkmcnt(3)
  v_mfma_f32_16x16x32_bf16 v[24:27], v[140:143], v[112:115], v[24:27]
  v_mfma_f32_16x16x32_bf16 v[28:31], v[140:143], v[116:119], v[28:31]
  v_mfma_f32_16x16x32_bf16 v[32:35], v[140:143], v[120:123], v[32:35]
  ds_read_b128 v[156:159], v250 offset:5120
  s_waitcnt lgkmcnt(3)
  v_mfma_f32_16x16x32_bf16 v[36:39], v[76:79], v[112:115], v[36:39]
  v_mfma_f32_16x16x32_bf16 v[40:43], v[76:79], v[116:119], v[40:43]
  v_mfma_f32_16x16x32_bf16 v[44:47], v[76:79], v[120:123], v[44:47]
  ds_read_b128 v[216:219], v250 offset:6144
  s_waitcnt lgkmcnt(3)
  v_mfma_f32_16x16x32_bf16 v[48:51], v[80:83], v[112:115], v[48:51]
  v_mfma_f32_16x16x32_bf16 v[52:55], v[80:83], v[116:119], v[52:55]
  v_mfma_f32_16x16x32_bf16 v[56:59], v[80:83], v[120:123], v[56:59]
  ds_read_b128 v[220:223], v250 offset:7168
  s_waitcnt vmcnt(7) lgkmcnt(3)
  v_mfma_f32_16x16x32_bf16 v[0:3], v[152:155], v[240:243], v[0:3]
  s_waitcnt vmcnt(6)
  v_mfma_f32_16x16x32_bf16 v[4:7], v[152:155], v[244:247], v[4:7]
  s_waitcnt vmcnt(5)
  v_mfma_f32_16x16x32_bf16 v[8:11], v[152:155], v[72:75], v[8:11]
  s_add_u32 s59, s41, 5120
  buffer_load_dwordx4 v[224:227], v248, s[28:31], s59 offen sc1
  s_add_u32 s59, s22, 0
  buffer_load_dwordx4 v[160:163], v249, s[32:35], s59 offen sc1
  s_add_u32 s59, s42, 0
  buffer_load_dwordx4 v[164:167], v248, s[28:31], s59 offen sc1
  s_waitcnt lgkmcnt(2)
  v_mfma_f32_16x16x32_bf16 v[12:15], v[156:159], v[240:243], v[12:15]
  v_mfma_f32_16x16x32_bf16 v[16:19], v[156:159], v[244:247], v[16:19]
  v_mfma_f32_16x16x32_bf16 v[20:23], v[156:159], v[72:75], v[20:23]
  ds_read_b128 v[168:171], v254 offset:0
  s_waitcnt lgkmcnt(2)
  v_mfma_f32_16x16x32_bf16 v[24:27], v[216:219], v[240:243], v[24:27]
  v_mfma_f32_16x16x32_bf16 v[28:31], v[216:219], v[244:247], v[28:31]
  v_mfma_f32_16x16x32_bf16 v[32:35], v[216:219], v[72:75], v[32:35]
  ds_read_b128 v[172:175], v254 offset:1024
  s_waitcnt lgkmcnt(2)
  v_mfma_f32_16x16x32_bf16 v[36:39], v[220:223], v[240:243], v[36:39]
  v_mfma_f32_16x16x32_bf16 v[40:43], v[220:223], v[244:247], v[40:43]
  v_mfma_f32_16x16x32_bf16 v[44:47], v[220:223], v[72:75], v[44:47]
  ds_read_b128 v[176:179], v254 offset:2048
  v_mfma_f32_16x16x32_bf16 v[60:63], v[80:83], v[240:243], v[60:63]
  v_mfma_f32_16x16x32_bf16 v[64:67], v[80:83], v[244:247], v[64:67]
  v_mfma_f32_16x16x32_bf16 v[68:71], v[80:83], v[72:75], v[68:71]
  ds_read_b128 v[88:91], v254 offset:3072
  s_waitcnt vmcnt(7) lgkmcnt(3)
  v_mfma_f32_16x16x32_bf16 v[0:3], v[168:171], v[124:127], v[0:3]
  s_waitcnt vmcnt(6)
  v_mfma_f32_16x16x32_bf16 v[4:7], v[168:171], v[128:131], v[4:7]
  s_waitcnt vmcnt(5)
  v_mfma_f32_16x16x32_bf16 v[8:11], v[168:171], v[84:87], v[8:11]
  ds_read_b128 v[92:95], v254 offset:8192
  s_add_u32 s59, s42, 1024
  buffer_load_dwordx4 v[96:99], v248, s[28:31], s59 offen sc1
  s_add_u32 s59, s42, 2048
  buffer_load_dwordx4 v[180:183], v248, s[28:31], s59 offen sc1
  s_add_u32 s59, s22, 1024
  buffer_load_dwordx4 v[184:187], v249, s[32:35], s59 offen sc1
  s_waitcnt lgkmcnt(3)
  v_mfma_f32_16x16x32_bf16 v[12:15], v[172:175], v[124:127], v[12:15]
  v_mfma_f32_16x16x32_bf16 v[16:19], v[172:175], v[128:131], v[16:19]
  v_mfma_f32_16x16x32_bf16 v[20:23], v[172:175], v[84:87], v[20:23]
  ds_read_b128 v[188:191], v254 offset:4096
  s_waitcnt lgkmcnt(3)
  v_mfma_f32_16x16x32_bf16 v[24:27], v[176:179], v[124:127], v[24:27]
  v_mfma_f32_16x16x32_bf16 v[28:31], v[176:179], v[128:131], v[28:31]
  v_mfma_f32_16x16x32_bf16 v[32:35], v[176:179], v[84:87], v[32:35]
  ds_read_b128 v[192:195], v254 offset:5120
  s_waitcnt lgkmcnt(3)
  v_mfma_f32_16x16x32_bf16 v[36:39], v[88:91], v[124:127], v[36:39]
  v_mfma_f32_16x16x32_bf16 v[40:43], v[88:91], v[128:131], v[40:43]
  v_mfma_f32_16x16x32_bf16 v[44:47], v[88:91], v[84:87], v[44:47]
  ds_read_b128 v[100:103], v254 offset:6144
  s_waitcnt lgkmcnt(3)
  v_mfma_f32_16x16x32_bf16 v[48:51], v[92:95], v[124:127], v[48:51]
  v_mfma_f32_16x16x32_bf16 v[52:55], v[92:95], v[128:131], v[52:55]
  v_mfma_f32_16x16x32_bf16 v[56:59], v[92:95], v[84:87], v[56:59]
  ds_read_b128 v[104:107], v254 offset:7168
  s_waitcnt vmcnt(7) lgkmcnt(3)
  v_mfma_f32_16x16x32_bf16 v[0:3], v[188:191], v[144:147], v[0:3]
  s_waitcnt vmcnt(6)
  v_mfma_f32_16x16x32_bf16 v[4:7], v[188:191], v[148:151], v[4:7]
  s_waitcnt vmcnt(5)
  v_mfma_f32_16x16x32_bf16 v[8:11], v[188:191], v[224:227], v[8:11]
  s_add_u32 s59, s22, 2048
  buffer_load_dwordx4 v[228:231], v249, s[32:35], s59 offen sc1
  s_add_u32 s59, s22, 3072
  buffer_load_dwordx4 v[196:199], v249, s[32:35], s59 offen sc1
  s_add_u32 s59, s22, 8192
  buffer_load_dwordx4 v[200:203], v249, s[32:35], s59 offen sc1
  s_waitcnt lgkmcnt(2)
  v_mfma_f32_16x16x32_bf16 v[12:15], v[192:195], v[144:147], v[12:15]
  v_mfma_f32_16x16x32_bf16 v[16:19], v[192:195], v[148:151], v[16:19]
  v_mfma_f32_16x16x32_bf16 v[20:23], v[192:195], v[224:227], v[20:23]
  s_waitcnt lgkmcnt(1)
  v_mfma_f32_16x16x32_bf16 v[24:27], v[100:103], v[144:147], v[24:27]
  v_mfma_f32_16x16x32_bf16 v[28:31], v[100:103], v[148:151], v[28:31]
  v_mfma_f32_16x16x32_bf16 v[32:35], v[100:103], v[224:227], v[32:35]
  s_waitcnt lgkmcnt(0)
  v_mfma_f32_16x16x32_bf16 v[36:39], v[104:107], v[144:147], v[36:39]
  v_mfma_f32_16x16x32_bf16 v[40:43], v[104:107], v[148:151], v[40:43]
  v_mfma_f32_16x16x32_bf16 v[44:47], v[104:107], v[224:227], v[44:47]
  v_mfma_f32_16x16x32_bf16 v[60:63], v[92:95], v[144:147], v[60:63]
  v_mfma_f32_16x16x32_bf16 v[64:67], v[92:95], v[148:151], v[64:67]
  v_mfma_f32_16x16x32_bf16 v[68:71], v[92:95], v[224:227], v[68:71]
  s_waitcnt vmcnt(6)
  v_mfma_f32_16x16x32_bf16 v[0:3], v[160:163], v[164:167], v[0:3]
  s_waitcnt vmcnt(5)
  v_mfma_f32_16x16x32_bf16 v[4:7], v[160:163], v[96:99], v[4:7]
  s_waitcnt vmcnt(4)
  v_mfma_f32_16x16x32_bf16 v[8:11], v[160:163], v[180:183], v[8:11]
  s_add_u32 s59, s22, 4096
  buffer_load_dwordx4 v[204:207], v249, s[32:35], s59 offen sc1
  s_add_u32 s59, s42, 3072
  buffer_load_dwordx4 v[208:211], v248, s[28:31], s59 offen sc1
  s_add_u32 s59, s42, 4096
  buffer_load_dwordx4 v[212:215], v248, s[28:31], s59 offen sc1
  s_add_u32 s59, s42, 5120
  buffer_load_dwordx4 v[232:235], v248, s[28:31], s59 offen sc1
  s_waitcnt vmcnt(7)
  v_mfma_f32_16x16x32_bf16 v[12:15], v[184:187], v[164:167], v[12:15]
  v_mfma_f32_16x16x32_bf16 v[16:19], v[184:187], v[96:99], v[16:19]
  v_mfma_f32_16x16x32_bf16 v[20:23], v[184:187], v[180:183], v[20:23]
  s_add_u32 s59, s22, 5120
  buffer_load_dwordx4 v[236:239], v249, s[32:35], s59 offen sc1
  s_waitcnt vmcnt(7)
  v_mfma_f32_16x16x32_bf16 v[24:27], v[228:231], v[164:167], v[24:27]
  v_mfma_f32_16x16x32_bf16 v[28:31], v[228:231], v[96:99], v[28:31]
  v_mfma_f32_16x16x32_bf16 v[32:35], v[228:231], v[180:183], v[32:35]
  s_add_u32 s59, s22, 6144
  buffer_load_dwordx4 v[108:111], v249, s[32:35], s59 offen sc1
  s_waitcnt vmcnt(7)
  v_mfma_f32_16x16x32_bf16 v[36:39], v[196:199], v[164:167], v[36:39]
  v_mfma_f32_16x16x32_bf16 v[40:43], v[196:199], v[96:99], v[40:43]
  v_mfma_f32_16x16x32_bf16 v[44:47], v[196:199], v[180:183], v[44:47]
  s_add_u32 s59, s22, 7168
  buffer_load_dwordx4 v[132:135], v249, s[32:35], s59 offen sc1
  s_waitcnt vmcnt(7)
  v_mfma_f32_16x16x32_bf16 v[48:51], v[200:203], v[164:167], v[48:51]
  v_mfma_f32_16x16x32_bf16 v[52:55], v[200:203], v[96:99], v[52:55]
  v_mfma_f32_16x16x32_bf16 v[56:59], v[200:203], v[180:183], v[56:59]
  s_add_u32 s59, s23, 0
  buffer_load_dwordx4 v[136:139], v249, s[32:35], s59 offen sc1
  s_waitcnt vmcnt(6)
  v_mfma_f32_16x16x32_bf16 v[0:3], v[204:207], v[208:211], v[0:3]
  s_waitcnt vmcnt(5)
  v_mfma_f32_16x16x32_bf16 v[4:7], v[204:207], v[212:215], v[4:7]
  s_waitcnt vmcnt(4)
  v_mfma_f32_16x16x32_bf16 v[8:11], v[204:207], v[232:235], v[8:11]
  s_add_u32 s59, s43, 0
  buffer_load_dwordx4 v[140:143], v248, s[28:31], s59 offen sc1
  s_add_u32 s59, s43, 1024
  buffer_load_dwordx4 v[76:79], v248, s[28:31], s59 offen sc1
  s_add_u32 s59, s43, 2048
  buffer_load_dwordx4 v[112:115], v248, s[28:31], s59 offen sc1
  s_add_u32 s59, s23, 1024
  buffer_load_dwordx4 v[116:119], v249, s[32:35], s59 offen sc1
  s_waitcnt vmcnt(7)
  v_mfma_f32_16x16x32_bf16 v[12:15], v[236:239], v[208:211], v[12:15]
  v_mfma_f32_16x16x32_bf16 v[16:19], v[236:239], v[212:215], v[16:19]
  v_mfma_f32_16x16x32_bf16 v[20:23], v[236:239], v[232:235], v[20:23]
  s_add_u32 s59, s23, 2048
  buffer_load_dwordx4 v[120:123], v249, s[32:35], s59 offen sc1
  s_waitcnt vmcnt(7)
  v_mfma_f32_16x16x32_bf16 v[24:27], v[108:111], v[208:211], v[24:27]
  v_mfma_f32_16x16x32_bf16 v[28:31], v[108:111], v[212:215], v[28:31]
  v_mfma_f32_16x16x32_bf16 v[32:35], v[108:111], v[232:235], v[32:35]
  s_add_u32 s59, s23, 3072
  buffer_load_dwordx4 v[152:155], v249, s[32:35], s59 offen sc1
  s_waitcnt vmcnt(7)
  v_mfma_f32_16x16x32_bf16 v[36:39], v[132:135], v[208:211], v[36:39]
  v_mfma_f32_16x16x32_bf16 v[40:43], v[132:135], v[212:215], v[40:43]
  v_mfma_f32_16x16x32_bf16 v[44:47], v[132:135], v[232:235], v[44:47]
  s_add_u32 s59, s23, 8192
  buffer_load_dwordx4 v[156:159], v249, s[32:35], s59 offen sc1
  v_mfma_f32_16x16x32_bf16 v[60:63], v[200:203], v[208:211], v[60:63]
  v_mfma_f32_16x16x32_bf16 v[64:67], v[200:203], v[212:215], v[64:67]
  v_mfma_f32_16x16x32_bf16 v[68:71], v[200:203], v[232:235], v[68:71]
  s_waitcnt vmcnt(6)
  v_mfma_f32_16x16x32_bf16 v[0:3], v[136:139], v[140:143], v[0:3]
  s_waitcnt vmcnt(5)
  v_mfma_f32_16x16x32_bf16 v[4:7], v[136:139], v[76:79], v[4:7]
  s_waitcnt vmcnt(4)
  v_mfma_f32_16x16x32_bf16 v[8:11], v[136:139], v[112:115], v[8:11]
  s_add_u32 s59, s23, 4096
  buffer_load_dwordx4 v[216:219], v249, s[32:35], s59 offen sc1
  s_add_u32 s59, s43, 3072
  buffer_load_dwordx4 v[220:223], v248, s[28:31], s59 offen sc1
  s_add_u32 s59, s43, 4096
  buffer_load_dwordx4 v[80:83], v248, s[28:31], s59 offen sc1
  s_add_u32 s59, s43, 5120
  buffer_load_dwordx4 v[240:243], v248, s[28:31], s59 offen sc1
  s_waitcnt vmcnt(7)
  v_mfma_f32_16x16x32_bf16 v[12:15], v[116:119], v[140:143], v[12:15]
  v_mfma_f32_16x16x32_bf16 v[16:19], v[116:119], v[76:79], v[16:19]
  v_mfma_f32_16x16x32_bf16 v[20:23], v[116:119], v[112:115], v[20:23]
  s_add_u32 s59, s23, 5120
  buffer_load_dwordx4 v[244:247], v249, s[32:35], s59 offen sc1
  s_waitcnt vmcnt(7)
  v_mfma_f32_16x16x32_bf16 v[24:27], v[120:123], v[140:143], v[24:27]
  v_mfma_f32_16x16x32_bf16 v[28:31], v[120:123], v[76:79], v[28:31]
  v_mfma_f32_16x16x32_bf16 v[32:35], v[120:123], v[112:115], v[32:35]
  s_add_u32 s59, s23, 6144
  buffer_load_dwordx4 v[72:75], v249, s[32:35], s59 offen sc1
  s_waitcnt vmcnt(7)
  v_mfma_f32_16x16x32_bf16 v[36:39], v[152:155], v[140:143], v[36:39]
  v_mfma_f32_16x16x32_bf16 v[40:43], v[152:155], v[76:79], v[40:43]
  v_mfma_f32_16x16x32_bf16 v[44:47], v[152:155], v[112:115], v[44:47]
  s_add_u32 s59, s23, 7168
  buffer_load_dwordx4 v[168:171], v249, s[32:35], s59 offen sc1
  s_waitcnt vmcnt(7)
  v_mfma_f32_16x16x32_bf16 v[48:51], v[156:159], v[140:143], v[48:51]
  v_mfma_f32_16x16x32_bf16 v[52:55], v[156:159], v[76:79], v[52:55]
  v_mfma_f32_16x16x32_bf16 v[56:59], v[156:159], v[112:115], v[56:59]
  s_waitcnt vmcnt(5)
  v_mfma_f32_16x16x32_bf16 v[0:3], v[216:219], v[220:223], v[0:3]
  s_waitcnt vmcnt(4)
  v_mfma_f32_16x16x32_bf16 v[4:7], v[216:219], v[80:83], v[4:7]
  s_waitcnt vmcnt(3)
  v_mfma_f32_16x16x32_bf16 v[8:11], v[216:219], v[240:243], v[8:11]
  s_waitcnt vmcnt(2)
  v_mfma_f32_16x16x32_bf16 v[12:15], v[244:247], v[220:223], v[12:15]
  v_mfma_f32_16x16x32_bf16 v[16:19], v[244:247], v[80:83], v[16:19]
  v_mfma_f32_16x16x32_bf16 v[20:23], v[244:247], v[240:243], v[20:23]
  s_waitcnt vmcnt(1)
  v_mfma_f32_16x16x32_bf16 v[24:27], v[72:75], v[220:223], v[24:27]
  v_mfma_f32_16x16x32_bf16 v[28:31], v[72:75], v[80:83], v[28:31]
  v_mfma_f32_16x16x32_bf16 v[32:35], v[72:75], v[240:243], v[32:35]
  s_waitcnt vmcnt(0)
  v_mfma_f32_16x16x32_bf16 v[36:39], v[168:171], v[220:223], v[36:39]
  v_mfma_f32_16x16x32_bf16 v[40:43], v[168:171], v[80:83], v[40:43]
  v_mfma_f32_16x16x32_bf16 v[44:47], v[168:171], v[240:243], v[44:47]
  v_mfma_f32_16x16x32_bf16 v[60:63], v[156:159], v[220:223], v[60:63]
  v_mfma_f32_16x16x32_bf16 v[64:67], v[156:159], v[80:83], v[64:67]
  v_mfma_f32_16x16x32_bf16 v[68:71], v[156:159], v[240:243], v[68:71]
  v_cmp_gt_u32 vcc, 32, v255
  s_nop 4
  v_cndmask_b32 v48, v60, v48, vcc
  v_cndmask_b32 v49, v61, v49, vcc
  v_cndmask_b32 v50, v62, v50, vcc
  v_cndmask_b32 v51, v63, v51, vcc
  v_cndmask_b32 v52, v64, v52, vcc
  v_cndmask_b32 v53, v65, v53, vcc
  v_cndmask_b32 v54, v66, v54, vcc
  v_cndmask_b32 v55, v67, v55, vcc
  v_cndmask_b32 v56, v68, v56, vcc
  v_cndmask_b32 v57, v69, v57, vcc
  v_cndmask_b32 v58, v70, v58, vcc
  v_cndmask_b32 v59, v71, v59, vcc
  s_waitcnt lgkmcnt(0)
  ds_write_b128 v250, v[0:3] offset:0
  ds_write_b128 v250, v[4:7] offset:1024
  ds_write_b128 v250, v[8:11] offset:2048
  ds_write_b128 v250, v[12:15] offset:3072
  ds_write_b128 v250, v[16:19] offset:4096
  ds_write_b128 v250, v[20:23] offset:5120
  ds_write_b128 v250, v[24:27] offset:6144
  ds_write_b128 v250, v[28:31] offset:7168
  ds_write_b128 v254, v[32:35] offset:0
  ds_write_b128 v254, v[36:39] offset:1024
  ds_write_b128 v254, v[40:43] offset:2048
  ds_write_b128 v254, v[44:47] offset:3072
  ds_write_b128 v254, v[48:51] offset:4096
  ds_write_b128 v254, v[52:55] offset:5120
  ds_write_b128 v254, v[56:59] offset:6144
  v_and_b32 v210, 15, v255
  v_lshrrev_b32 v211, 4, v255
  s_mul_i32 s57, s70, 55296
  s_mul_i32 s58, s71, 144
  s_add_u32 s57, s57, s58
  v_mul_u32_u24 v212, 1152, v210
  v_lshl_add_u32 v212, v211, 3, v212
  v_add_u32 v212, s57, v212
  s_lshl_b32 s55, s54, 10
  v_add_u32 v205, s55, v251
  v_add_u32 v206, 0x10000, v205
  v_add_u32 v207, 0x20000, v205
  s_waitcnt lgkmcnt(0)
  s_waitcnt lgkmcnt(0)
  s_barrier
  ds_read_b128 v[8:11], v205 offset:27648
  ds_read_b128 v[12:15], v205 offset:46080
  ds_read_b128 v[16:19], v206 offset:20480
  ds_read_b128 v[20:23], v206 offset:38912
  ds_read_b128 v[24:27], v205 offset:9216
  ds_read_b128 v[28:31], v205 offset:18432
  ds_read_b128 v[32:35], v207 offset:4096
  ds_read_b128 v[36:39], v207 offset:22528
  ds_read_b128 v[48:51], v205 offset:36864
  ds_read_b128 v[52:55], v205 offset:55296
  ds_read_b128 v[56:59], v206 offset:29696
  ds_read_b128 v[60:63], v206 offset:48128
  ds_read_b128 v[64:67], v206 offset:2048
  ds_read_b128 v[68:71], v206 offset:11264
  ds_read_b128 v[72:75], v207 offset:13312
  ds_read_b128 v[76:79], v205 offset:0
  s_mov_b32 s66, s54
  s_waitcnt lgkmcnt(14)
  v_add_f32 v8, v8, v12
  s_waitcnt lgkmcnt(12)
  v_add_f32 v16, v16, v20
  s_waitcnt lgkmcnt(10)
  v_add_f32 v24, v24, v28
  s_waitcnt lgkmcnt(8)
  v_add_f32 v32, v32, v36
  v_add_f32 v9, v9, v13
  v_add_f32 v17, v17, v21
  v_add_f32 v25, v25, v29
  v_add_f32 v33, v33, v37
  v_add_f32 v10, v10, v14
  v_add_f32 v18, v18, v22
  v_add_f32 v26, v26, v30
  v_add_f32 v34, v34, v38
  v_add_f32 v11, v11, v15
  v_add_f32 v19, v19, v23
  v_add_f32 v27, v27, v31
  v_add_f32 v35, v35, v39
  v_add_f32 v8, v8, v16
  v_add_f32 v24, v24, v32
  v_add_f32 v9, v9, v17
  v_add_f32 v25, v25, v33
  v_add_f32 v10, v10, v18
  v_add_f32 v26, v26, v34
  v_add_f32 v11, v11, v19
  v_add_f32 v27, v27, v35
  v_add_f32 v8, v8, v24
  v_add_f32 v9, v9, v25
  v_add_f32 v10, v10, v26
  v_add_f32 v11, v11, v27
  s_mul_i32 s64, s66, 86
  s_lshr_b32 s64, s64, 8
  s_mul_i32 s65, s64, 3
  s_sub_u32 s65, s66, s65
  s_mul_i32 s65, s65, 18432
  s_lshl_b32 s64, s64, 5
  s_add_u32 s64, s64, s65
  v_cvt_pk_bf16_f32 v8, v8, v9
  v_cvt_pk_bf16_f32 v9, v10, v11
  buffer_store_dwordx2 v[8:9], v212, s[4:7], s64 offen
  s_cmp_eq_u32 s54, 7
  s_cbranch_scc1 L_done
  s_waitcnt lgkmcnt(6)
  v_add_f32 v48, v48, v52
  s_waitcnt lgkmcnt(4)
  v_add_f32 v56, v56, v60
  s_waitcnt lgkmcnt(2)
  v_add_f32 v64, v64, v68
  s_waitcnt lgkmcnt(0)
  v_add_f32 v72, v72, v76
  v_add_f32 v49, v49, v53
  v_add_f32 v57, v57, v61
  v_add_f32 v65, v65, v69
  v_add_f32 v73, v73, v77
  v_add_f32 v50, v50, v54
  v_add_f32 v58, v58, v62
  v_add_f32 v66, v66, v70
  v_add_f32 v74, v74, v78
  v_add_f32 v51, v51, v55
  v_add_f32 v59, v59, v63
  v_add_f32 v67, v67, v71
  v_add_f32 v75, v75, v79
  v_add_f32 v48, v48, v56
  v_add_f32 v64, v64, v72
  v_add_f32 v49, v49, v57
  v_add_f32 v65, v65, v73
  v_add_f32 v50, v50, v58
  v_add_f32 v66, v66, v74
  v_add_f32 v51, v51, v59
  v_add_f32 v67, v67, v75
  v_add_f32 v48, v48, v64
  v_add_f32 v49, v49, v65
  v_add_f32 v50, v50, v66
  v_add_f32 v51, v51, v67
  s_add_u32 s66, s54, 8
  s_cmp_ge_u32 s54, 4
  s_cbranch_scc1 L_half
  s_mul_i32 s64, s66, 86
  s_lshr_b32 s64, s64, 8
  s_mul_i32 s65, s64, 3
  s_sub_u32 s65, s66, s65
  s_mul_i32 s65, s65, 18432
  s_lshl_b32 s64, s64, 5
  s_add_u32 s64, s64, s65
  v_cvt_pk_bf16_f32 v48, v48, v49
  v_cvt_pk_bf16_f32 v49, v50, v51
  buffer_store_dwordx2 v[48:49], v212, s[4:7], s64 offen
  s_branch L_done
L_half:
  v_mov_b32 v56, v48
  v_mov_b32 v57, v49
  v_mov_b32 v58, v50
  v_mov_b32 v59, v51
  v_permlane32_swap_b32 v48, v56
  v_permlane32_swap_b32 v49, v57
  v_permlane32_swap_b32 v50, v58
  v_permlane32_swap_b32 v51, v59
  v_add_f32 v48, v48, v56
  v_add_f32 v49, v49, v57
  v_add_f32 v50, v50, v58
  v_add_f32 v51, v51, v59
  v_cmp_gt_u32 vcc, 32, v255
  s_nop 1
  s_and_saveexec_b64 s[68:69], vcc
  s_mul_i32 s64, s66, 86
  s_lshr_b32 s64, s64, 8
  s_mul_i32 s65, s64, 3
  s_sub_u32 s65, s66, s65
  s_mul_i32 s65, s65, 18432
  s_lshl_b32 s64, s64, 5
  s_add_u32 s64, s64, s65
  v_cvt_pk_bf16_f32 v48, v48, v49
  v_cvt_pk_bf16_f32 v49, v50, v51
  buffer_store_dwordx2 v[48:49], v212, s[4:7], s64 offen
L_done:
L_exit:
  s_endpgm
L_code_end:
.section .rodata,"a"
.p2align 6
.amdhsa_kernel standalone__gqa_block_cached__near_ridge_kernel
  .amdhsa_next_free_vgpr 256
  .amdhsa_next_free_sgpr 96
  .amdhsa_accum_offset 256
  .amdhsa_group_segment_fixed_size 0
  .amdhsa_kernarg_size 64
  .amdhsa_user_sgpr_count 2
  .amdhsa_user_sgpr_kernarg_segment_ptr 1
  .amdhsa_system_sgpr_workgroup_id_x 1
.end_amdhsa_kernel
```
